```python
import torch

def _softmax(x, axis=-1):
    return torch.softmax(x, dim=axis)
def _gelu(x):
    return torch.nn.functional.gelu(x, approximate="tanh")
def _silu(x):
    return torch.nn.functional.silu(x)
def _sigmoid(x):
    return torch.sigmoid(x)
def _layernorm(x, axis=-1, eps=1e-5):
    m = x.mean(dim=axis, keepdim=True)
    v = x.var(dim=axis, keepdim=True, unbiased=False)
    return (x - m) / torch.sqrt(v + eps)
def _scatter_add(tgt, idx, src, axis=0):
    return tgt.clone().index_add_(axis, idx, src)
def _segment_sum(src, seg, n):
    out = torch.zeros((n,) + src.shape[1:], dtype=src.dtype)
    return out.index_add_(0, seg, src)
def _pad(x, pw):
    flat = tuple(v for pair in reversed(pw) for v in pair)
    return torch.nn.functional.pad(x, flat)

kernel_name = 'concat_heads__gqa_block_cached__mha_block_cached__near_ridge'

def setup_inputs():

    _w = (lambda a: (lambda t: t.to(torch.bfloat16) if t.is_floating_point() else t)(torch.as_tensor(a)))
    def _A_setup():
        B, Sq, D = 32, 64, 512
        Hq, Hkv, Sk, Dh = 32, 8, 512, 128
        assert Hq % Hkv == 0, (Hq, Hkv)
        return {
            "x": _w((lambda *s: torch.randn(*s, dtype=torch.bfloat16) * 0.8)(B, Sq, D)),
            "k_cache": _w((lambda *s: torch.randn(*s, dtype=torch.bfloat16) * 0.8)(B, Hkv, Sk, Dh)),
            "v_cache": _w((lambda *s: torch.randn(*s, dtype=torch.bfloat16) * 0.05)(B, Hkv, Sk, Dh)),
            "wq": _w((lambda *s: torch.randn(*s, dtype=torch.bfloat16) * 0.8)(D, Hq * Dh) * (D ** -0.5)),
            "wo": _w((lambda *s: torch.randn(*s, dtype=torch.bfloat16) * 0.05)(Hq * Dh, D) * ((Hq * Dh) ** -0.5)),
        }
    _A_in = _A_setup()

    def _B_setup():
        B, Sq, D = 32, 64, 512
        H, Sk, Dh = 32, 512, 128
        return {
            "x": _w((lambda *s: torch.randn(*s, dtype=torch.bfloat16) * 0.8)(B, Sq, D)),
            "k_cache": _w((lambda *s: torch.randn(*s, dtype=torch.bfloat16) * 0.8)(B, H, Sk, Dh)),
            "v_cache": _w((lambda *s: torch.randn(*s, dtype=torch.bfloat16) * 0.05)(B, H, Sk, Dh)),
            "wq": _w((lambda *s: torch.randn(*s, dtype=torch.bfloat16) * 0.8)(D, H * Dh) * (D ** -0.5)),
            "wo": _w((lambda *s: torch.randn(*s, dtype=torch.bfloat16) * 0.05)(H * Dh, D) * ((H * Dh) ** -0.5)),
        }
    _B_in = _B_setup()

    return {
        "A_x": _A_in["x"],
        "A_k_cache": _A_in["k_cache"],
        "A_v_cache": _A_in["v_cache"],
        "A_wq": _A_in["wq"],
        "A_wo": _A_in["wo"],
        "B_x": _B_in["x"],
        "B_k_cache": _B_in["k_cache"],
        "B_v_cache": _B_in["v_cache"],
        "B_wq": _B_in["wq"],
        "B_wo": _B_in["wo"],
    }

def reference(A_x, A_k_cache, A_v_cache, A_wq, A_wo, B_x, B_k_cache, B_v_cache, B_wq, B_wo):
    def _A_ref(x, k_cache, v_cache, wq, wo):
        B, Sq, D = x.shape
        Hq, Dh = 32, 128
        Hkv = k_cache.shape[1]
        rep = Hq // Hkv
        q = (lambda x, *d: x.permute(*d))((x @ wq).reshape(B, Sq, Hq, Dh), 0, 2, 1, 3)
        k = (lambda x, n, axis: torch.repeat_interleave(x, n, dim=axis))(k_cache, rep, axis=1)
        v = (lambda x, n, axis: torch.repeat_interleave(x, n, dim=axis))(v_cache, rep, axis=1)
        scores = torch.einsum("bhqd,bhkd->bhqk", q, k) * (Dh ** -0.5)
        p = _softmax(scores, axis=-1)
        o = torch.einsum("bhqk,bhkd->bhqd", p, v)
        return (lambda x, *d: x.permute(*d))(o, 0, 2, 1, 3).reshape(B, Sq, Hq * Dh) @ wo

    def _B_ref(x, k_cache, v_cache, wq, wo):
        B, Sq, D = x.shape
        H, Dh = 32, 128
        q = (lambda x, *d: x.permute(*d))((x @ wq).reshape(B, Sq, H, Dh), 0, 2, 1, 3)
        scores = torch.einsum("bhqd,bhkd->bhqk", q, k_cache) * (Dh ** -0.5)
        p = _softmax(scores, axis=-1)
        o = torch.einsum("bhqk,bhkd->bhqd", p, v_cache)
        return (lambda x, *d: x.permute(*d))(o, 0, 2, 1, 3).reshape(B, Sq, H * Dh) @ wo

    a = _A_ref(A_x, A_k_cache, A_v_cache, A_wq, A_wo)
    b = _B_ref(B_x, B_k_cache, B_v_cache, B_wq, B_wo)
    return torch.concatenate([a, b], axis=-1)
```

```asm
; @launch grid=(256,1,1) block=(512,1,1) lds=156736
.amdgcn_target "amdgcn-amd-amdhsa--gfx950"
.text
.globl concat_heads__gqa_block_cached__mha_block_cached__near_ridge_kernel
.p2align 8
.type concat_heads__gqa_block_cached__mha_block_cached__near_ridge_kernel,@function
concat_heads__gqa_block_cached__mha_block_cached__near_ridge_kernel:
    s_cmp_ge_u32 s2, 256
    s_cbranch_scc1 L_end
    s_load_dwordx16 s[4:19], s[0:1], 0
    s_load_dwordx8 s[20:27], s[0:1], 64
    s_load_dwordx2 s[28:29], s[0:1], 96
    s_getpc_b64 s[30:31]
L_pc:
    v_lshlrev_b32 v2, 3, v0
    v_mov_b32 v3, s31
    v_add_co_u32 v4, vcc, s30, v2
    s_lshr_b32 s3, s2, 4
    s_add_u32 s3, s3, 1
    v_addc_co_u32 v5, vcc, 0, v3, vcc
    s_mov_b32 exec_lo, 0x10001
    s_mov_b32 exec_hi, exec_lo
    global_load_dword v8, v[4:5], off
    s_mov_b64 exec, -1
    v_lshl_add_u32 v2, s3, 12, v2
    v_min_u32 v2, L_last-L_pc-4, v2
    v_add_co_u32 v6, vcc, s30, v2
    s_bitcmp1_b32 s2, 3
    s_mov_b32 s3, 0x10001
    v_addc_co_u32 v7, vcc, 0, v3, vcc
    s_cselect_b32 exec_lo, 0, s3
    s_cselect_b32 exec_hi, s3, 0
    global_load_dword v9, v[6:7], off
    s_mov_b64 exec, -1
    v_lshrrev_b32 v1, 6, v0
    v_and_b32 v253, 63, v0
    v_readfirstlane_b32 s74, v1
    s_and_b32 s66, s2, 7
    s_lshr_b32 s67, s2, 3
    s_and_b32 s65, s74, 3
    s_lshr_b32 s64, s74, 2
    s_lshr_b32 s80, s65, 1
    s_mul_i32 s72, s65, 13056
    s_add_u32 s72, s72, 104448
    s_and_b32 s83, s66, 3
    s_lshl_b32 s83, s83, 20
    v_lshlrev_b32 v245, 4, v253
    v_bfe_u32 v254, v253, 3, 2
    v_lshlrev_b32 v246, 16, v254
    v_lshrrev_b32 v254, 5, v253
    v_lshl_add_u32 v246, v254, 15, v246
    v_and_b32 v254, 7, v253
    v_lshl_add_u32 v246, v254, 4, v246
    v_add_u32 v249, 21536, v246
    v_add_u32 v248, 14400, v246
    v_add_u32 v247, 7264, v246
    v_add_u32 v246, 128, v246
    v_lshrrev_b32 v254, 4, v253
    v_sub_u32 v255, 0, v254
    v_and_b32 v255, 3, v255
    v_xor_b32 v255, v255, v253
    v_and_b32 v255, 15, v255
    v_lshlrev_b32 v255, 4, v255
    v_lshl_add_u32 v255, v254, 12, v255
    s_waitcnt lgkmcnt(0)
    s_cmp_eq_u32 s64, 0
    s_cselect_b32 s40, s20, s10
    s_cselect_b32 s41, s21, s11
    s_lshl_b32 s74, s66, 2
    s_add_u32 s74, s74, s65
    s_lshl_b32 s74, s74, 8
    s_add_u32 s40, s40, s74
    s_addc_u32 s41, s41, 0
    s_sub_u32 s40, s40, 128
    s_subb_u32 s41, s41, 0
    s_sub_u32 s42, 4194432, s74
    s_mov_b32 s43, 0x20000
    s_cmp_eq_u32 s64, 0
    s_cbranch_scc1 L_first_B
    s_setprio 1
    s_lshl_b32 s74, s67, 16
    s_add_u32 s48, s14, s74
    s_addc_u32 s49, s15, 0
    s_mov_b32 s50, 0x10000
    s_mov_b32 s51, 0x20000
    s_lshl_b32 s71, s65, 14
    s_add_u32 s71, s71, 0
    s_lshr_b32 s74, s83, 12
    s_xor_b32 s71, s71, s74
    s_mul_i32 s74, s65, 4352
    s_add_u32 m0, s74, 34816
    s_nop 0
    buffer_load_dwordx4 v255, s[48:51], s71 offen offset:0  lds
    s_add_u32 m0, s74, 34880
    s_nop 0
    buffer_load_dwordx4 v255, s[48:51], s71 offen offset:1024  lds
    s_add_u32 m0, s74, 34944
    s_nop 0
    buffer_load_dwordx4 v255, s[48:51], s71 offen offset:2048  lds
    s_add_u32 m0, s74, 35008
    s_nop 0
    buffer_load_dwordx4 v255, s[48:51], s71 offen offset:3072  lds
    s_lshl_b32 s74, s66, 10
    s_add_u32 s60, s20, s74
    s_addc_u32 s61, s21, 0
    s_sub_u32 s62, 0x400000, s74
    s_mov_b32 s63, 0x20000
    s_lshl_b32 s74, s67, 2
    s_add_u32 s74, s74, s65
    s_lshl_b32 s74, s74, 15
    buffer_load_dwordx4 v[192:195], v245, s[60:63], s74 offen
    s_add_u32 s74, s74, 8192
    buffer_load_dwordx4 v[196:199], v245, s[60:63], s74 offen
    s_add_u32 s74, s74, 8192
    buffer_load_dwordx4 v[200:203], v245, s[60:63], s74 offen
    s_add_u32 s74, s74, 8192
    buffer_load_dwordx4 v[204:207], v245, s[60:63], s74 offen
    s_branch L_common
L_first_B:
    s_add_u32 m0, s72, 0
    s_xor_b32 s76, s83, 0
    buffer_load_dwordx4 v246, s[40:43], s76 offen offset:0 lds
    buffer_load_dwordx4 v247, s[40:43], s76 offen offset:1056 lds
    buffer_load_dwordx4 v248, s[40:43], s76 offen offset:2112 lds
    buffer_load_dwordx4 v249, s[40:43], s76 offen offset:3168 lds
    s_add_u32 m0, s72, 4352
    s_xor_b32 s76, s83, 128
    buffer_load_dwordx4 v246, s[40:43], s76 offen offset:0 lds
    buffer_load_dwordx4 v247, s[40:43], s76 offen offset:1056 lds
    buffer_load_dwordx4 v248, s[40:43], s76 offen offset:2112 lds
    buffer_load_dwordx4 v249, s[40:43], s76 offen offset:3168 lds
    s_add_u32 m0, s72, 8704
    s_xor_b32 s76, s83, 262144
    buffer_load_dwordx4 v246, s[40:43], s76 offen offset:0 lds
    buffer_load_dwordx4 v247, s[40:43], s76 offen offset:1056 lds
    buffer_load_dwordx4 v248, s[40:43], s76 offen offset:2112 lds
    buffer_load_dwordx4 v249, s[40:43], s76 offen offset:3168 lds
    s_lshl_b32 s74, s67, 16
    s_add_u32 s48, s4, s74
    s_addc_u32 s49, s5, 0
    s_mov_b32 s50, 0x10000
    s_mov_b32 s51, 0x20000
L_common:
    s_bitcmp0_b32 s67, 3
    s_mov_b32 s74, 0x86543322
    s_cselect_b32 s74, 0x11100000, s74
    s_mov_b32 s75, 0xffffffee
    s_cselect_b32 s75, 0xeddccbb9, s75
    s_bitcmp0_b32 s67, 4
    s_cselect_b32 s74, s74, s75
    s_and_b32 s75, s67, 7
    s_lshl_b32 s75, s75, 2
    s_lshr_b32 s74, s74, s75
    s_and_b32 s68, s74, 15
    s_lshl_b32 s74, s80, 1
    s_add_u32 s74, s74, s65
    s_mul_i32 s73, s74, 17408
    s_cmp_eq_u32 s80, 0
    s_cselect_b32 s81, 17, s68
    v_bfe_u32 v254, v253, 4, 1
    v_lshlrev_b32 v254, 4, v254
    v_xor_b32 v244, v245, v254
    v_and_b32 v224, 7, v253
    v_mul_u32_u24 v242, 1088, v224
    v_bfe_u32 v224, v253, 3, 1
    v_lshl_add_u32 v242, v224, 8, v242
    v_lshrrev_b32 v225, 5, v253
    v_xor_b32 v224, v224, v225
    v_lshl_add_u32 v242, v224, 4, v242
    v_bfe_u32 v224, v253, 4, 1
    v_lshl_add_u32 v242, v224, 5, v242
    v_bfe_u32 v224, v253, 2, 3
    v_mul_u32_u24 v243, 1056, v224
    v_lshl_add_u32 v243, v225, 8, v243
    v_and_b32 v224, 3, v253
    v_lshl_add_u32 v243, v224, 3, v243
    v_and_b32 v224, 3, v253
    v_bfe_u32 v225, v253, 2, 2
    v_mul_u32_u24 v250, 1056, v225
    v_lshl_add_u32 v250, v224, 3, v250
    v_lshrrev_b32 v226, 4, v253
    v_lshl_add_u32 v250, v226, 7, v250
    v_add_u32 v250, s72, v250
    v_mul_u32_u24 v251, 1088, v224
    v_lshl_add_u32 v251, v225, 8, v251
    v_sub_u32 v227, 0, v225
    v_and_b32 v227, 3, v227
    v_xor_b32 v227, v227, v226
    v_lshl_add_u32 v251, v227, 4, v251
    v_add_u32 v251, 34816, v251
    v_cmp_eq_u32 vcc, v224, v225
    v_mov_b32 v226, 0x3f803f80
    v_mov_b32 v236, 0
    v_mov_b32 v237, 0
    v_mov_b32 v238, 0
    v_mov_b32 v239, 0
    v_cndmask_b32 v240, 0, v226, vcc
    v_mov_b32 v241, v240
    s_lshl_b32 s74, s2, 2
    s_add_u32 s75, s74, s65
    s_and_b32 s70, s75, 15
    s_lshl_b32 s70, s70, 13
    s_lshl_b32 s74, s75, 17
    s_add_u32 s32, s16, s74
    s_addc_u32 s33, s17, 0
    s_mov_b32 s34, 0x20000
    s_mov_b32 s35, 0x20000
    s_add_u32 s36, s18, s74
    s_addc_u32 s37, s19, 0
    s_mov_b32 s38, 0x20000
    s_mov_b32 s39, 0x20000
    s_xor_b32 s74, s64, 1
    s_lshl_b32 s74, s74, 5
    s_add_u32 s74, s74, s67
    s_lshl_b32 s74, s74, 8
    s_and_b32 s75, s75, 31
    s_add_u32 s74, s74, s75
    s_lshl_b32 s74, s74, 11
    s_add_u32 s52, s28, s74
    s_addc_u32 s53, s29, 0
    s_mov_b32 s54, 0x70800
    s_mov_b32 s55, 0x20000
    s_lshl_b32 s74, s66, 19
    s_lshl_b32 s75, s65, 8
    s_add_u32 s74, s74, s75
    s_add_u32 s44, s12, s74
    s_addc_u32 s45, s13, 0
    s_sub_u32 s44, s44, 128
    s_subb_u32 s45, s45, 0
    s_sub_u32 s46, 4194432, s74
    s_mov_b32 s47, 0x20000
    s_bitcmp0_b32 s65, 0
    s_cselect_b32 s56, s6, s8
    s_cselect_b32 s57, s7, s9
    s_cselect_b32 s78, 64, 32
    s_cselect_b64 vcc, -1, 0
    s_cselect_b32 s79, 0, 8704
    v_cndmask_b32 v252, v245, v244, vcc
    s_lshl_b32 s74, s2, 17
    s_add_u32 s56, s56, s74
    s_addc_u32 s57, s57, 0
    s_mov_b32 s58, 0x20000
    s_mov_b32 s59, 0x20000
    s_and_b32 s77, s2, 15
    s_lshl_b32 s77, s77, 1
    s_add_u32 s77, s77, s80
    s_lshl_b32 s77, s77, 12
    s_add_u32 s74, s78, 1024
    s_mul_i32 s74, s74, s80
    s_lshl_b32 s74, s74, 2
    s_add_u32 s79, s79, s74
    s_cmp_eq_u32 s64, 0
    s_cbranch_scc1 L_Binit
    v_add_u32 v242, 34816, v242
    v_add_u32 v243, 43520, v243
    v_mov_b32 v224, 156672
    ds_write_b128 v224, v[236:239]
    s_waitcnt vmcnt(4) lgkmcnt(0)
    s_barrier
    s_or_b32 s74, s66, s65
    s_cmp_eq_u32 s74, 0
    s_cbranch_scc0 L_ni1
    s_mov_b64 exec, 1
    s_add_u32 s60, s28, 0x2000000
    s_addc_u32 s61, s29, 0
    s_mov_b32 s62, 0x8000
    s_mov_b32 s63, 0x20000
    s_mul_i32 s71, s67, 768
    s_add_u32 s71, s71, 0
    buffer_store_dword v236, off, s[60:63], s71 sc1
    buffer_store_dword v236, off, s[60:63], s71 offset:256 sc1
    s_mov_b64 exec, -1
L_ni1:
    s_lshl_b32 s71, s65, 14
    s_add_u32 s71, s71, 256
    s_lshr_b32 s74, s83, 12
    s_xor_b32 s71, s71, s74
    s_mul_i32 s74, s65, 4352
    s_add_u32 m0, s74, 52224
    s_nop 0
    buffer_load_dwordx4 v255, s[48:51], s71 offen offset:0  lds
    s_add_u32 m0, s74, 52288
    s_nop 0
    buffer_load_dwordx4 v255, s[48:51], s71 offen offset:1024  lds
    s_add_u32 m0, s74, 52352
    s_nop 0
    buffer_load_dwordx4 v255, s[48:51], s71 offen offset:2048  lds
    s_add_u32 m0, s74, 52416
    s_nop 0
    buffer_load_dwordx4 v255, s[48:51], s71 offen offset:3072  lds
    s_waitcnt vmcnt(0)
    s_barrier
    s_or_b32 s74, s66, s65
    s_cmp_eq_u32 s74, 0
    s_cbranch_scc0 L_ni2
    s_mov_b64 exec, 1
    s_waitcnt vmcnt(0)
    s_mov_b32 s60, s26
    s_mov_b32 s61, s27
    s_mov_b32 s62, 256
    s_mov_b32 s63, 0x20000
    s_lshl_b32 s71, s67, 3
    v_mov_b32 v254, 8
    buffer_store_dword v254, off, s[60:63], s71 sc1
    s_mov_b64 exec, -1
L_ni2:
    s_lshl_b32 s71, s65, 14
    s_add_u32 s71, s71, 512
    s_lshr_b32 s74, s83, 12
    s_xor_b32 s71, s71, s74
    s_mul_i32 s74, s65, 4352
    s_add_u32 m0, s74, 69632
    s_nop 0
    buffer_load_dwordx4 v255, s[48:51], s71 offen offset:0  lds
    s_add_u32 m0, s74, 69696
    s_nop 0
    buffer_load_dwordx4 v255, s[48:51], s71 offen offset:1024  lds
    s_add_u32 m0, s74, 69760
    s_nop 0
    buffer_load_dwordx4 v255, s[48:51], s71 offen offset:2048  lds
    s_add_u32 m0, s74, 69824
    s_nop 0
    buffer_load_dwordx4 v255, s[48:51], s71 offen offset:3072  lds
    s_lshl_b32 s71, s65, 14
    s_add_u32 s71, s71, 768
    s_lshr_b32 s74, s83, 12
    s_xor_b32 s71, s71, s74
    s_mul_i32 s74, s65, 4352
    s_add_u32 m0, s74, 87040
    s_nop 0
    buffer_load_dwordx4 v255, s[48:51], s71 offen offset:0  lds
    s_add_u32 m0, s74, 87104
    s_nop 0
    buffer_load_dwordx4 v255, s[48:51], s71 offen offset:1024  lds
    s_add_u32 m0, s74, 87168
    s_nop 0
    buffer_load_dwordx4 v255, s[48:51], s71 offen offset:2048  lds
    s_add_u32 m0, s74, 87232
    s_nop 0
    buffer_load_dwordx4 v255, s[48:51], s71 offen offset:3072  lds
    s_waitcnt vmcnt(0)
    s_barrier
    s_bitcmp1_b32 0x3f000, s67
    s_cbranch_scc1 L_sh3
    s_lshl_b32 s74, s66, 10
    s_add_u32 s60, s10, s74
    s_addc_u32 s61, s11, 0
    s_sub_u32 s62, 0x400000, s74
    s_mov_b32 s63, 0x20000
    s_lshl_b32 s74, s67, 2
    s_add_u32 s74, s74, s65
    s_lshl_b32 s74, s74, 15
    buffer_load_dwordx4 v[192:195], v245, s[60:63], s74 offen
    s_add_u32 s74, s74, 8192
    buffer_load_dwordx4 v[196:199], v245, s[60:63], s74 offen
    s_add_u32 s74, s74, 8192
    buffer_load_dwordx4 v[200:203], v245, s[60:63], s74 offen
    s_add_u32 s74, s74, 8192
    buffer_load_dwordx4 v[204:207], v245, s[60:63], s74 offen
    s_lshl_b32 s74, s67, 3
    s_add_u32 s74, s74, s66
    s_lshl_b32 s74, s74, 2
    s_add_u32 s74, s74, s65
    s_lshl_b32 s74, s74, 11
    s_add_u32 s60, s4, s74
    s_addc_u32 s61, s5, 0
    s_mov_b32 s62, 0x800
    s_mov_b32 s63, 0x20000
    buffer_load_dwordx4 v[208:211], v245, s[60:63], 0 offen offset:0
    buffer_load_dwordx4 v[212:215], v245, s[60:63], 0 offen offset:1024
    s_bitcmp1_b32 0xfc000000, s67
    s_cbranch_scc0 L_sh3
    s_bfm_b32 s82, s67, 0
    s_and_b32 s82, s82, 0xfc000000
    s_bcnt1_i32_b32 s82, s82
    s_mul_i32 s82, s82, 5
    s_mov_b32 s74, 0x2307b9ac
    s_mov_b32 s75, 0x0
    s_lshr_b64 s[74:75], s[74:75], s82
    s_and_b32 s82, s74, 31
    s_lshl_b32 s74, s66, 10
    s_add_u32 s60, s10, s74
    s_addc_u32 s61, s11, 0
    s_sub_u32 s62, 0x400000, s74
    s_mov_b32 s63, 0x20000
    s_lshl_b32 s74, s82, 2
    s_add_u32 s74, s74, s65
    s_lshl_b32 s74, s74, 15
    buffer_load_dwordx4 v[192:195], v245, s[60:63], s74 offen
    s_add_u32 s74, s74, 8192
    buffer_load_dwordx4 v[196:199], v245, s[60:63], s74 offen
    s_add_u32 s74, s74, 8192
    buffer_load_dwordx4 v[200:203], v245, s[60:63], s74 offen
    s_add_u32 s74, s74, 8192
    buffer_load_dwordx4 v[204:207], v245, s[60:63], s74 offen
    s_lshl_b32 s74, s82, 3
    s_add_u32 s74, s74, s66
    s_lshl_b32 s74, s74, 2
    s_add_u32 s74, s74, s65
    s_lshl_b32 s74, s74, 11
    s_add_u32 s60, s4, s74
    s_addc_u32 s61, s5, 0
    s_mov_b32 s62, 0x800
    s_mov_b32 s63, 0x20000
    buffer_load_dwordx4 v[208:211], v245, s[60:63], 0 offen offset:0
    buffer_load_dwordx4 v[212:215], v245, s[60:63], 0 offen offset:1024
L_sh3:
    s_barrier
    s_bitcmp1_b32 0xfc00, s67
    s_cbranch_scc1 L_sh4
    s_lshl_b32 s74, s66, 19
    s_add_u32 s60, s12, s74
    s_addc_u32 s61, s13, 0
    s_sub_u32 s62, 0x400000, s74
    s_mov_b32 s63, 0x20000
    s_lshl_b32 s74, s67, 2
    s_add_u32 s74, s74, s65
    s_lshl_b32 s74, s74, 12
    buffer_load_dwordx4 v[192:195], v245, s[60:63], s74 offen
    s_add_u32 s74, s74, 1024
    buffer_load_dwordx4 v[196:199], v245, s[60:63], s74 offen
    s_add_u32 s74, s74, 1024
    buffer_load_dwordx4 v[200:203], v245, s[60:63], s74 offen
    s_add_u32 s74, s74, 1024
    buffer_load_dwordx4 v[204:207], v245, s[60:63], s74 offen
    s_lshl_b32 s74, s66, 19
    s_add_u32 s60, s22, s74
    s_addc_u32 s61, s23, 0
    s_sub_u32 s62, 0x400000, s74
    s_mov_b32 s63, 0x20000
    s_lshl_b32 s74, s67, 2
    s_add_u32 s74, s74, s65
    s_lshl_b32 s74, s74, 12
    buffer_load_dwordx4 v[192:195], v245, s[60:63], s74 offen
    s_add_u32 s74, s74, 1024
    buffer_load_dwordx4 v[196:199], v245, s[60:63], s74 offen
    s_add_u32 s74, s74, 1024
    buffer_load_dwordx4 v[200:203], v245, s[60:63], s74 offen
    s_add_u32 s74, s74, 1024
    buffer_load_dwordx4 v[204:207], v245, s[60:63], s74 offen
    s_bitcmp1_b32 0xfc000000, s67
    s_cbranch_scc0 L_sh4
    s_bfm_b32 s82, s67, 0
    s_and_b32 s82, s82, 0xfc000000
    s_bcnt1_i32_b32 s82, s82
    s_mul_i32 s82, s82, 5
    s_mov_b32 s74, 0x1ee6b16a
    s_mov_b32 s75, 0x0
    s_lshr_b64 s[74:75], s[74:75], s82
    s_and_b32 s82, s74, 31
    s_lshl_b32 s74, s66, 19
    s_add_u32 s60, s12, s74
    s_addc_u32 s61, s13, 0
    s_sub_u32 s62, 0x400000, s74
    s_mov_b32 s63, 0x20000
    s_lshl_b32 s74, s82, 2
    s_add_u32 s74, s74, s65
    s_lshl_b32 s74, s74, 12
    buffer_load_dwordx4 v[192:195], v245, s[60:63], s74 offen
    s_add_u32 s74, s74, 1024
    buffer_load_dwordx4 v[196:199], v245, s[60:63], s74 offen
    s_add_u32 s74, s74, 1024
    buffer_load_dwordx4 v[200:203], v245, s[60:63], s74 offen
    s_add_u32 s74, s74, 1024
    buffer_load_dwordx4 v[204:207], v245, s[60:63], s74 offen
    s_lshl_b32 s74, s66, 19
    s_add_u32 s60, s22, s74
    s_addc_u32 s61, s23, 0
    s_sub_u32 s62, 0x400000, s74
    s_mov_b32 s63, 0x20000
    s_lshl_b32 s74, s82, 2
    s_add_u32 s74, s74, s65
    s_lshl_b32 s74, s74, 12
    buffer_load_dwordx4 v[192:195], v245, s[60:63], s74 offen
    s_add_u32 s74, s74, 1024
    buffer_load_dwordx4 v[196:199], v245, s[60:63], s74 offen
    s_add_u32 s74, s74, 1024
    buffer_load_dwordx4 v[200:203], v245, s[60:63], s74 offen
    s_add_u32 s74, s74, 1024
    buffer_load_dwordx4 v[204:207], v245, s[60:63], s74 offen
L_sh4:
    s_barrier
    s_lshl_b32 s74, s67, 16
    s_add_u32 s48, s4, s74
    s_addc_u32 s49, s5, 0
    s_mov_b32 s50, 0x10000
    s_mov_b32 s51, 0x20000
    s_cmp_eq_u32 s81, 0
    s_cbranch_scc0 L_hv
    s_lshl_b32 s71, s65, 8
    s_add_u32 s71, s71, 0
    s_lshr_b32 s74, s83, 12
    s_xor_b32 s71, s71, s74
    s_add_u32 m0, s73, 0
    s_nop 0
    buffer_load_dwordx4 v255, s[48:51], s71 offen offset:0 nt lds
    s_add_u32 m0, s73, 64
    s_nop 0
    buffer_load_dwordx4 v255, s[48:51], s71 offen offset:1024 nt lds
    s_add_u32 m0, s73, 128
    s_nop 0
    buffer_load_dwordx4 v255, s[48:51], s71 offen offset:2048 nt lds
    s_add_u32 m0, s73, 192
    s_nop 0
    buffer_load_dwordx4 v255, s[48:51], s71 offen offset:3072 nt lds
    s_add_u32 s71, s71, 16384
    s_add_u32 m0, s73, 4352
    s_nop 0
    buffer_load_dwordx4 v255, s[48:51], s71 offen offset:0 nt lds
    s_add_u32 m0, s73, 4416
    s_nop 0
    buffer_load_dwordx4 v255, s[48:51], s71 offen offset:1024 nt lds
    s_add_u32 m0, s73, 4480
    s_nop 0
    buffer_load_dwordx4 v255, s[48:51], s71 offen offset:2048 nt lds
    s_add_u32 m0, s73, 4544
    s_nop 0
    buffer_load_dwordx4 v255, s[48:51], s71 offen offset:3072 nt lds
    s_lshl_b32 s71, s65, 8
    s_add_u32 s71, s71, 32768
    s_lshr_b32 s74, s83, 12
    s_xor_b32 s71, s71, s74
    s_add_u32 m0, s73, 8704
    s_nop 0
    buffer_load_dwordx4 v255, s[48:51], s71 offen offset:0 nt lds
    s_add_u32 m0, s73, 8768
    s_nop 0
    buffer_load_dwordx4 v255, s[48:51], s71 offen offset:1024 nt lds
    s_add_u32 m0, s73, 8832
    s_nop 0
    buffer_load_dwordx4 v255, s[48:51], s71 offen offset:2048 nt lds
    s_add_u32 m0, s73, 8896
    s_nop 0
    buffer_load_dwordx4 v255, s[48:51], s71 offen offset:3072 nt lds
    s_add_u32 s71, s71, 16384
    s_add_u32 m0, s73, 13056
    s_nop 0
    buffer_load_dwordx4 v255, s[48:51], s71 offen offset:0 nt lds
    s_add_u32 m0, s73, 13120
    s_nop 0
    buffer_load_dwordx4 v255, s[48:51], s71 offen offset:1024 nt lds
    s_add_u32 m0, s73, 13184
    s_nop 0
    buffer_load_dwordx4 v255, s[48:51], s71 offen offset:2048 nt lds
    s_add_u32 m0, s73, 13248
    s_nop 0
    buffer_load_dwordx4 v255, s[48:51], s71 offen offset:3072 nt lds
    s_branch L_hx
L_hv:
    s_add_u32 s71, s70, 4096
    s_add_u32 m0, s73, 0
    s_nop 0
    buffer_load_dwordx4 v244, s[32:35], s70 offen offset:0 nt lds
    s_add_u32 m0, s73, 4352
    s_nop 0
    buffer_load_dwordx4 v244, s[32:35], s71 offen offset:0 nt lds
    s_add_u32 m0, s73, 128
    s_nop 0
    buffer_load_dwordx4 v244, s[32:35], s70 offen offset:2048 nt lds
    s_add_u32 m0, s73, 4480
    s_nop 0
    buffer_load_dwordx4 v244, s[32:35], s71 offen offset:2048 nt lds
    s_add_u32 m0, s73, 64
    s_nop 0
    buffer_load_dwordx4 v244, s[32:35], s70 offen offset:1024 nt lds
    s_add_u32 m0, s73, 4416
    s_nop 0
    buffer_load_dwordx4 v244, s[32:35], s71 offen offset:1024 nt lds
    s_add_u32 m0, s73, 192
    s_nop 0
    buffer_load_dwordx4 v244, s[32:35], s70 offen offset:3072 nt lds
    s_add_u32 m0, s73, 4544
    s_nop 0
    buffer_load_dwordx4 v244, s[32:35], s71 offen offset:3072 nt lds
    s_add_u32 s71, s70, 4096
    s_add_u32 m0, s73, 8704
    s_nop 0
    buffer_load_dwordx4 v245, s[36:39], s70 offen offset:0 nt lds
    s_add_u32 m0, s73, 12928
    s_nop 0
    buffer_load_dwordx4 v245, s[36:39], s71 offen offset:0 nt lds
    s_add_u32 m0, s73, 8768
    s_nop 0
    buffer_load_dwordx4 v245, s[36:39], s70 offen offset:2048 nt lds
    s_add_u32 m0, s73, 12992
    s_nop 0
    buffer_load_dwordx4 v245, s[36:39], s71 offen offset:2048 nt lds
    s_add_u32 m0, s73, 8736
    s_nop 0
    buffer_load_dwordx4 v245, s[36:39], s70 offen offset:1024 nt lds
    s_add_u32 m0, s73, 12960
    s_nop 0
    buffer_load_dwordx4 v245, s[36:39], s71 offen offset:1024 nt lds
    s_add_u32 m0, s73, 8800
    s_nop 0
    buffer_load_dwordx4 v245, s[36:39], s70 offen offset:3072 nt lds
    s_add_u32 m0, s73, 13024
    s_nop 0
    buffer_load_dwordx4 v245, s[36:39], s71 offen offset:3072 nt lds
L_hx:
    s_lshl_b32 s71, s65, 14
    s_add_u32 s71, s71, 0
    s_lshr_b32 s74, s83, 12
    s_xor_b32 s71, s71, s74
    s_mul_i32 s74, s65, 4352
    s_add_u32 m0, s74, 34816
    s_nop 0
    buffer_load_dwordx4 v255, s[48:51], s71 offen offset:0 nt lds
    s_add_u32 m0, s74, 34880
    s_nop 0
    buffer_load_dwordx4 v255, s[48:51], s71 offen offset:1024 nt lds
    s_add_u32 m0, s74, 34944
    s_nop 0
    buffer_load_dwordx4 v255, s[48:51], s71 offen offset:2048 nt lds
    s_add_u32 m0, s74, 35008
    s_nop 0
    buffer_load_dwordx4 v255, s[48:51], s71 offen offset:3072 nt lds
    s_waitcnt vmcnt(4)
    s_barrier
    s_lshl_b32 s71, s65, 14
    s_add_u32 s71, s71, 256
    s_lshr_b32 s74, s83, 12
    s_xor_b32 s71, s71, s74
    s_mul_i32 s74, s65, 4352
    s_add_u32 m0, s74, 52224
    s_nop 0
    buffer_load_dwordx4 v255, s[48:51], s71 offen offset:0 nt lds
    s_add_u32 m0, s74, 52288
    s_nop 0
    buffer_load_dwordx4 v255, s[48:51], s71 offen offset:1024 nt lds
    s_add_u32 m0, s74, 52352
    s_nop 0
    buffer_load_dwordx4 v255, s[48:51], s71 offen offset:2048 nt lds
    s_add_u32 m0, s74, 52416
    s_nop 0
    buffer_load_dwordx4 v255, s[48:51], s71 offen offset:3072 nt lds
    s_lshl_b32 s74, s2, 17
    s_add_u32 s32, s6, s74
    s_addc_u32 s33, s7, 0
    s_mov_b32 s34, 0x20000
    s_mov_b32 s35, 0x20000
    s_add_u32 s36, s8, s74
    s_addc_u32 s37, s9, 0
    s_mov_b32 s38, 0x20000
    s_mov_b32 s39, 0x20000
    s_add_u32 m0, s72, 0
    s_xor_b32 s76, s83, 0
    buffer_load_dwordx4 v246, s[40:43], s76 offen offset:0 lds
    buffer_load_dwordx4 v247, s[40:43], s76 offen offset:1056 lds
    buffer_load_dwordx4 v248, s[40:43], s76 offen offset:2112 lds
    buffer_load_dwordx4 v249, s[40:43], s76 offen offset:3168 lds
    s_add_u32 m0, s72, 4352
    s_xor_b32 s76, s83, 128
    buffer_load_dwordx4 v246, s[40:43], s76 offen offset:0 lds
    buffer_load_dwordx4 v247, s[40:43], s76 offen offset:1056 lds
    buffer_load_dwordx4 v248, s[40:43], s76 offen offset:2112 lds
    buffer_load_dwordx4 v249, s[40:43], s76 offen offset:3168 lds
    s_add_u32 m0, s72, 8704
    s_xor_b32 s76, s83, 262144
    buffer_load_dwordx4 v246, s[40:43], s76 offen offset:0 lds
    buffer_load_dwordx4 v247, s[40:43], s76 offen offset:1056 lds
    buffer_load_dwordx4 v248, s[40:43], s76 offen offset:2112 lds
    buffer_load_dwordx4 v249, s[40:43], s76 offen offset:3168 lds
    s_waitcnt vmcnt(12)
    s_lshl_b32 s74, s66, 19
    s_lshl_b32 s75, s65, 8
    s_add_u32 s74, s74, s75
    s_add_u32 s60, s22, s74
    s_addc_u32 s61, s23, 0
    s_sub_u32 s60, s60, 128
    s_subb_u32 s61, s61, 0
    s_sub_u32 s62, 4194432, s74
    s_mov_b32 s63, 0x20000
    s_branch L_Qstart
L_Binit:
    s_lshl_b32 s74, s66, 2
    s_add_u32 s74, s74, s65
    s_lshl_b32 s74, s74, 8
    s_add_u32 s60, s10, s74
    s_addc_u32 s61, s11, 0
    s_sub_u32 s60, s60, 128
    s_subb_u32 s61, s61, 0
    s_sub_u32 s62, 4194432, s74
    s_mov_b32 s63, 0x20000
    v_add_u32 v242, s73, v242
    v_add_u32 v243, s73, v243
    v_add_u32 v243, 8704, v243
L_Qstart:
    s_barrier
    s_waitcnt vmcnt(8)
    ds_read_b128 v[160:163], v251 offset:0
    ds_read_b128 v[164:167], v251 offset:4352
    ds_read_b128 v[168:171], v251 offset:8704
    ds_read_b128 v[172:175], v251 offset:13056
    ds_read_b64_tr_b16 v[128:129], v250 offset:0
    ds_read_b64_tr_b16 v[130:131], v250 offset:512
    ds_read_b64_tr_b16 v[132:133], v250 offset:32
    ds_read_b64_tr_b16 v[134:135], v250 offset:544
    ds_read_b64_tr_b16 v[136:137], v250 offset:64
    ds_read_b64_tr_b16 v[138:139], v250 offset:576
    ds_read_b64_tr_b16 v[140:141], v250 offset:96
    ds_read_b64_tr_b16 v[142:143], v250 offset:608
    s_waitcnt lgkmcnt(0)
    v_mfma_f32_16x16x32_bf16 v[0:3], v[128:131], v[160:163], 0
    s_add_u32 m0, s72, 0
    s_xor_b32 s76, s83, 262272
    v_mfma_f32_16x16x32_bf16 v[8:11], v[128:131], v[164:167], 0
    ds_read_b128 v[176:179], v251 offset:64
    ds_read_b128 v[180:183], v251 offset:4416
    v_mfma_f32_16x16x32_bf16 v[16:19], v[128:131], v[168:171], 0
    buffer_load_dwordx4 v246, s[40:43], s76 offen offset:0 lds
    v_mfma_f32_16x16x32_bf16 v[24:27], v[128:131], v[172:175], 0
    v_mfma_f32_16x16x32_bf16 v[28:31], v[132:135], v[172:175], 0
    buffer_load_dwordx4 v247, s[40:43], s76 offen offset:1056 lds
    s_waitcnt vmcnt(6)
    v_mfma_f32_16x16x32_bf16 v[20:23], v[132:135], v[168:171], 0
    ds_read_b64_tr_b16 v[144:145], v250 offset:4352
    ds_read_b64_tr_b16 v[146:147], v250 offset:4864
    v_mfma_f32_16x16x32_bf16 v[12:15], v[132:135], v[164:167], 0
    buffer_load_dwordx4 v248, s[40:43], s76 offen offset:2112 lds
    v_mfma_f32_16x16x32_bf16 v[4:7], v[132:135], v[160:163], 0
    ds_read_b64_tr_b16 v[148:149], v250 offset:4384
    ds_read_b64_tr_b16 v[150:151], v250 offset:4896
    v_mfma_f32_16x16x32_bf16 v[32:35], v[136:139], v[160:163], 0
    buffer_load_dwordx4 v249, s[40:43], s76 offen offset:3168 lds
    v_mfma_f32_16x16x32_bf16 v[40:43], v[136:139], v[164:167], 0
    ds_read_b64_tr_b16 v[152:153], v250 offset:4416
    ds_read_b64_tr_b16 v[154:155], v250 offset:4928
    v_mfma_f32_16x16x32_bf16 v[48:51], v[136:139], v[168:171], 0
    ds_read_b64_tr_b16 v[156:157], v250 offset:4448
    ds_read_b64_tr_b16 v[158:159], v250 offset:4960
    v_mfma_f32_16x16x32_bf16 v[56:59], v[136:139], v[172:175], 0
    v_mfma_f32_16x16x32_bf16 v[60:63], v[140:143], v[172:175], 0
    v_mfma_f32_16x16x32_bf16 v[52:55], v[140:143], v[168:171], 0
    v_mfma_f32_16x16x32_bf16 v[44:47], v[140:143], v[164:167], 0
    v_mfma_f32_16x16x32_bf16 v[36:39], v[140:143], v[160:163], 0
    s_waitcnt lgkmcnt(0)
    v_mfma_f32_16x16x32_bf16 v[64:67], v[144:147], v[160:163], 0
    s_add_u32 m0, s72, 4352
    s_xor_b32 s76, s83, 524288
    v_mfma_f32_16x16x32_bf16 v[72:75], v[144:147], v[164:167], 0
    ds_read_b128 v[184:187], v251 offset:8768
    ds_read_b128 v[188:191], v251 offset:13120
    v_mfma_f32_16x16x32_bf16 v[80:83], v[144:147], v[168:171], 0
    buffer_load_dwordx4 v246, s[40:43], s76 offen offset:0 lds
    v_mfma_f32_16x16x32_bf16 v[88:91], v[144:147], v[172:175], 0
    v_mfma_f32_16x16x32_bf16 v[92:95], v[148:151], v[172:175], 0
    buffer_load_dwordx4 v247, s[40:43], s76 offen offset:1056 lds
    s_waitcnt vmcnt(6)
    v_mfma_f32_16x16x32_bf16 v[84:87], v[148:151], v[168:171], 0
    ds_read_b64_tr_b16 v[128:129], v250 offset:8704
    ds_read_b64_tr_b16 v[130:131], v250 offset:9216
    v_mfma_f32_16x16x32_bf16 v[76:79], v[148:151], v[164:167], 0
    buffer_load_dwordx4 v248, s[40:43], s76 offen offset:2112 lds
    v_mfma_f32_16x16x32_bf16 v[68:71], v[148:151], v[160:163], 0
    ds_read_b64_tr_b16 v[132:133], v250 offset:8736
    ds_read_b64_tr_b16 v[134:135], v250 offset:9248
    v_mfma_f32_16x16x32_bf16 v[96:99], v[152:155], v[160:163], 0
    buffer_load_dwordx4 v249, s[40:43], s76 offen offset:3168 lds
    v_mfma_f32_16x16x32_bf16 v[104:107], v[152:155], v[164:167], 0
    ds_read_b64_tr_b16 v[136:137], v250 offset:8768
    ds_read_b64_tr_b16 v[138:139], v250 offset:9280
    v_mfma_f32_16x16x32_bf16 v[112:115], v[152:155], v[168:171], 0
    ds_read_b64_tr_b16 v[140:141], v250 offset:8800
    ds_read_b64_tr_b16 v[142:143], v250 offset:9312
    v_mfma_f32_16x16x32_bf16 v[120:123], v[152:155], v[172:175], 0
    v_mfma_f32_16x16x32_bf16 v[124:127], v[156:159], v[172:175], 0
    v_mfma_f32_16x16x32_bf16 v[116:119], v[156:159], v[168:171], 0
    v_mfma_f32_16x16x32_bf16 v[108:111], v[156:159], v[164:167], 0
    v_mfma_f32_16x16x32_bf16 v[100:103], v[156:159], v[160:163], 0
    s_waitcnt lgkmcnt(0)
    v_mfma_f32_16x16x32_bf16 v[0:3], v[128:131], v[176:179], v[0:3]
    s_add_u32 m0, s72, 8704
    s_xor_b32 s76, s83, 524416
    v_mfma_f32_16x16x32_bf16 v[8:11], v[128:131], v[180:183], v[8:11]
    ds_read_b128 v[160:163], v251 offset:128
    ds_read_b128 v[164:167], v251 offset:4480
    v_mfma_f32_16x16x32_bf16 v[16:19], v[128:131], v[184:187], v[16:19]
    buffer_load_dwordx4 v246, s[40:43], s76 offen offset:0 lds
    v_mfma_f32_16x16x32_bf16 v[24:27], v[128:131], v[188:191], v[24:27]
    v_mfma_f32_16x16x32_bf16 v[28:31], v[132:135], v[188:191], v[28:31]
    buffer_load_dwordx4 v247, s[40:43], s76 offen offset:1056 lds
    s_waitcnt vmcnt(6)
    v_mfma_f32_16x16x32_bf16 v[20:23], v[132:135], v[184:187], v[20:23]
    ds_read_b64_tr_b16 v[144:145], v250 offset:0
    ds_read_b64_tr_b16 v[146:147], v250 offset:512
    v_mfma_f32_16x16x32_bf16 v[12:15], v[132:135], v[180:183], v[12:15]
    buffer_load_dwordx4 v248, s[40:43], s76 offen offset:2112 lds
    v_mfma_f32_16x16x32_bf16 v[4:7], v[132:135], v[176:179], v[4:7]
    ds_read_b64_tr_b16 v[148:149], v250 offset:32
    ds_read_b64_tr_b16 v[150:151], v250 offset:544
    v_mfma_f32_16x16x32_bf16 v[32:35], v[136:139], v[176:179], v[32:35]
    buffer_load_dwordx4 v249, s[40:43], s76 offen offset:3168 lds
    v_mfma_f32_16x16x32_bf16 v[40:43], v[136:139], v[180:183], v[40:43]
    ds_read_b64_tr_b16 v[152:153], v250 offset:64
    ds_read_b64_tr_b16 v[154:155], v250 offset:576
    v_mfma_f32_16x16x32_bf16 v[48:51], v[136:139], v[184:187], v[48:51]
    ds_read_b64_tr_b16 v[156:157], v250 offset:96
    ds_read_b64_tr_b16 v[158:159], v250 offset:608
    v_mfma_f32_16x16x32_bf16 v[56:59], v[136:139], v[188:191], v[56:59]
    v_mfma_f32_16x16x32_bf16 v[60:63], v[140:143], v[188:191], v[60:63]
    v_mfma_f32_16x16x32_bf16 v[52:55], v[140:143], v[184:187], v[52:55]
    v_mfma_f32_16x16x32_bf16 v[44:47], v[140:143], v[180:183], v[44:47]
    v_mfma_f32_16x16x32_bf16 v[36:39], v[140:143], v[176:179], v[36:39]
    s_waitcnt lgkmcnt(0)
    v_mfma_f32_16x16x32_bf16 v[64:67], v[144:147], v[176:179], v[64:67]
    s_add_u32 m0, s72, 0
    s_xor_b32 s76, s83, 786432
    v_mfma_f32_16x16x32_bf16 v[72:75], v[144:147], v[180:183], v[72:75]
    ds_read_b128 v[168:171], v251 offset:8832
    ds_read_b128 v[172:175], v251 offset:13184
    v_mfma_f32_16x16x32_bf16 v[80:83], v[144:147], v[184:187], v[80:83]
    buffer_load_dwordx4 v246, s[40:43], s76 offen offset:0 lds
    v_mfma_f32_16x16x32_bf16 v[88:91], v[144:147], v[188:191], v[88:91]
    v_mfma_f32_16x16x32_bf16 v[92:95], v[148:151], v[188:191], v[92:95]
    buffer_load_dwordx4 v247, s[40:43], s76 offen offset:1056 lds
    s_waitcnt vmcnt(6)
    v_mfma_f32_16x16x32_bf16 v[84:87], v[148:151], v[184:187], v[84:87]
    ds_read_b64_tr_b16 v[128:129], v250 offset:4352
    ds_read_b64_tr_b16 v[130:131], v250 offset:4864
    v_mfma_f32_16x16x32_bf16 v[76:79], v[148:151], v[180:183], v[76:79]
    buffer_load_dwordx4 v248, s[40:43], s76 offen offset:2112 lds
    v_mfma_f32_16x16x32_bf16 v[68:71], v[148:151], v[176:179], v[68:71]
    ds_read_b64_tr_b16 v[132:133], v250 offset:4384
    ds_read_b64_tr_b16 v[134:135], v250 offset:4896
    v_mfma_f32_16x16x32_bf16 v[96:99], v[152:155], v[176:179], v[96:99]
    buffer_load_dwordx4 v249, s[40:43], s76 offen offset:3168 lds
    v_mfma_f32_16x16x32_bf16 v[104:107], v[152:155], v[180:183], v[104:107]
    ds_read_b64_tr_b16 v[136:137], v250 offset:4416
    ds_read_b64_tr_b16 v[138:139], v250 offset:4928
    v_mfma_f32_16x16x32_bf16 v[112:115], v[152:155], v[184:187], v[112:115]
    ds_read_b64_tr_b16 v[140:141], v250 offset:4448
    ds_read_b64_tr_b16 v[142:143], v250 offset:4960
    v_mfma_f32_16x16x32_bf16 v[120:123], v[152:155], v[188:191], v[120:123]
    v_mfma_f32_16x16x32_bf16 v[124:127], v[156:159], v[188:191], v[124:127]
    v_mfma_f32_16x16x32_bf16 v[116:119], v[156:159], v[184:187], v[116:119]
    v_mfma_f32_16x16x32_bf16 v[108:111], v[156:159], v[180:183], v[108:111]
    v_mfma_f32_16x16x32_bf16 v[100:103], v[156:159], v[176:179], v[100:103]
    s_waitcnt lgkmcnt(0)
    v_mfma_f32_16x16x32_bf16 v[0:3], v[128:131], v[160:163], v[0:3]
    s_add_u32 m0, s72, 4352
    s_xor_b32 s76, s83, 786560
    v_mfma_f32_16x16x32_bf16 v[8:11], v[128:131], v[164:167], v[8:11]
    ds_read_b128 v[176:179], v251 offset:192
    ds_read_b128 v[180:183], v251 offset:4544
    v_mfma_f32_16x16x32_bf16 v[16:19], v[128:131], v[168:171], v[16:19]
    buffer_load_dwordx4 v246, s[40:43], s76 offen offset:0 lds
    v_mfma_f32_16x16x32_bf16 v[24:27], v[128:131], v[172:175], v[24:27]
    v_mfma_f32_16x16x32_bf16 v[28:31], v[132:135], v[172:175], v[28:31]
    buffer_load_dwordx4 v247, s[40:43], s76 offen offset:1056 lds
    s_waitcnt vmcnt(6)
    v_mfma_f32_16x16x32_bf16 v[20:23], v[132:135], v[168:171], v[20:23]
    ds_read_b64_tr_b16 v[144:145], v250 offset:8704
    ds_read_b64_tr_b16 v[146:147], v250 offset:9216
    v_mfma_f32_16x16x32_bf16 v[12:15], v[132:135], v[164:167], v[12:15]
    buffer_load_dwordx4 v248, s[40:43], s76 offen offset:2112 lds
    v_mfma_f32_16x16x32_bf16 v[4:7], v[132:135], v[160:163], v[4:7]
    ds_read_b64_tr_b16 v[148:149], v250 offset:8736
    ds_read_b64_tr_b16 v[150:151], v250 offset:9248
    v_mfma_f32_16x16x32_bf16 v[32:35], v[136:139], v[160:163], v[32:35]
    buffer_load_dwordx4 v249, s[40:43], s76 offen offset:3168 lds
    v_mfma_f32_16x16x32_bf16 v[40:43], v[136:139], v[164:167], v[40:43]
    ds_read_b64_tr_b16 v[152:153], v250 offset:8768
    ds_read_b64_tr_b16 v[154:155], v250 offset:9280
    v_mfma_f32_16x16x32_bf16 v[48:51], v[136:139], v[168:171], v[48:51]
    ds_read_b64_tr_b16 v[156:157], v250 offset:8800
    ds_read_b64_tr_b16 v[158:159], v250 offset:9312
    v_mfma_f32_16x16x32_bf16 v[56:59], v[136:139], v[172:175], v[56:59]
    v_mfma_f32_16x16x32_bf16 v[60:63], v[140:143], v[172:175], v[60:63]
    v_mfma_f32_16x16x32_bf16 v[52:55], v[140:143], v[168:171], v[52:55]
    v_mfma_f32_16x16x32_bf16 v[44:47], v[140:143], v[164:167], v[44:47]
    v_mfma_f32_16x16x32_bf16 v[36:39], v[140:143], v[160:163], v[36:39]
    s_waitcnt lgkmcnt(0)
    v_mfma_f32_16x16x32_bf16 v[64:67], v[144:147], v[160:163], v[64:67]
    s_add_u32 m0, s72, 8704
    s_xor_b32 s76, s83, 1048576
    v_mfma_f32_16x16x32_bf16 v[72:75], v[144:147], v[164:167], v[72:75]
    ds_read_b128 v[184:187], v251 offset:8896
    ds_read_b128 v[188:191], v251 offset:13248
    v_mfma_f32_16x16x32_bf16 v[80:83], v[144:147], v[168:171], v[80:83]
    buffer_load_dwordx4 v246, s[40:43], s76 offen offset:0 lds
    v_mfma_f32_16x16x32_bf16 v[88:91], v[144:147], v[172:175], v[88:91]
    v_mfma_f32_16x16x32_bf16 v[92:95], v[148:151], v[172:175], v[92:95]
    buffer_load_dwordx4 v247, s[40:43], s76 offen offset:1056 lds
    s_waitcnt vmcnt(6)
    v_mfma_f32_16x16x32_bf16 v[84:87], v[148:151], v[168:171], v[84:87]
    ds_read_b64_tr_b16 v[128:129], v250 offset:0
    ds_read_b64_tr_b16 v[130:131], v250 offset:512
    v_mfma_f32_16x16x32_bf16 v[76:79], v[148:151], v[164:167], v[76:79]
    buffer_load_dwordx4 v248, s[40:43], s76 offen offset:2112 lds
    v_mfma_f32_16x16x32_bf16 v[68:71], v[148:151], v[160:163], v[68:71]
    ds_read_b64_tr_b16 v[132:133], v250 offset:32
    ds_read_b64_tr_b16 v[134:135], v250 offset:544
    v_mfma_f32_16x16x32_bf16 v[96:99], v[152:155], v[160:163], v[96:99]
    buffer_load_dwordx4 v249, s[40:43], s76 offen offset:3168 lds
    v_mfma_f32_16x16x32_bf16 v[104:107], v[152:155], v[164:167], v[104:107]
    ds_read_b64_tr_b16 v[136:137], v250 offset:64
    ds_read_b64_tr_b16 v[138:139], v250 offset:576
    v_mfma_f32_16x16x32_bf16 v[112:115], v[152:155], v[168:171], v[112:115]
    ds_read_b64_tr_b16 v[140:141], v250 offset:96
    ds_read_b64_tr_b16 v[142:143], v250 offset:608
    v_mfma_f32_16x16x32_bf16 v[120:123], v[152:155], v[172:175], v[120:123]
    v_mfma_f32_16x16x32_bf16 v[124:127], v[156:159], v[172:175], v[124:127]
    v_mfma_f32_16x16x32_bf16 v[116:119], v[156:159], v[168:171], v[116:119]
    v_mfma_f32_16x16x32_bf16 v[108:111], v[156:159], v[164:167], v[108:111]
    v_mfma_f32_16x16x32_bf16 v[100:103], v[156:159], v[160:163], v[100:103]
    s_waitcnt lgkmcnt(0)
    s_barrier
    v_mfma_f32_16x16x32_bf16 v[0:3], v[128:131], v[176:179], v[0:3]
    s_add_u32 m0, s72, 0
    s_xor_b32 s76, s83, 1048704
    v_mfma_f32_16x16x32_bf16 v[8:11], v[128:131], v[180:183], v[8:11]
    ds_read_b128 v[160:163], v251 offset:17408
    ds_read_b128 v[164:167], v251 offset:21760
    v_mfma_f32_16x16x32_bf16 v[16:19], v[128:131], v[184:187], v[16:19]
    buffer_load_dwordx4 v246, s[40:43], s76 offen offset:0 lds
    v_mfma_f32_16x16x32_bf16 v[24:27], v[128:131], v[188:191], v[24:27]
    v_mfma_f32_16x16x32_bf16 v[28:31], v[132:135], v[188:191], v[28:31]
    buffer_load_dwordx4 v247, s[40:43], s76 offen offset:1056 lds
    s_waitcnt vmcnt(6)
    v_mfma_f32_16x16x32_bf16 v[20:23], v[132:135], v[184:187], v[20:23]
    ds_read_b64_tr_b16 v[144:145], v250 offset:4352
    ds_read_b64_tr_b16 v[146:147], v250 offset:4864
    v_mfma_f32_16x16x32_bf16 v[12:15], v[132:135], v[180:183], v[12:15]
    buffer_load_dwordx4 v248, s[40:43], s76 offen offset:2112 lds
    v_mfma_f32_16x16x32_bf16 v[4:7], v[132:135], v[176:179], v[4:7]
    ds_read_b64_tr_b16 v[148:149], v250 offset:4384
    ds_read_b64_tr_b16 v[150:151], v250 offset:4896
    v_mfma_f32_16x16x32_bf16 v[32:35], v[136:139], v[176:179], v[32:35]
    buffer_load_dwordx4 v249, s[40:43], s76 offen offset:3168 lds
    v_mfma_f32_16x16x32_bf16 v[40:43], v[136:139], v[180:183], v[40:43]
    ds_read_b64_tr_b16 v[152:153], v250 offset:4416
    ds_read_b64_tr_b16 v[154:155], v250 offset:4928
    v_mfma_f32_16x16x32_bf16 v[48:51], v[136:139], v[184:187], v[48:51]
    ds_read_b64_tr_b16 v[156:157], v250 offset:4448
    ds_read_b64_tr_b16 v[158:159], v250 offset:4960
    v_mfma_f32_16x16x32_bf16 v[56:59], v[136:139], v[188:191], v[56:59]
    v_mfma_f32_16x16x32_bf16 v[60:63], v[140:143], v[188:191], v[60:63]
    v_mfma_f32_16x16x32_bf16 v[52:55], v[140:143], v[184:187], v[52:55]
    v_mfma_f32_16x16x32_bf16 v[44:47], v[140:143], v[180:183], v[44:47]
    v_mfma_f32_16x16x32_bf16 v[36:39], v[140:143], v[176:179], v[36:39]
    s_waitcnt lgkmcnt(0)
    v_mfma_f32_16x16x32_bf16 v[64:67], v[144:147], v[176:179], v[64:67]
    s_add_u32 m0, s72, 4352
    s_xor_b32 s76, s83, 1310720
    v_mfma_f32_16x16x32_bf16 v[72:75], v[144:147], v[180:183], v[72:75]
    ds_read_b128 v[168:171], v251 offset:26112
    ds_read_b128 v[172:175], v251 offset:30464
    v_mfma_f32_16x16x32_bf16 v[80:83], v[144:147], v[184:187], v[80:83]
    buffer_load_dwordx4 v246, s[40:43], s76 offen offset:0 lds
    v_mfma_f32_16x16x32_bf16 v[88:91], v[144:147], v[188:191], v[88:91]
    v_mfma_f32_16x16x32_bf16 v[92:95], v[148:151], v[188:191], v[92:95]
    buffer_load_dwordx4 v247, s[40:43], s76 offen offset:1056 lds
    s_waitcnt vmcnt(6)
    v_mfma_f32_16x16x32_bf16 v[84:87], v[148:151], v[184:187], v[84:87]
    ds_read_b64_tr_b16 v[128:129], v250 offset:8704
    ds_read_b64_tr_b16 v[130:131], v250 offset:9216
    v_mfma_f32_16x16x32_bf16 v[76:79], v[148:151], v[180:183], v[76:79]
    buffer_load_dwordx4 v248, s[40:43], s76 offen offset:2112 lds
    v_mfma_f32_16x16x32_bf16 v[68:71], v[148:151], v[176:179], v[68:71]
    ds_read_b64_tr_b16 v[132:133], v250 offset:8736
    ds_read_b64_tr_b16 v[134:135], v250 offset:9248
    v_mfma_f32_16x16x32_bf16 v[96:99], v[152:155], v[176:179], v[96:99]
    buffer_load_dwordx4 v249, s[40:43], s76 offen offset:3168 lds
    v_mfma_f32_16x16x32_bf16 v[104:107], v[152:155], v[180:183], v[104:107]
    ds_read_b64_tr_b16 v[136:137], v250 offset:8768
    ds_read_b64_tr_b16 v[138:139], v250 offset:9280
    v_mfma_f32_16x16x32_bf16 v[112:115], v[152:155], v[184:187], v[112:115]
    ds_read_b64_tr_b16 v[140:141], v250 offset:8800
    ds_read_b64_tr_b16 v[142:143], v250 offset:9312
    v_mfma_f32_16x16x32_bf16 v[120:123], v[152:155], v[188:191], v[120:123]
    v_mfma_f32_16x16x32_bf16 v[124:127], v[156:159], v[188:191], v[124:127]
    v_mfma_f32_16x16x32_bf16 v[116:119], v[156:159], v[184:187], v[116:119]
    v_mfma_f32_16x16x32_bf16 v[108:111], v[156:159], v[180:183], v[108:111]
    v_mfma_f32_16x16x32_bf16 v[100:103], v[156:159], v[176:179], v[100:103]
    s_waitcnt lgkmcnt(0)
    v_mfma_f32_16x16x32_bf16 v[0:3], v[128:131], v[160:163], v[0:3]
    s_add_u32 m0, s72, 8704
    s_xor_b32 s76, s83, 1310848
    v_mfma_f32_16x16x32_bf16 v[8:11], v[128:131], v[164:167], v[8:11]
    ds_read_b128 v[176:179], v251 offset:17472
    ds_read_b128 v[180:183], v251 offset:21824
    v_mfma_f32_16x16x32_bf16 v[16:19], v[128:131], v[168:171], v[16:19]
    buffer_load_dwordx4 v246, s[40:43], s76 offen offset:0 lds
    v_mfma_f32_16x16x32_bf16 v[24:27], v[128:131], v[172:175], v[24:27]
    v_mfma_f32_16x16x32_bf16 v[28:31], v[132:135], v[172:175], v[28:31]
    buffer_load_dwordx4 v247, s[40:43], s76 offen offset:1056 lds
    s_waitcnt vmcnt(6)
    v_mfma_f32_16x16x32_bf16 v[20:23], v[132:135], v[168:171], v[20:23]
    ds_read_b64_tr_b16 v[144:145], v250 offset:0
    ds_read_b64_tr_b16 v[146:147], v250 offset:512
    v_mfma_f32_16x16x32_bf16 v[12:15], v[132:135], v[164:167], v[12:15]
    buffer_load_dwordx4 v248, s[40:43], s76 offen offset:2112 lds
    v_mfma_f32_16x16x32_bf16 v[4:7], v[132:135], v[160:163], v[4:7]
    ds_read_b64_tr_b16 v[148:149], v250 offset:32
    ds_read_b64_tr_b16 v[150:151], v250 offset:544
    v_mfma_f32_16x16x32_bf16 v[32:35], v[136:139], v[160:163], v[32:35]
    buffer_load_dwordx4 v249, s[40:43], s76 offen offset:3168 lds
    v_mfma_f32_16x16x32_bf16 v[40:43], v[136:139], v[164:167], v[40:43]
    ds_read_b64_tr_b16 v[152:153], v250 offset:64
    ds_read_b64_tr_b16 v[154:155], v250 offset:576
    v_mfma_f32_16x16x32_bf16 v[48:51], v[136:139], v[168:171], v[48:51]
    ds_read_b64_tr_b16 v[156:157], v250 offset:96
    ds_read_b64_tr_b16 v[158:159], v250 offset:608
    v_mfma_f32_16x16x32_bf16 v[56:59], v[136:139], v[172:175], v[56:59]
    v_mfma_f32_16x16x32_bf16 v[60:63], v[140:143], v[172:175], v[60:63]
    v_mfma_f32_16x16x32_bf16 v[52:55], v[140:143], v[168:171], v[52:55]
    v_mfma_f32_16x16x32_bf16 v[44:47], v[140:143], v[164:167], v[44:47]
    v_mfma_f32_16x16x32_bf16 v[36:39], v[140:143], v[160:163], v[36:39]
    s_waitcnt lgkmcnt(0)
    v_mfma_f32_16x16x32_bf16 v[64:67], v[144:147], v[160:163], v[64:67]
    s_add_u32 m0, s72, 0
    s_xor_b32 s76, s83, 1572864
    v_mfma_f32_16x16x32_bf16 v[72:75], v[144:147], v[164:167], v[72:75]
    ds_read_b128 v[184:187], v251 offset:26176
    ds_read_b128 v[188:191], v251 offset:30528
    v_mfma_f32_16x16x32_bf16 v[80:83], v[144:147], v[168:171], v[80:83]
    buffer_load_dwordx4 v246, s[40:43], s76 offen offset:0 lds
    v_mfma_f32_16x16x32_bf16 v[88:91], v[144:147], v[172:175], v[88:91]
    v_mfma_f32_16x16x32_bf16 v[92:95], v[148:151], v[172:175], v[92:95]
    buffer_load_dwordx4 v247, s[40:43], s76 offen offset:1056 lds
    s_waitcnt vmcnt(6)
    v_mfma_f32_16x16x32_bf16 v[84:87], v[148:151], v[168:171], v[84:87]
    ds_read_b64_tr_b16 v[128:129], v250 offset:4352
    ds_read_b64_tr_b16 v[130:131], v250 offset:4864
    v_mfma_f32_16x16x32_bf16 v[76:79], v[148:151], v[164:167], v[76:79]
    buffer_load_dwordx4 v248, s[40:43], s76 offen offset:2112 lds
    v_mfma_f32_16x16x32_bf16 v[68:71], v[148:151], v[160:163], v[68:71]
    ds_read_b64_tr_b16 v[132:133], v250 offset:4384
    ds_read_b64_tr_b16 v[134:135], v250 offset:4896
    v_mfma_f32_16x16x32_bf16 v[96:99], v[152:155], v[160:163], v[96:99]
    buffer_load_dwordx4 v249, s[40:43], s76 offen offset:3168 lds
    v_mfma_f32_16x16x32_bf16 v[104:107], v[152:155], v[164:167], v[104:107]
    ds_read_b64_tr_b16 v[136:137], v250 offset:4416
    ds_read_b64_tr_b16 v[138:139], v250 offset:4928
    v_mfma_f32_16x16x32_bf16 v[112:115], v[152:155], v[168:171], v[112:115]
    ds_read_b64_tr_b16 v[140:141], v250 offset:4448
    ds_read_b64_tr_b16 v[142:143], v250 offset:4960
    v_mfma_f32_16x16x32_bf16 v[120:123], v[152:155], v[172:175], v[120:123]
    v_mfma_f32_16x16x32_bf16 v[124:127], v[156:159], v[172:175], v[124:127]
    v_mfma_f32_16x16x32_bf16 v[116:119], v[156:159], v[168:171], v[116:119]
    v_mfma_f32_16x16x32_bf16 v[108:111], v[156:159], v[164:167], v[108:111]
    v_mfma_f32_16x16x32_bf16 v[100:103], v[156:159], v[160:163], v[100:103]
    s_waitcnt lgkmcnt(0)
    v_mfma_f32_16x16x32_bf16 v[0:3], v[128:131], v[176:179], v[0:3]
    s_add_u32 m0, s72, 4352
    s_xor_b32 s76, s83, 1572992
    v_mfma_f32_16x16x32_bf16 v[8:11], v[128:131], v[180:183], v[8:11]
    ds_read_b128 v[160:163], v251 offset:17536
    ds_read_b128 v[164:167], v251 offset:21888
    v_mfma_f32_16x16x32_bf16 v[16:19], v[128:131], v[184:187], v[16:19]
    buffer_load_dwordx4 v246, s[40:43], s76 offen offset:0 lds
    v_mfma_f32_16x16x32_bf16 v[24:27], v[128:131], v[188:191], v[24:27]
    v_mfma_f32_16x16x32_bf16 v[28:31], v[132:135], v[188:191], v[28:31]
    buffer_load_dwordx4 v247, s[40:43], s76 offen offset:1056 lds
    s_waitcnt vmcnt(6)
    v_mfma_f32_16x16x32_bf16 v[20:23], v[132:135], v[184:187], v[20:23]
    ds_read_b64_tr_b16 v[144:145], v250 offset:8704
    ds_read_b64_tr_b16 v[146:147], v250 offset:9216
    v_mfma_f32_16x16x32_bf16 v[12:15], v[132:135], v[180:183], v[12:15]
    buffer_load_dwordx4 v248, s[40:43], s76 offen offset:2112 lds
    v_mfma_f32_16x16x32_bf16 v[4:7], v[132:135], v[176:179], v[4:7]
    ds_read_b64_tr_b16 v[148:149], v250 offset:8736
    ds_read_b64_tr_b16 v[150:151], v250 offset:9248
    v_mfma_f32_16x16x32_bf16 v[32:35], v[136:139], v[176:179], v[32:35]
    buffer_load_dwordx4 v249, s[40:43], s76 offen offset:3168 lds
    v_mfma_f32_16x16x32_bf16 v[40:43], v[136:139], v[180:183], v[40:43]
    ds_read_b64_tr_b16 v[152:153], v250 offset:8768
    ds_read_b64_tr_b16 v[154:155], v250 offset:9280
    v_mfma_f32_16x16x32_bf16 v[48:51], v[136:139], v[184:187], v[48:51]
    ds_read_b64_tr_b16 v[156:157], v250 offset:8800
    ds_read_b64_tr_b16 v[158:159], v250 offset:9312
    v_mfma_f32_16x16x32_bf16 v[56:59], v[136:139], v[188:191], v[56:59]
    v_mfma_f32_16x16x32_bf16 v[60:63], v[140:143], v[188:191], v[60:63]
    v_mfma_f32_16x16x32_bf16 v[52:55], v[140:143], v[184:187], v[52:55]
    v_mfma_f32_16x16x32_bf16 v[44:47], v[140:143], v[180:183], v[44:47]
    v_mfma_f32_16x16x32_bf16 v[36:39], v[140:143], v[176:179], v[36:39]
    s_waitcnt lgkmcnt(0)
    v_mfma_f32_16x16x32_bf16 v[64:67], v[144:147], v[176:179], v[64:67]
    s_add_u32 m0, s72, 8704
    s_xor_b32 s76, s83, 1835008
    v_mfma_f32_16x16x32_bf16 v[72:75], v[144:147], v[180:183], v[72:75]
    ds_read_b128 v[168:171], v251 offset:26240
    ds_read_b128 v[172:175], v251 offset:30592
    v_mfma_f32_16x16x32_bf16 v[80:83], v[144:147], v[184:187], v[80:83]
    buffer_load_dwordx4 v246, s[40:43], s76 offen offset:0 lds
    v_mfma_f32_16x16x32_bf16 v[88:91], v[144:147], v[188:191], v[88:91]
    v_mfma_f32_16x16x32_bf16 v[92:95], v[148:151], v[188:191], v[92:95]
    buffer_load_dwordx4 v247, s[40:43], s76 offen offset:1056 lds
    s_waitcnt vmcnt(6)
    v_mfma_f32_16x16x32_bf16 v[84:87], v[148:151], v[184:187], v[84:87]
    ds_read_b64_tr_b16 v[128:129], v250 offset:0
    ds_read_b64_tr_b16 v[130:131], v250 offset:512
    v_mfma_f32_16x16x32_bf16 v[76:79], v[148:151], v[180:183], v[76:79]
    buffer_load_dwordx4 v248, s[40:43], s76 offen offset:2112 lds
    v_mfma_f32_16x16x32_bf16 v[68:71], v[148:151], v[176:179], v[68:71]
    ds_read_b64_tr_b16 v[132:133], v250 offset:32
    ds_read_b64_tr_b16 v[134:135], v250 offset:544
    v_mfma_f32_16x16x32_bf16 v[96:99], v[152:155], v[176:179], v[96:99]
    buffer_load_dwordx4 v249, s[40:43], s76 offen offset:3168 lds
    v_mfma_f32_16x16x32_bf16 v[104:107], v[152:155], v[180:183], v[104:107]
    ds_read_b64_tr_b16 v[136:137], v250 offset:64
    ds_read_b64_tr_b16 v[138:139], v250 offset:576
    v_mfma_f32_16x16x32_bf16 v[112:115], v[152:155], v[184:187], v[112:115]
    ds_read_b64_tr_b16 v[140:141], v250 offset:96
    ds_read_b64_tr_b16 v[142:143], v250 offset:608
    v_mfma_f32_16x16x32_bf16 v[120:123], v[152:155], v[188:191], v[120:123]
    v_mfma_f32_16x16x32_bf16 v[124:127], v[156:159], v[188:191], v[124:127]
    v_mfma_f32_16x16x32_bf16 v[116:119], v[156:159], v[184:187], v[116:119]
    v_mfma_f32_16x16x32_bf16 v[108:111], v[156:159], v[180:183], v[108:111]
    v_mfma_f32_16x16x32_bf16 v[100:103], v[156:159], v[176:179], v[100:103]
    s_waitcnt lgkmcnt(0)
    v_mfma_f32_16x16x32_bf16 v[0:3], v[128:131], v[160:163], v[0:3]
    s_add_u32 m0, s72, 0
    s_xor_b32 s76, s83, 1835136
    v_mfma_f32_16x16x32_bf16 v[8:11], v[128:131], v[164:167], v[8:11]
    ds_read_b128 v[176:179], v251 offset:17600
    ds_read_b128 v[180:183], v251 offset:21952
    v_mfma_f32_16x16x32_bf16 v[16:19], v[128:131], v[168:171], v[16:19]
    buffer_load_dwordx4 v246, s[40:43], s76 offen offset:0 lds
    v_mfma_f32_16x16x32_bf16 v[24:27], v[128:131], v[172:175], v[24:27]
    v_mfma_f32_16x16x32_bf16 v[28:31], v[132:135], v[172:175], v[28:31]
    buffer_load_dwordx4 v247, s[40:43], s76 offen offset:1056 lds
    s_waitcnt vmcnt(6)
    v_mfma_f32_16x16x32_bf16 v[20:23], v[132:135], v[168:171], v[20:23]
    ds_read_b64_tr_b16 v[144:145], v250 offset:4352
    ds_read_b64_tr_b16 v[146:147], v250 offset:4864
    v_mfma_f32_16x16x32_bf16 v[12:15], v[132:135], v[164:167], v[12:15]
    buffer_load_dwordx4 v248, s[40:43], s76 offen offset:2112 lds
    v_mfma_f32_16x16x32_bf16 v[4:7], v[132:135], v[160:163], v[4:7]
    ds_read_b64_tr_b16 v[148:149], v250 offset:4384
    ds_read_b64_tr_b16 v[150:151], v250 offset:4896
    v_mfma_f32_16x16x32_bf16 v[32:35], v[136:139], v[160:163], v[32:35]
    buffer_load_dwordx4 v249, s[40:43], s76 offen offset:3168 lds
    v_mfma_f32_16x16x32_bf16 v[40:43], v[136:139], v[164:167], v[40:43]
    ds_read_b64_tr_b16 v[152:153], v250 offset:4416
    ds_read_b64_tr_b16 v[154:155], v250 offset:4928
    v_mfma_f32_16x16x32_bf16 v[48:51], v[136:139], v[168:171], v[48:51]
    ds_read_b64_tr_b16 v[156:157], v250 offset:4448
    ds_read_b64_tr_b16 v[158:159], v250 offset:4960
    v_mfma_f32_16x16x32_bf16 v[56:59], v[136:139], v[172:175], v[56:59]
    v_mfma_f32_16x16x32_bf16 v[60:63], v[140:143], v[172:175], v[60:63]
    v_mfma_f32_16x16x32_bf16 v[52:55], v[140:143], v[168:171], v[52:55]
    v_mfma_f32_16x16x32_bf16 v[44:47], v[140:143], v[164:167], v[44:47]
    v_mfma_f32_16x16x32_bf16 v[36:39], v[140:143], v[160:163], v[36:39]
    s_waitcnt lgkmcnt(0)
    v_mfma_f32_16x16x32_bf16 v[64:67], v[144:147], v[160:163], v[64:67]
    s_add_u32 m0, s72, 4352
    s_xor_b32 s76, s83, 2097152
    v_mfma_f32_16x16x32_bf16 v[72:75], v[144:147], v[164:167], v[72:75]
    ds_read_b128 v[184:187], v251 offset:26304
    ds_read_b128 v[188:191], v251 offset:30656
    v_mfma_f32_16x16x32_bf16 v[80:83], v[144:147], v[168:171], v[80:83]
    buffer_load_dwordx4 v246, s[40:43], s76 offen offset:0 lds
    v_mfma_f32_16x16x32_bf16 v[88:91], v[144:147], v[172:175], v[88:91]
    v_mfma_f32_16x16x32_bf16 v[92:95], v[148:151], v[172:175], v[92:95]
    buffer_load_dwordx4 v247, s[40:43], s76 offen offset:1056 lds
    s_waitcnt vmcnt(6)
    v_mfma_f32_16x16x32_bf16 v[84:87], v[148:151], v[168:171], v[84:87]
    ds_read_b64_tr_b16 v[128:129], v250 offset:8704
    ds_read_b64_tr_b16 v[130:131], v250 offset:9216
    v_mfma_f32_16x16x32_bf16 v[76:79], v[148:151], v[164:167], v[76:79]
    buffer_load_dwordx4 v248, s[40:43], s76 offen offset:2112 lds
    v_mfma_f32_16x16x32_bf16 v[68:71], v[148:151], v[160:163], v[68:71]
    ds_read_b64_tr_b16 v[132:133], v250 offset:8736
    ds_read_b64_tr_b16 v[134:135], v250 offset:9248
    v_mfma_f32_16x16x32_bf16 v[96:99], v[152:155], v[160:163], v[96:99]
    buffer_load_dwordx4 v249, s[40:43], s76 offen offset:3168 lds
    v_mfma_f32_16x16x32_bf16 v[104:107], v[152:155], v[164:167], v[104:107]
    ds_read_b64_tr_b16 v[136:137], v250 offset:8768
    ds_read_b64_tr_b16 v[138:139], v250 offset:9280
    v_mfma_f32_16x16x32_bf16 v[112:115], v[152:155], v[168:171], v[112:115]
    ds_read_b64_tr_b16 v[140:141], v250 offset:8800
    ds_read_b64_tr_b16 v[142:143], v250 offset:9312
    v_mfma_f32_16x16x32_bf16 v[120:123], v[152:155], v[172:175], v[120:123]
    v_mfma_f32_16x16x32_bf16 v[124:127], v[156:159], v[172:175], v[124:127]
    v_mfma_f32_16x16x32_bf16 v[116:119], v[156:159], v[168:171], v[116:119]
    v_mfma_f32_16x16x32_bf16 v[108:111], v[156:159], v[164:167], v[108:111]
    v_mfma_f32_16x16x32_bf16 v[100:103], v[156:159], v[160:163], v[100:103]
    s_waitcnt lgkmcnt(0)
    s_barrier
    v_mfma_f32_16x16x32_bf16 v[0:3], v[128:131], v[176:179], v[0:3]
    s_add_u32 m0, s72, 8704
    s_xor_b32 s76, s83, 2097280
    v_mfma_f32_16x16x32_bf16 v[8:11], v[128:131], v[180:183], v[8:11]
    ds_read_b128 v[160:163], v251 offset:34816
    ds_read_b128 v[164:167], v251 offset:39168
    v_mfma_f32_16x16x32_bf16 v[16:19], v[128:131], v[184:187], v[16:19]
    buffer_load_dwordx4 v246, s[40:43], s76 offen offset:0 lds
    v_mfma_f32_16x16x32_bf16 v[24:27], v[128:131], v[188:191], v[24:27]
    v_mfma_f32_16x16x32_bf16 v[28:31], v[132:135], v[188:191], v[28:31]
    buffer_load_dwordx4 v247, s[40:43], s76 offen offset:1056 lds
    s_waitcnt vmcnt(6)
    v_mfma_f32_16x16x32_bf16 v[20:23], v[132:135], v[184:187], v[20:23]
    ds_read_b64_tr_b16 v[144:145], v250 offset:0
    ds_read_b64_tr_b16 v[146:147], v250 offset:512
    v_mfma_f32_16x16x32_bf16 v[12:15], v[132:135], v[180:183], v[12:15]
    buffer_load_dwordx4 v248, s[40:43], s76 offen offset:2112 lds
    v_mfma_f32_16x16x32_bf16 v[4:7], v[132:135], v[176:179], v[4:7]
    ds_read_b64_tr_b16 v[148:149], v250 offset:32
    ds_read_b64_tr_b16 v[150:151], v250 offset:544
    v_mfma_f32_16x16x32_bf16 v[32:35], v[136:139], v[176:179], v[32:35]
    buffer_load_dwordx4 v249, s[40:43], s76 offen offset:3168 lds
    v_mfma_f32_16x16x32_bf16 v[40:43], v[136:139], v[180:183], v[40:43]
    ds_read_b64_tr_b16 v[152:153], v250 offset:64
    ds_read_b64_tr_b16 v[154:155], v250 offset:576
    v_mfma_f32_16x16x32_bf16 v[48:51], v[136:139], v[184:187], v[48:51]
    ds_read_b64_tr_b16 v[156:157], v250 offset:96
    ds_read_b64_tr_b16 v[158:159], v250 offset:608
    v_mfma_f32_16x16x32_bf16 v[56:59], v[136:139], v[188:191], v[56:59]
    v_mfma_f32_16x16x32_bf16 v[60:63], v[140:143], v[188:191], v[60:63]
    v_mfma_f32_16x16x32_bf16 v[52:55], v[140:143], v[184:187], v[52:55]
    v_mfma_f32_16x16x32_bf16 v[44:47], v[140:143], v[180:183], v[44:47]
    v_mfma_f32_16x16x32_bf16 v[36:39], v[140:143], v[176:179], v[36:39]
    s_waitcnt lgkmcnt(0)
    v_mfma_f32_16x16x32_bf16 v[64:67], v[144:147], v[176:179], v[64:67]
    s_add_u32 m0, s72, 0
    s_xor_b32 s76, s83, 2359296
    v_mfma_f32_16x16x32_bf16 v[72:75], v[144:147], v[180:183], v[72:75]
    ds_read_b128 v[168:171], v251 offset:43520
    ds_read_b128 v[172:175], v251 offset:47872
    v_mfma_f32_16x16x32_bf16 v[80:83], v[144:147], v[184:187], v[80:83]
    buffer_load_dwordx4 v246, s[40:43], s76 offen offset:0 lds
    v_mfma_f32_16x16x32_bf16 v[88:91], v[144:147], v[188:191], v[88:91]
    v_mfma_f32_16x16x32_bf16 v[92:95], v[148:151], v[188:191], v[92:95]
    buffer_load_dwordx4 v247, s[40:43], s76 offen offset:1056 lds
    s_waitcnt vmcnt(6)
    v_mfma_f32_16x16x32_bf16 v[84:87], v[148:151], v[184:187], v[84:87]
    ds_read_b64_tr_b16 v[128:129], v250 offset:4352
    ds_read_b64_tr_b16 v[130:131], v250 offset:4864
    v_mfma_f32_16x16x32_bf16 v[76:79], v[148:151], v[180:183], v[76:79]
    buffer_load_dwordx4 v248, s[40:43], s76 offen offset:2112 lds
    v_mfma_f32_16x16x32_bf16 v[68:71], v[148:151], v[176:179], v[68:71]
    ds_read_b64_tr_b16 v[132:133], v250 offset:4384
    ds_read_b64_tr_b16 v[134:135], v250 offset:4896
    v_mfma_f32_16x16x32_bf16 v[96:99], v[152:155], v[176:179], v[96:99]
    buffer_load_dwordx4 v249, s[40:43], s76 offen offset:3168 lds
    v_mfma_f32_16x16x32_bf16 v[104:107], v[152:155], v[180:183], v[104:107]
    ds_read_b64_tr_b16 v[136:137], v250 offset:4416
    ds_read_b64_tr_b16 v[138:139], v250 offset:4928
    v_mfma_f32_16x16x32_bf16 v[112:115], v[152:155], v[184:187], v[112:115]
    ds_read_b64_tr_b16 v[140:141], v250 offset:4448
    ds_read_b64_tr_b16 v[142:143], v250 offset:4960
    v_mfma_f32_16x16x32_bf16 v[120:123], v[152:155], v[188:191], v[120:123]
    v_mfma_f32_16x16x32_bf16 v[124:127], v[156:159], v[188:191], v[124:127]
    v_mfma_f32_16x16x32_bf16 v[116:119], v[156:159], v[184:187], v[116:119]
    v_mfma_f32_16x16x32_bf16 v[108:111], v[156:159], v[180:183], v[108:111]
    v_mfma_f32_16x16x32_bf16 v[100:103], v[156:159], v[176:179], v[100:103]
    s_waitcnt lgkmcnt(0)
    v_mfma_f32_16x16x32_bf16 v[0:3], v[128:131], v[160:163], v[0:3]
    s_add_u32 m0, s72, 4352
    s_xor_b32 s76, s83, 2359424
    v_mfma_f32_16x16x32_bf16 v[8:11], v[128:131], v[164:167], v[8:11]
    ds_read_b128 v[176:179], v251 offset:34880
    ds_read_b128 v[180:183], v251 offset:39232
    v_mfma_f32_16x16x32_bf16 v[16:19], v[128:131], v[168:171], v[16:19]
    buffer_load_dwordx4 v246, s[40:43], s76 offen offset:0 lds
    v_mfma_f32_16x16x32_bf16 v[24:27], v[128:131], v[172:175], v[24:27]
    v_mfma_f32_16x16x32_bf16 v[28:31], v[132:135], v[172:175], v[28:31]
    buffer_load_dwordx4 v247, s[40:43], s76 offen offset:1056 lds
    s_waitcnt vmcnt(6)
    v_mfma_f32_16x16x32_bf16 v[20:23], v[132:135], v[168:171], v[20:23]
    ds_read_b64_tr_b16 v[144:145], v250 offset:8704
    ds_read_b64_tr_b16 v[146:147], v250 offset:9216
    v_mfma_f32_16x16x32_bf16 v[12:15], v[132:135], v[164:167], v[12:15]
    buffer_load_dwordx4 v248, s[40:43], s76 offen offset:2112 lds
    v_mfma_f32_16x16x32_bf16 v[4:7], v[132:135], v[160:163], v[4:7]
    ds_read_b64_tr_b16 v[148:149], v250 offset:8736
    ds_read_b64_tr_b16 v[150:151], v250 offset:9248
    v_mfma_f32_16x16x32_bf16 v[32:35], v[136:139], v[160:163], v[32:35]
    buffer_load_dwordx4 v249, s[40:43], s76 offen offset:3168 lds
    v_mfma_f32_16x16x32_bf16 v[40:43], v[136:139], v[164:167], v[40:43]
    ds_read_b64_tr_b16 v[152:153], v250 offset:8768
    ds_read_b64_tr_b16 v[154:155], v250 offset:9280
    v_mfma_f32_16x16x32_bf16 v[48:51], v[136:139], v[168:171], v[48:51]
    ds_read_b64_tr_b16 v[156:157], v250 offset:8800
    ds_read_b64_tr_b16 v[158:159], v250 offset:9312
    v_mfma_f32_16x16x32_bf16 v[56:59], v[136:139], v[172:175], v[56:59]
    v_mfma_f32_16x16x32_bf16 v[60:63], v[140:143], v[172:175], v[60:63]
    v_mfma_f32_16x16x32_bf16 v[52:55], v[140:143], v[168:171], v[52:55]
    v_mfma_f32_16x16x32_bf16 v[44:47], v[140:143], v[164:167], v[44:47]
    v_mfma_f32_16x16x32_bf16 v[36:39], v[140:143], v[160:163], v[36:39]
    s_waitcnt lgkmcnt(0)
    v_mfma_f32_16x16x32_bf16 v[64:67], v[144:147], v[160:163], v[64:67]
    s_add_u32 m0, s72, 8704
    s_xor_b32 s76, s83, 2621440
    v_mfma_f32_16x16x32_bf16 v[72:75], v[144:147], v[164:167], v[72:75]
    ds_read_b128 v[184:187], v251 offset:43584
    ds_read_b128 v[188:191], v251 offset:47936
    v_mfma_f32_16x16x32_bf16 v[80:83], v[144:147], v[168:171], v[80:83]
    buffer_load_dwordx4 v246, s[40:43], s76 offen offset:0 lds
    v_mfma_f32_16x16x32_bf16 v[88:91], v[144:147], v[172:175], v[88:91]
    v_mfma_f32_16x16x32_bf16 v[92:95], v[148:151], v[172:175], v[92:95]
    buffer_load_dwordx4 v247, s[40:43], s76 offen offset:1056 lds
    s_waitcnt vmcnt(6)
    v_mfma_f32_16x16x32_bf16 v[84:87], v[148:151], v[168:171], v[84:87]
    ds_read_b64_tr_b16 v[128:129], v250 offset:0
    ds_read_b64_tr_b16 v[130:131], v250 offset:512
    v_mfma_f32_16x16x32_bf16 v[76:79], v[148:151], v[164:167], v[76:79]
    buffer_load_dwordx4 v248, s[40:43], s76 offen offset:2112 lds
    v_mfma_f32_16x16x32_bf16 v[68:71], v[148:151], v[160:163], v[68:71]
    ds_read_b64_tr_b16 v[132:133], v250 offset:32
    ds_read_b64_tr_b16 v[134:135], v250 offset:544
    v_mfma_f32_16x16x32_bf16 v[96:99], v[152:155], v[160:163], v[96:99]
    buffer_load_dwordx4 v249, s[40:43], s76 offen offset:3168 lds
    v_mfma_f32_16x16x32_bf16 v[104:107], v[152:155], v[164:167], v[104:107]
    ds_read_b64_tr_b16 v[136:137], v250 offset:64
    ds_read_b64_tr_b16 v[138:139], v250 offset:576
    v_mfma_f32_16x16x32_bf16 v[112:115], v[152:155], v[168:171], v[112:115]
    ds_read_b64_tr_b16 v[140:141], v250 offset:96
    ds_read_b64_tr_b16 v[142:143], v250 offset:608
    v_mfma_f32_16x16x32_bf16 v[120:123], v[152:155], v[172:175], v[120:123]
    v_mfma_f32_16x16x32_bf16 v[124:127], v[156:159], v[172:175], v[124:127]
    v_mfma_f32_16x16x32_bf16 v[116:119], v[156:159], v[168:171], v[116:119]
    v_mfma_f32_16x16x32_bf16 v[108:111], v[156:159], v[164:167], v[108:111]
    v_mfma_f32_16x16x32_bf16 v[100:103], v[156:159], v[160:163], v[100:103]
    s_waitcnt lgkmcnt(0)
    v_mfma_f32_16x16x32_bf16 v[0:3], v[128:131], v[176:179], v[0:3]
    s_add_u32 m0, s72, 0
    s_xor_b32 s76, s83, 2621568
    v_mfma_f32_16x16x32_bf16 v[8:11], v[128:131], v[180:183], v[8:11]
    ds_read_b128 v[160:163], v251 offset:34944
    ds_read_b128 v[164:167], v251 offset:39296
    v_mfma_f32_16x16x32_bf16 v[16:19], v[128:131], v[184:187], v[16:19]
    buffer_load_dwordx4 v246, s[40:43], s76 offen offset:0 lds
    v_mfma_f32_16x16x32_bf16 v[24:27], v[128:131], v[188:191], v[24:27]
    v_mfma_f32_16x16x32_bf16 v[28:31], v[132:135], v[188:191], v[28:31]
    buffer_load_dwordx4 v247, s[40:43], s76 offen offset:1056 lds
    s_waitcnt vmcnt(6)
    v_mfma_f32_16x16x32_bf16 v[20:23], v[132:135], v[184:187], v[20:23]
    ds_read_b64_tr_b16 v[144:145], v250 offset:4352
    ds_read_b64_tr_b16 v[146:147], v250 offset:4864
    v_mfma_f32_16x16x32_bf16 v[12:15], v[132:135], v[180:183], v[12:15]
    buffer_load_dwordx4 v248, s[40:43], s76 offen offset:2112 lds
    v_mfma_f32_16x16x32_bf16 v[4:7], v[132:135], v[176:179], v[4:7]
    ds_read_b64_tr_b16 v[148:149], v250 offset:4384
    ds_read_b64_tr_b16 v[150:151], v250 offset:4896
    v_mfma_f32_16x16x32_bf16 v[32:35], v[136:139], v[176:179], v[32:35]
    buffer_load_dwordx4 v249, s[40:43], s76 offen offset:3168 lds
    v_mfma_f32_16x16x32_bf16 v[40:43], v[136:139], v[180:183], v[40:43]
    ds_read_b64_tr_b16 v[152:153], v250 offset:4416
    ds_read_b64_tr_b16 v[154:155], v250 offset:4928
    v_mfma_f32_16x16x32_bf16 v[48:51], v[136:139], v[184:187], v[48:51]
    ds_read_b64_tr_b16 v[156:157], v250 offset:4448
    ds_read_b64_tr_b16 v[158:159], v250 offset:4960
    v_mfma_f32_16x16x32_bf16 v[56:59], v[136:139], v[188:191], v[56:59]
    v_mfma_f32_16x16x32_bf16 v[60:63], v[140:143], v[188:191], v[60:63]
    v_mfma_f32_16x16x32_bf16 v[52:55], v[140:143], v[184:187], v[52:55]
    v_mfma_f32_16x16x32_bf16 v[44:47], v[140:143], v[180:183], v[44:47]
    v_mfma_f32_16x16x32_bf16 v[36:39], v[140:143], v[176:179], v[36:39]
    s_waitcnt lgkmcnt(0)
    v_mfma_f32_16x16x32_bf16 v[64:67], v[144:147], v[176:179], v[64:67]
    s_add_u32 m0, s72, 4352
    s_xor_b32 s76, s83, 2883584
    v_mfma_f32_16x16x32_bf16 v[72:75], v[144:147], v[180:183], v[72:75]
    ds_read_b128 v[168:171], v251 offset:43648
    ds_read_b128 v[172:175], v251 offset:48000
    v_mfma_f32_16x16x32_bf16 v[80:83], v[144:147], v[184:187], v[80:83]
    buffer_load_dwordx4 v246, s[40:43], s76 offen offset:0 lds
    v_mfma_f32_16x16x32_bf16 v[88:91], v[144:147], v[188:191], v[88:91]
    v_mfma_f32_16x16x32_bf16 v[92:95], v[148:151], v[188:191], v[92:95]
    buffer_load_dwordx4 v247, s[40:43], s76 offen offset:1056 lds
    s_waitcnt vmcnt(6)
    v_mfma_f32_16x16x32_bf16 v[84:87], v[148:151], v[184:187], v[84:87]
    ds_read_b64_tr_b16 v[128:129], v250 offset:8704
    ds_read_b64_tr_b16 v[130:131], v250 offset:9216
    v_mfma_f32_16x16x32_bf16 v[76:79], v[148:151], v[180:183], v[76:79]
    buffer_load_dwordx4 v248, s[40:43], s76 offen offset:2112 lds
    v_mfma_f32_16x16x32_bf16 v[68:71], v[148:151], v[176:179], v[68:71]
    ds_read_b64_tr_b16 v[132:133], v250 offset:8736
    ds_read_b64_tr_b16 v[134:135], v250 offset:9248
    v_mfma_f32_16x16x32_bf16 v[96:99], v[152:155], v[176:179], v[96:99]
    buffer_load_dwordx4 v249, s[40:43], s76 offen offset:3168 lds
    v_mfma_f32_16x16x32_bf16 v[104:107], v[152:155], v[180:183], v[104:107]
    ds_read_b64_tr_b16 v[136:137], v250 offset:8768
    ds_read_b64_tr_b16 v[138:139], v250 offset:9280
    v_mfma_f32_16x16x32_bf16 v[112:115], v[152:155], v[184:187], v[112:115]
    ds_read_b64_tr_b16 v[140:141], v250 offset:8800
    ds_read_b64_tr_b16 v[142:143], v250 offset:9312
    v_mfma_f32_16x16x32_bf16 v[120:123], v[152:155], v[188:191], v[120:123]
    v_mfma_f32_16x16x32_bf16 v[124:127], v[156:159], v[188:191], v[124:127]
    v_mfma_f32_16x16x32_bf16 v[116:119], v[156:159], v[184:187], v[116:119]
    v_mfma_f32_16x16x32_bf16 v[108:111], v[156:159], v[180:183], v[108:111]
    v_mfma_f32_16x16x32_bf16 v[100:103], v[156:159], v[176:179], v[100:103]
    s_waitcnt lgkmcnt(0)
    v_mfma_f32_16x16x32_bf16 v[0:3], v[128:131], v[160:163], v[0:3]
    s_add_u32 m0, s72, 8704
    s_xor_b32 s76, s83, 2883712
    v_mfma_f32_16x16x32_bf16 v[8:11], v[128:131], v[164:167], v[8:11]
    ds_read_b128 v[176:179], v251 offset:35008
    ds_read_b128 v[180:183], v251 offset:39360
    v_mfma_f32_16x16x32_bf16 v[16:19], v[128:131], v[168:171], v[16:19]
    buffer_load_dwordx4 v246, s[40:43], s76 offen offset:0 lds
    v_mfma_f32_16x16x32_bf16 v[24:27], v[128:131], v[172:175], v[24:27]
    v_mfma_f32_16x16x32_bf16 v[28:31], v[132:135], v[172:175], v[28:31]
    buffer_load_dwordx4 v247, s[40:43], s76 offen offset:1056 lds
    s_waitcnt vmcnt(6)
    v_mfma_f32_16x16x32_bf16 v[20:23], v[132:135], v[168:171], v[20:23]
    ds_read_b64_tr_b16 v[144:145], v250 offset:0
    ds_read_b64_tr_b16 v[146:147], v250 offset:512
    v_mfma_f32_16x16x32_bf16 v[12:15], v[132:135], v[164:167], v[12:15]
    buffer_load_dwordx4 v248, s[40:43], s76 offen offset:2112 lds
    v_mfma_f32_16x16x32_bf16 v[4:7], v[132:135], v[160:163], v[4:7]
    ds_read_b64_tr_b16 v[148:149], v250 offset:32
    ds_read_b64_tr_b16 v[150:151], v250 offset:544
    v_mfma_f32_16x16x32_bf16 v[32:35], v[136:139], v[160:163], v[32:35]
    buffer_load_dwordx4 v249, s[40:43], s76 offen offset:3168 lds
    v_mfma_f32_16x16x32_bf16 v[40:43], v[136:139], v[164:167], v[40:43]
    ds_read_b64_tr_b16 v[152:153], v250 offset:64
    ds_read_b64_tr_b16 v[154:155], v250 offset:576
    v_mfma_f32_16x16x32_bf16 v[48:51], v[136:139], v[168:171], v[48:51]
    ds_read_b64_tr_b16 v[156:157], v250 offset:96
    ds_read_b64_tr_b16 v[158:159], v250 offset:608
    v_mfma_f32_16x16x32_bf16 v[56:59], v[136:139], v[172:175], v[56:59]
    v_mfma_f32_16x16x32_bf16 v[60:63], v[140:143], v[172:175], v[60:63]
    v_mfma_f32_16x16x32_bf16 v[52:55], v[140:143], v[168:171], v[52:55]
    v_mfma_f32_16x16x32_bf16 v[44:47], v[140:143], v[164:167], v[44:47]
    v_mfma_f32_16x16x32_bf16 v[36:39], v[140:143], v[160:163], v[36:39]
    s_waitcnt lgkmcnt(0)
    v_mfma_f32_16x16x32_bf16 v[64:67], v[144:147], v[160:163], v[64:67]
    s_add_u32 m0, s72, 0
    s_xor_b32 s76, s83, 3145728
    v_mfma_f32_16x16x32_bf16 v[72:75], v[144:147], v[164:167], v[72:75]
    ds_read_b128 v[184:187], v251 offset:43712
    ds_read_b128 v[188:191], v251 offset:48064
    v_mfma_f32_16x16x32_bf16 v[80:83], v[144:147], v[168:171], v[80:83]
    buffer_load_dwordx4 v246, s[40:43], s76 offen offset:0 lds
    v_mfma_f32_16x16x32_bf16 v[88:91], v[144:147], v[172:175], v[88:91]
    v_mfma_f32_16x16x32_bf16 v[92:95], v[148:151], v[172:175], v[92:95]
    buffer_load_dwordx4 v247, s[40:43], s76 offen offset:1056 lds
    s_waitcnt vmcnt(6)
    v_mfma_f32_16x16x32_bf16 v[84:87], v[148:151], v[168:171], v[84:87]
    ds_read_b64_tr_b16 v[128:129], v250 offset:4352
    ds_read_b64_tr_b16 v[130:131], v250 offset:4864
    v_mfma_f32_16x16x32_bf16 v[76:79], v[148:151], v[164:167], v[76:79]
    buffer_load_dwordx4 v248, s[40:43], s76 offen offset:2112 lds
    v_mfma_f32_16x16x32_bf16 v[68:71], v[148:151], v[160:163], v[68:71]
    ds_read_b64_tr_b16 v[132:133], v250 offset:4384
    ds_read_b64_tr_b16 v[134:135], v250 offset:4896
    v_mfma_f32_16x16x32_bf16 v[96:99], v[152:155], v[160:163], v[96:99]
    buffer_load_dwordx4 v249, s[40:43], s76 offen offset:3168 lds
    v_mfma_f32_16x16x32_bf16 v[104:107], v[152:155], v[164:167], v[104:107]
    ds_read_b64_tr_b16 v[136:137], v250 offset:4416
    ds_read_b64_tr_b16 v[138:139], v250 offset:4928
    v_mfma_f32_16x16x32_bf16 v[112:115], v[152:155], v[168:171], v[112:115]
    ds_read_b64_tr_b16 v[140:141], v250 offset:4448
    ds_read_b64_tr_b16 v[142:143], v250 offset:4960
    v_mfma_f32_16x16x32_bf16 v[120:123], v[152:155], v[172:175], v[120:123]
    v_mfma_f32_16x16x32_bf16 v[124:127], v[156:159], v[172:175], v[124:127]
    v_mfma_f32_16x16x32_bf16 v[116:119], v[156:159], v[168:171], v[116:119]
    v_mfma_f32_16x16x32_bf16 v[108:111], v[156:159], v[164:167], v[108:111]
    v_mfma_f32_16x16x32_bf16 v[100:103], v[156:159], v[160:163], v[100:103]
    s_waitcnt lgkmcnt(0)
    s_barrier
    v_mfma_f32_16x16x32_bf16 v[0:3], v[128:131], v[176:179], v[0:3]
    s_add_u32 m0, s72, 4352
    s_xor_b32 s76, s83, 3145856
    v_mfma_f32_16x16x32_bf16 v[8:11], v[128:131], v[180:183], v[8:11]
    ds_read_b128 v[160:163], v251 offset:52224
    ds_read_b128 v[164:167], v251 offset:56576
    v_mfma_f32_16x16x32_bf16 v[16:19], v[128:131], v[184:187], v[16:19]
    buffer_load_dwordx4 v246, s[40:43], s76 offen offset:0 lds
    v_mfma_f32_16x16x32_bf16 v[24:27], v[128:131], v[188:191], v[24:27]
    v_mfma_f32_16x16x32_bf16 v[28:31], v[132:135], v[188:191], v[28:31]
    buffer_load_dwordx4 v247, s[40:43], s76 offen offset:1056 lds
    s_waitcnt vmcnt(6)
    v_mfma_f32_16x16x32_bf16 v[20:23], v[132:135], v[184:187], v[20:23]
    ds_read_b64_tr_b16 v[144:145], v250 offset:8704
    ds_read_b64_tr_b16 v[146:147], v250 offset:9216
    v_mfma_f32_16x16x32_bf16 v[12:15], v[132:135], v[180:183], v[12:15]
    buffer_load_dwordx4 v248, s[40:43], s76 offen offset:2112 lds
    v_mfma_f32_16x16x32_bf16 v[4:7], v[132:135], v[176:179], v[4:7]
    ds_read_b64_tr_b16 v[148:149], v250 offset:8736
    ds_read_b64_tr_b16 v[150:151], v250 offset:9248
    v_mfma_f32_16x16x32_bf16 v[32:35], v[136:139], v[176:179], v[32:35]
    buffer_load_dwordx4 v249, s[40:43], s76 offen offset:3168 lds
    v_mfma_f32_16x16x32_bf16 v[40:43], v[136:139], v[180:183], v[40:43]
    ds_read_b64_tr_b16 v[152:153], v250 offset:8768
    ds_read_b64_tr_b16 v[154:155], v250 offset:9280
    v_mfma_f32_16x16x32_bf16 v[48:51], v[136:139], v[184:187], v[48:51]
    ds_read_b64_tr_b16 v[156:157], v250 offset:8800
    ds_read_b64_tr_b16 v[158:159], v250 offset:9312
    v_mfma_f32_16x16x32_bf16 v[56:59], v[136:139], v[188:191], v[56:59]
    v_mfma_f32_16x16x32_bf16 v[60:63], v[140:143], v[188:191], v[60:63]
    v_mfma_f32_16x16x32_bf16 v[52:55], v[140:143], v[184:187], v[52:55]
    v_mfma_f32_16x16x32_bf16 v[44:47], v[140:143], v[180:183], v[44:47]
    v_mfma_f32_16x16x32_bf16 v[36:39], v[140:143], v[176:179], v[36:39]
    s_waitcnt lgkmcnt(0)
    v_mfma_f32_16x16x32_bf16 v[64:67], v[144:147], v[176:179], v[64:67]
    s_add_u32 m0, s72, 8704
    s_xor_b32 s76, s83, 3407872
    v_mfma_f32_16x16x32_bf16 v[72:75], v[144:147], v[180:183], v[72:75]
    ds_read_b128 v[168:171], v251 offset:60928
    ds_read_b128 v[172:175], v251 offset:65280
    v_mfma_f32_16x16x32_bf16 v[80:83], v[144:147], v[184:187], v[80:83]
    buffer_load_dwordx4 v246, s[40:43], s76 offen offset:0 lds
    v_mfma_f32_16x16x32_bf16 v[88:91], v[144:147], v[188:191], v[88:91]
    v_mfma_f32_16x16x32_bf16 v[92:95], v[148:151], v[188:191], v[92:95]
    buffer_load_dwordx4 v247, s[40:43], s76 offen offset:1056 lds
    s_waitcnt vmcnt(6)
    v_mfma_f32_16x16x32_bf16 v[84:87], v[148:151], v[184:187], v[84:87]
    ds_read_b64_tr_b16 v[128:129], v250 offset:0
    ds_read_b64_tr_b16 v[130:131], v250 offset:512
    v_mfma_f32_16x16x32_bf16 v[76:79], v[148:151], v[180:183], v[76:79]
    buffer_load_dwordx4 v248, s[40:43], s76 offen offset:2112 lds
    v_mfma_f32_16x16x32_bf16 v[68:71], v[148:151], v[176:179], v[68:71]
    ds_read_b64_tr_b16 v[132:133], v250 offset:32
    ds_read_b64_tr_b16 v[134:135], v250 offset:544
    v_mfma_f32_16x16x32_bf16 v[96:99], v[152:155], v[176:179], v[96:99]
    buffer_load_dwordx4 v249, s[40:43], s76 offen offset:3168 lds
    v_mfma_f32_16x16x32_bf16 v[104:107], v[152:155], v[180:183], v[104:107]
    ds_read_b64_tr_b16 v[136:137], v250 offset:64
    ds_read_b64_tr_b16 v[138:139], v250 offset:576
    v_mfma_f32_16x16x32_bf16 v[112:115], v[152:155], v[184:187], v[112:115]
    ds_read_b64_tr_b16 v[140:141], v250 offset:96
    ds_read_b64_tr_b16 v[142:143], v250 offset:608
    v_mfma_f32_16x16x32_bf16 v[120:123], v[152:155], v[188:191], v[120:123]
    v_mfma_f32_16x16x32_bf16 v[124:127], v[156:159], v[188:191], v[124:127]
    v_mfma_f32_16x16x32_bf16 v[116:119], v[156:159], v[184:187], v[116:119]
    v_mfma_f32_16x16x32_bf16 v[108:111], v[156:159], v[180:183], v[108:111]
    v_mfma_f32_16x16x32_bf16 v[100:103], v[156:159], v[176:179], v[100:103]
    s_waitcnt lgkmcnt(0)
    v_mfma_f32_16x16x32_bf16 v[0:3], v[128:131], v[160:163], v[0:3]
    s_add_u32 m0, s72, 0
    s_xor_b32 s76, s83, 3408000
    v_mfma_f32_16x16x32_bf16 v[8:11], v[128:131], v[164:167], v[8:11]
    ds_read_b128 v[176:179], v251 offset:52288
    ds_read_b128 v[180:183], v251 offset:56640
    v_mfma_f32_16x16x32_bf16 v[16:19], v[128:131], v[168:171], v[16:19]
    buffer_load_dwordx4 v246, s[40:43], s76 offen offset:0 lds
    v_mfma_f32_16x16x32_bf16 v[24:27], v[128:131], v[172:175], v[24:27]
    v_mfma_f32_16x16x32_bf16 v[28:31], v[132:135], v[172:175], v[28:31]
    buffer_load_dwordx4 v247, s[40:43], s76 offen offset:1056 lds
    s_waitcnt vmcnt(6)
    v_mfma_f32_16x16x32_bf16 v[20:23], v[132:135], v[168:171], v[20:23]
    ds_read_b64_tr_b16 v[144:145], v250 offset:4352
    ds_read_b64_tr_b16 v[146:147], v250 offset:4864
    v_mfma_f32_16x16x32_bf16 v[12:15], v[132:135], v[164:167], v[12:15]
    buffer_load_dwordx4 v248, s[40:43], s76 offen offset:2112 lds
    v_mfma_f32_16x16x32_bf16 v[4:7], v[132:135], v[160:163], v[4:7]
    ds_read_b64_tr_b16 v[148:149], v250 offset:4384
    ds_read_b64_tr_b16 v[150:151], v250 offset:4896
    v_mfma_f32_16x16x32_bf16 v[32:35], v[136:139], v[160:163], v[32:35]
    buffer_load_dwordx4 v249, s[40:43], s76 offen offset:3168 lds
    v_mfma_f32_16x16x32_bf16 v[40:43], v[136:139], v[164:167], v[40:43]
    ds_read_b64_tr_b16 v[152:153], v250 offset:4416
    ds_read_b64_tr_b16 v[154:155], v250 offset:4928
    v_mfma_f32_16x16x32_bf16 v[48:51], v[136:139], v[168:171], v[48:51]
    ds_read_b64_tr_b16 v[156:157], v250 offset:4448
    ds_read_b64_tr_b16 v[158:159], v250 offset:4960
    v_mfma_f32_16x16x32_bf16 v[56:59], v[136:139], v[172:175], v[56:59]
    v_mfma_f32_16x16x32_bf16 v[60:63], v[140:143], v[172:175], v[60:63]
    v_mfma_f32_16x16x32_bf16 v[52:55], v[140:143], v[168:171], v[52:55]
    v_mfma_f32_16x16x32_bf16 v[44:47], v[140:143], v[164:167], v[44:47]
    v_mfma_f32_16x16x32_bf16 v[36:39], v[140:143], v[160:163], v[36:39]
    s_waitcnt lgkmcnt(0)
    v_mfma_f32_16x16x32_bf16 v[64:67], v[144:147], v[160:163], v[64:67]
    s_add_u32 m0, s72, 4352
    s_xor_b32 s76, s83, 3670016
    v_mfma_f32_16x16x32_bf16 v[72:75], v[144:147], v[164:167], v[72:75]
    ds_read_b128 v[184:187], v251 offset:60992
    ds_read_b128 v[188:191], v251 offset:65344
    v_mfma_f32_16x16x32_bf16 v[80:83], v[144:147], v[168:171], v[80:83]
    buffer_load_dwordx4 v246, s[40:43], s76 offen offset:0 lds
    v_mfma_f32_16x16x32_bf16 v[88:91], v[144:147], v[172:175], v[88:91]
    v_mfma_f32_16x16x32_bf16 v[92:95], v[148:151], v[172:175], v[92:95]
    buffer_load_dwordx4 v247, s[40:43], s76 offen offset:1056 lds
    s_waitcnt vmcnt(6)
    v_mfma_f32_16x16x32_bf16 v[84:87], v[148:151], v[168:171], v[84:87]
    ds_read_b64_tr_b16 v[128:129], v250 offset:8704
    ds_read_b64_tr_b16 v[130:131], v250 offset:9216
    v_mfma_f32_16x16x32_bf16 v[76:79], v[148:151], v[164:167], v[76:79]
    buffer_load_dwordx4 v248, s[40:43], s76 offen offset:2112 lds
    v_mfma_f32_16x16x32_bf16 v[68:71], v[148:151], v[160:163], v[68:71]
    ds_read_b64_tr_b16 v[132:133], v250 offset:8736
    ds_read_b64_tr_b16 v[134:135], v250 offset:9248
    v_mfma_f32_16x16x32_bf16 v[96:99], v[152:155], v[160:163], v[96:99]
    buffer_load_dwordx4 v249, s[40:43], s76 offen offset:3168 lds
    v_mfma_f32_16x16x32_bf16 v[104:107], v[152:155], v[164:167], v[104:107]
    ds_read_b64_tr_b16 v[136:137], v250 offset:8768
    ds_read_b64_tr_b16 v[138:139], v250 offset:9280
    v_mfma_f32_16x16x32_bf16 v[112:115], v[152:155], v[168:171], v[112:115]
    ds_read_b64_tr_b16 v[140:141], v250 offset:8800
    ds_read_b64_tr_b16 v[142:143], v250 offset:9312
    v_mfma_f32_16x16x32_bf16 v[120:123], v[152:155], v[172:175], v[120:123]
    v_mfma_f32_16x16x32_bf16 v[124:127], v[156:159], v[172:175], v[124:127]
    v_mfma_f32_16x16x32_bf16 v[116:119], v[156:159], v[168:171], v[116:119]
    v_mfma_f32_16x16x32_bf16 v[108:111], v[156:159], v[164:167], v[108:111]
    v_mfma_f32_16x16x32_bf16 v[100:103], v[156:159], v[160:163], v[100:103]
    s_waitcnt lgkmcnt(0)
    v_mfma_f32_16x16x32_bf16 v[0:3], v[128:131], v[176:179], v[0:3]
    s_add_u32 m0, s72, 8704
    s_xor_b32 s76, s83, 3932160
    v_mfma_f32_16x16x32_bf16 v[8:11], v[128:131], v[180:183], v[8:11]
    ds_read_b128 v[160:163], v251 offset:52352
    ds_read_b128 v[164:167], v251 offset:56704
    v_mfma_f32_16x16x32_bf16 v[16:19], v[128:131], v[184:187], v[16:19]
    buffer_load_dwordx4 v246, s[40:43], s76 offen offset:0 lds
    v_mfma_f32_16x16x32_bf16 v[24:27], v[128:131], v[188:191], v[24:27]
    v_mfma_f32_16x16x32_bf16 v[28:31], v[132:135], v[188:191], v[28:31]
    buffer_load_dwordx4 v247, s[40:43], s76 offen offset:1056 lds
    s_waitcnt vmcnt(6)
    v_mfma_f32_16x16x32_bf16 v[20:23], v[132:135], v[184:187], v[20:23]
    ds_read_b64_tr_b16 v[144:145], v250 offset:0
    ds_read_b64_tr_b16 v[146:147], v250 offset:512
    v_mfma_f32_16x16x32_bf16 v[12:15], v[132:135], v[180:183], v[12:15]
    buffer_load_dwordx4 v248, s[40:43], s76 offen offset:2112 lds
    v_mfma_f32_16x16x32_bf16 v[4:7], v[132:135], v[176:179], v[4:7]
    ds_read_b64_tr_b16 v[148:149], v250 offset:32
    ds_read_b64_tr_b16 v[150:151], v250 offset:544
    v_mfma_f32_16x16x32_bf16 v[32:35], v[136:139], v[176:179], v[32:35]
    buffer_load_dwordx4 v249, s[40:43], s76 offen offset:3168 lds
    v_mfma_f32_16x16x32_bf16 v[40:43], v[136:139], v[180:183], v[40:43]
    ds_read_b64_tr_b16 v[152:153], v250 offset:64
    ds_read_b64_tr_b16 v[154:155], v250 offset:576
    v_mfma_f32_16x16x32_bf16 v[48:51], v[136:139], v[184:187], v[48:51]
    ds_read_b64_tr_b16 v[156:157], v250 offset:96
    ds_read_b64_tr_b16 v[158:159], v250 offset:608
    v_mfma_f32_16x16x32_bf16 v[56:59], v[136:139], v[188:191], v[56:59]
    v_mfma_f32_16x16x32_bf16 v[60:63], v[140:143], v[188:191], v[60:63]
    v_mfma_f32_16x16x32_bf16 v[52:55], v[140:143], v[184:187], v[52:55]
    v_mfma_f32_16x16x32_bf16 v[44:47], v[140:143], v[180:183], v[44:47]
    v_mfma_f32_16x16x32_bf16 v[36:39], v[140:143], v[176:179], v[36:39]
    s_waitcnt lgkmcnt(0)
    v_mfma_f32_16x16x32_bf16 v[64:67], v[144:147], v[176:179], v[64:67]
    s_add_u32 m0, s72, 0
    s_xor_b32 s76, s83, 3670144
    v_mfma_f32_16x16x32_bf16 v[72:75], v[144:147], v[180:183], v[72:75]
    ds_read_b128 v[168:171], v251 offset:61056
    ds_read_b128 v[172:175], v251 offset:65408
    v_mfma_f32_16x16x32_bf16 v[80:83], v[144:147], v[184:187], v[80:83]
    buffer_load_dwordx4 v246, s[40:43], s76 offen offset:0 lds
    v_mfma_f32_16x16x32_bf16 v[88:91], v[144:147], v[188:191], v[88:91]
    v_mfma_f32_16x16x32_bf16 v[92:95], v[148:151], v[188:191], v[92:95]
    buffer_load_dwordx4 v247, s[40:43], s76 offen offset:1056 lds
    s_waitcnt vmcnt(6)
    v_mfma_f32_16x16x32_bf16 v[84:87], v[148:151], v[184:187], v[84:87]
    ds_read_b64_tr_b16 v[128:129], v250 offset:4352
    ds_read_b64_tr_b16 v[130:131], v250 offset:4864
    v_mfma_f32_16x16x32_bf16 v[76:79], v[148:151], v[180:183], v[76:79]
    buffer_load_dwordx4 v248, s[40:43], s76 offen offset:2112 lds
    v_mfma_f32_16x16x32_bf16 v[68:71], v[148:151], v[176:179], v[68:71]
    ds_read_b64_tr_b16 v[132:133], v250 offset:4384
    ds_read_b64_tr_b16 v[134:135], v250 offset:4896
    v_mfma_f32_16x16x32_bf16 v[96:99], v[152:155], v[176:179], v[96:99]
    buffer_load_dwordx4 v249, s[40:43], s76 offen offset:3168 lds
    v_mfma_f32_16x16x32_bf16 v[104:107], v[152:155], v[180:183], v[104:107]
    ds_read_b64_tr_b16 v[136:137], v250 offset:4416
    ds_read_b64_tr_b16 v[138:139], v250 offset:4928
    v_mfma_f32_16x16x32_bf16 v[112:115], v[152:155], v[184:187], v[112:115]
    ds_read_b64_tr_b16 v[140:141], v250 offset:4448
    ds_read_b64_tr_b16 v[142:143], v250 offset:4960
    v_mfma_f32_16x16x32_bf16 v[120:123], v[152:155], v[188:191], v[120:123]
    v_mfma_f32_16x16x32_bf16 v[124:127], v[156:159], v[188:191], v[124:127]
    v_mfma_f32_16x16x32_bf16 v[116:119], v[156:159], v[184:187], v[116:119]
    v_mfma_f32_16x16x32_bf16 v[108:111], v[156:159], v[180:183], v[108:111]
    v_mfma_f32_16x16x32_bf16 v[100:103], v[156:159], v[176:179], v[100:103]
    s_waitcnt lgkmcnt(0)
    v_mfma_f32_16x16x32_bf16 v[0:3], v[128:131], v[160:163], v[0:3]
    s_add_u32 m0, s72, 4352
    s_xor_b32 s76, s83, 3932288
    v_mfma_f32_16x16x32_bf16 v[8:11], v[128:131], v[164:167], v[8:11]
    ds_read_b128 v[176:179], v251 offset:52416
    ds_read_b128 v[180:183], v251 offset:56768
    v_mfma_f32_16x16x32_bf16 v[16:19], v[128:131], v[168:171], v[16:19]
    buffer_load_dwordx4 v246, s[40:43], s76 offen offset:0 lds
    v_mfma_f32_16x16x32_bf16 v[24:27], v[128:131], v[172:175], v[24:27]
    ds_read_b128 v[184:187], v251 offset:61120
    ds_read_b128 v[188:191], v251 offset:65472
    v_mfma_f32_16x16x32_bf16 v[28:31], v[132:135], v[172:175], v[28:31]
    buffer_load_dwordx4 v247, s[40:43], s76 offen offset:1056 lds
    s_waitcnt vmcnt(6)
    v_mfma_f32_16x16x32_bf16 v[20:23], v[132:135], v[168:171], v[20:23]
    ds_read_b64_tr_b16 v[144:145], v250 offset:8704
    ds_read_b64_tr_b16 v[146:147], v250 offset:9216
    v_mfma_f32_16x16x32_bf16 v[12:15], v[132:135], v[164:167], v[12:15]
    buffer_load_dwordx4 v248, s[40:43], s76 offen offset:2112 lds
    v_mfma_f32_16x16x32_bf16 v[4:7], v[132:135], v[160:163], v[4:7]
    ds_read_b64_tr_b16 v[148:149], v250 offset:8736
    ds_read_b64_tr_b16 v[150:151], v250 offset:9248
    v_mfma_f32_16x16x32_bf16 v[32:35], v[136:139], v[160:163], v[32:35]
    buffer_load_dwordx4 v249, s[40:43], s76 offen offset:3168 lds
    v_mfma_f32_16x16x32_bf16 v[40:43], v[136:139], v[164:167], v[40:43]
    ds_read_b64_tr_b16 v[152:153], v250 offset:8768
    ds_read_b64_tr_b16 v[154:155], v250 offset:9280
    v_mfma_f32_16x16x32_bf16 v[48:51], v[136:139], v[168:171], v[48:51]
    ds_read_b64_tr_b16 v[156:157], v250 offset:8800
    ds_read_b64_tr_b16 v[158:159], v250 offset:9312
    v_mfma_f32_16x16x32_bf16 v[56:59], v[136:139], v[172:175], v[56:59]
    v_mfma_f32_16x16x32_bf16 v[60:63], v[140:143], v[172:175], v[60:63]
    v_mfma_f32_16x16x32_bf16 v[52:55], v[140:143], v[168:171], v[52:55]
    v_mfma_f32_16x16x32_bf16 v[44:47], v[140:143], v[164:167], v[44:47]
    v_mfma_f32_16x16x32_bf16 v[36:39], v[140:143], v[160:163], v[36:39]
    s_waitcnt lgkmcnt(0)
    s_cmp_eq_u32 s64, 0
    s_cbranch_scc0 L_QA
    s_waitcnt vmcnt(4)
    s_barrier
    v_mfma_f32_16x16x32_bf16 v[0:3], v[144:147], v[176:179], v[0:3]
    v_mfma_f32_16x16x32_bf16 v[8:11], v[144:147], v[180:183], v[8:11]
    v_mfma_f32_16x16x32_bf16 v[16:19], v[144:147], v[184:187], v[16:19]
    v_mfma_f32_16x16x32_bf16 v[24:27], v[144:147], v[188:191], v[24:27]
    v_mfma_f32_16x16x32_bf16 v[28:31], v[148:151], v[188:191], v[28:31]
    v_mfma_f32_16x16x32_bf16 v[20:23], v[148:151], v[184:187], v[20:23]
    ds_read_b64_tr_b16 v[128:129], v250 offset:0
    ds_read_b64_tr_b16 v[130:131], v250 offset:512
    v_mfma_f32_16x16x32_bf16 v[12:15], v[148:151], v[180:183], v[12:15]
    v_mfma_f32_16x16x32_bf16 v[4:7], v[148:151], v[176:179], v[4:7]
    ds_read_b64_tr_b16 v[132:133], v250 offset:32
    ds_read_b64_tr_b16 v[134:135], v250 offset:544
    v_mfma_f32_16x16x32_bf16 v[32:35], v[152:155], v[176:179], v[32:35]
    v_mfma_f32_16x16x32_bf16 v[40:43], v[152:155], v[180:183], v[40:43]
    ds_read_b64_tr_b16 v[136:137], v250 offset:64
    ds_read_b64_tr_b16 v[138:139], v250 offset:576
    v_mfma_f32_16x16x32_bf16 v[48:51], v[152:155], v[184:187], v[48:51]
    ds_read_b64_tr_b16 v[140:141], v250 offset:96
    ds_read_b64_tr_b16 v[142:143], v250 offset:608
    v_mfma_f32_16x16x32_bf16 v[56:59], v[152:155], v[188:191], v[56:59]
    v_mfma_f32_16x16x32_bf16 v[60:63], v[156:159], v[188:191], v[60:63]
    v_mfma_f32_16x16x32_bf16 v[52:55], v[156:159], v[184:187], v[52:55]
    v_mfma_f32_16x16x32_bf16 v[44:47], v[156:159], v[180:183], v[44:47]
    v_mfma_f32_16x16x32_bf16 v[36:39], v[156:159], v[176:179], v[36:39]
    s_waitcnt vmcnt(0) lgkmcnt(0)
    v_mfma_f32_16x16x32_bf16 v[64:67], v[128:131], v[160:163], v[64:67]
    v_mfma_f32_16x16x32_bf16 v[72:75], v[128:131], v[164:167], v[72:75]
    v_mfma_f32_16x16x32_bf16 v[80:83], v[128:131], v[168:171], v[80:83]
    v_mfma_f32_16x16x32_bf16 v[88:91], v[128:131], v[172:175], v[88:91]
    v_mfma_f32_16x16x32_bf16 v[92:95], v[132:135], v[172:175], v[92:95]
    v_mfma_f32_16x16x32_bf16 v[84:87], v[132:135], v[168:171], v[84:87]
    ds_read_b64_tr_b16 v[144:145], v250 offset:4352
    ds_read_b64_tr_b16 v[146:147], v250 offset:4864
    v_mfma_f32_16x16x32_bf16 v[76:79], v[132:135], v[164:167], v[76:79]
    v_mfma_f32_16x16x32_bf16 v[68:71], v[132:135], v[160:163], v[68:71]
    ds_read_b64_tr_b16 v[148:149], v250 offset:4384
    ds_read_b64_tr_b16 v[150:151], v250 offset:4896
    v_mfma_f32_16x16x32_bf16 v[96:99], v[136:139], v[160:163], v[96:99]
    v_mfma_f32_16x16x32_bf16 v[104:107], v[136:139], v[164:167], v[104:107]
    ds_read_b64_tr_b16 v[152:153], v250 offset:4416
    ds_read_b64_tr_b16 v[154:155], v250 offset:4928
    v_mfma_f32_16x16x32_bf16 v[112:115], v[136:139], v[168:171], v[112:115]
    ds_read_b64_tr_b16 v[156:157], v250 offset:4448
    ds_read_b64_tr_b16 v[158:159], v250 offset:4960
    v_mfma_f32_16x16x32_bf16 v[120:123], v[136:139], v[172:175], v[120:123]
    v_mfma_f32_16x16x32_bf16 v[124:127], v[140:143], v[172:175], v[124:127]
    v_mfma_f32_16x16x32_bf16 v[116:119], v[140:143], v[168:171], v[116:119]
    v_mfma_f32_16x16x32_bf16 v[108:111], v[140:143], v[164:167], v[108:111]
    v_mfma_f32_16x16x32_bf16 v[100:103], v[140:143], v[160:163], v[100:103]
    s_waitcnt lgkmcnt(0)
    v_mfma_f32_16x16x32_bf16 v[64:67], v[144:147], v[176:179], v[64:67]
    v_mfma_f32_16x16x32_bf16 v[72:75], v[144:147], v[180:183], v[72:75]
    v_mfma_f32_16x16x32_bf16 v[80:83], v[144:147], v[184:187], v[80:83]
    v_mfma_f32_16x16x32_bf16 v[88:91], v[144:147], v[188:191], v[88:91]
    v_mfma_f32_16x16x32_bf16 v[92:95], v[148:151], v[188:191], v[92:95]
    v_mfma_f32_16x16x32_bf16 v[84:87], v[148:151], v[184:187], v[84:87]
    v_mfma_f32_16x16x32_bf16 v[76:79], v[148:151], v[180:183], v[76:79]
    v_mfma_f32_16x16x32_bf16 v[68:71], v[148:151], v[176:179], v[68:71]
    v_mfma_f32_16x16x32_bf16 v[96:99], v[152:155], v[176:179], v[96:99]
    v_mfma_f32_16x16x32_bf16 v[104:107], v[152:155], v[180:183], v[104:107]
    v_mfma_f32_16x16x32_bf16 v[112:115], v[152:155], v[184:187], v[112:115]
    v_mfma_f32_16x16x32_bf16 v[120:123], v[152:155], v[188:191], v[120:123]
    v_mfma_f32_16x16x32_bf16 v[124:127], v[156:159], v[188:191], v[124:127]
    v_mfma_f32_16x16x32_bf16 v[116:119], v[156:159], v[184:187], v[116:119]
    v_mfma_f32_16x16x32_bf16 v[108:111], v[156:159], v[180:183], v[108:111]
    v_mfma_f32_16x16x32_bf16 v[100:103], v[156:159], v[176:179], v[100:103]
    s_branch L_Qepi
L_QA:
    s_waitcnt vmcnt(4)
    v_mfma_f32_16x16x32_bf16 v[0:3], v[144:147], v[176:179], v[0:3]
    v_mfma_f32_16x16x32_bf16 v[8:11], v[144:147], v[180:183], v[8:11]
    v_mfma_f32_16x16x32_bf16 v[16:19], v[144:147], v[184:187], v[16:19]
    v_mfma_f32_16x16x32_bf16 v[24:27], v[144:147], v[188:191], v[24:27]
    v_mfma_f32_16x16x32_bf16 v[28:31], v[148:151], v[188:191], v[28:31]
    v_mfma_f32_16x16x32_bf16 v[20:23], v[148:151], v[184:187], v[20:23]
    ds_read_b64_tr_b16 v[128:129], v250 offset:0
    ds_read_b64_tr_b16 v[130:131], v250 offset:512
    v_mfma_f32_16x16x32_bf16 v[12:15], v[148:151], v[180:183], v[12:15]
    v_mfma_f32_16x16x32_bf16 v[4:7], v[148:151], v[176:179], v[4:7]
    ds_read_b64_tr_b16 v[132:133], v250 offset:32
    ds_read_b64_tr_b16 v[134:135], v250 offset:544
    v_mfma_f32_16x16x32_bf16 v[32:35], v[152:155], v[176:179], v[32:35]
    v_mfma_f32_16x16x32_bf16 v[40:43], v[152:155], v[180:183], v[40:43]
    ds_read_b64_tr_b16 v[136:137], v250 offset:64
    ds_read_b64_tr_b16 v[138:139], v250 offset:576
    v_mfma_f32_16x16x32_bf16 v[48:51], v[152:155], v[184:187], v[48:51]
    ds_read_b64_tr_b16 v[140:141], v250 offset:96
    ds_read_b64_tr_b16 v[142:143], v250 offset:608
    v_mfma_f32_16x16x32_bf16 v[56:59], v[152:155], v[188:191], v[56:59]
    v_mfma_f32_16x16x32_bf16 v[60:63], v[156:159], v[188:191], v[60:63]
    v_mfma_f32_16x16x32_bf16 v[52:55], v[156:159], v[184:187], v[52:55]
    v_mfma_f32_16x16x32_bf16 v[44:47], v[156:159], v[180:183], v[44:47]
    v_mfma_f32_16x16x32_bf16 v[36:39], v[156:159], v[176:179], v[36:39]
    s_waitcnt vmcnt(0) lgkmcnt(0)
    s_barrier
    v_mfma_f32_16x16x32_bf16 v[64:67], v[128:131], v[160:163], v[64:67]
    v_mfma_f32_16x16x32_bf16 v[72:75], v[128:131], v[164:167], v[72:75]
    v_mfma_f32_16x16x32_bf16 v[80:83], v[128:131], v[168:171], v[80:83]
    v_mfma_f32_16x16x32_bf16 v[88:91], v[128:131], v[172:175], v[88:91]
    v_mfma_f32_16x16x32_bf16 v[92:95], v[132:135], v[172:175], v[92:95]
    v_mfma_f32_16x16x32_bf16 v[84:87], v[132:135], v[168:171], v[84:87]
    ds_read_b64_tr_b16 v[144:145], v250 offset:4352
    ds_read_b64_tr_b16 v[146:147], v250 offset:4864
    v_mfma_f32_16x16x32_bf16 v[76:79], v[132:135], v[164:167], v[76:79]
    v_mfma_f32_16x16x32_bf16 v[68:71], v[132:135], v[160:163], v[68:71]
    ds_read_b64_tr_b16 v[148:149], v250 offset:4384
    ds_read_b64_tr_b16 v[150:151], v250 offset:4896
    v_mfma_f32_16x16x32_bf16 v[96:99], v[136:139], v[160:163], v[96:99]
    v_mfma_f32_16x16x32_bf16 v[104:107], v[136:139], v[164:167], v[104:107]
    ds_read_b64_tr_b16 v[152:153], v250 offset:4416
    ds_read_b64_tr_b16 v[154:155], v250 offset:4928
    v_mfma_f32_16x16x32_bf16 v[112:115], v[136:139], v[168:171], v[112:115]
    ds_read_b64_tr_b16 v[156:157], v250 offset:4448
    ds_read_b64_tr_b16 v[158:159], v250 offset:4960
    v_mfma_f32_16x16x32_bf16 v[120:123], v[136:139], v[172:175], v[120:123]
    v_mfma_f32_16x16x32_bf16 v[124:127], v[140:143], v[172:175], v[124:127]
    v_mfma_f32_16x16x32_bf16 v[116:119], v[140:143], v[168:171], v[116:119]
    v_mfma_f32_16x16x32_bf16 v[108:111], v[140:143], v[164:167], v[108:111]
    v_mfma_f32_16x16x32_bf16 v[100:103], v[140:143], v[160:163], v[100:103]
    s_waitcnt lgkmcnt(0)
    v_mfma_f32_16x16x32_bf16 v[64:67], v[144:147], v[176:179], v[64:67]
    v_mfma_f32_16x16x32_bf16 v[72:75], v[144:147], v[180:183], v[72:75]
    v_mfma_f32_16x16x32_bf16 v[80:83], v[144:147], v[184:187], v[80:83]
    v_mfma_f32_16x16x32_bf16 v[88:91], v[144:147], v[188:191], v[88:91]
    v_mfma_f32_16x16x32_bf16 v[92:95], v[148:151], v[188:191], v[92:95]
    v_mfma_f32_16x16x32_bf16 v[84:87], v[148:151], v[184:187], v[84:87]
    v_mfma_f32_16x16x32_bf16 v[76:79], v[148:151], v[180:183], v[76:79]
    v_mfma_f32_16x16x32_bf16 v[68:71], v[148:151], v[176:179], v[68:71]
    v_mfma_f32_16x16x32_bf16 v[96:99], v[152:155], v[176:179], v[96:99]
    v_mfma_f32_16x16x32_bf16 v[104:107], v[152:155], v[180:183], v[104:107]
    v_mfma_f32_16x16x32_bf16 v[112:115], v[152:155], v[184:187], v[112:115]
    v_mfma_f32_16x16x32_bf16 v[120:123], v[152:155], v[188:191], v[120:123]
    v_mfma_f32_16x16x32_bf16 v[124:127], v[156:159], v[188:191], v[124:127]
    v_mfma_f32_16x16x32_bf16 v[116:119], v[156:159], v[184:187], v[116:119]
    v_mfma_f32_16x16x32_bf16 v[108:111], v[156:159], v[180:183], v[108:111]
    v_mfma_f32_16x16x32_bf16 v[100:103], v[156:159], v[176:179], v[100:103]
L_Qepi:
    v_mov_b32 v254, 0x3e0293ee
    v_mov_b32 v255, 0x3e0293ee
    v_pk_mul_f32 v[0:1], v[0:1], v[254:255]
    v_pk_mul_f32 v[2:3], v[2:3], v[254:255]
    v_pk_mul_f32 v[4:5], v[4:5], v[254:255]
    v_pk_mul_f32 v[6:7], v[6:7], v[254:255]
    v_cvt_pk_bf16_f32 v128, v0, v1
    v_cvt_pk_bf16_f32 v129, v2, v3
    v_cvt_pk_bf16_f32 v130, v4, v5
    v_cvt_pk_bf16_f32 v131, v6, v7
    v_pk_mul_f32 v[8:9], v[8:9], v[254:255]
    v_pk_mul_f32 v[10:11], v[10:11], v[254:255]
    v_pk_mul_f32 v[12:13], v[12:13], v[254:255]
    v_pk_mul_f32 v[14:15], v[14:15], v[254:255]
    v_permlane16_swap_b32 v128, v130
    v_permlane16_swap_b32 v129, v131
    v_cvt_pk_bf16_f32 v144, v8, v9
    v_cvt_pk_bf16_f32 v145, v10, v11
    v_cvt_pk_bf16_f32 v146, v12, v13
    v_cvt_pk_bf16_f32 v147, v14, v15
    v_pk_mul_f32 v[16:17], v[16:17], v[254:255]
    v_pk_mul_f32 v[18:19], v[18:19], v[254:255]
    v_pk_mul_f32 v[20:21], v[20:21], v[254:255]
    v_pk_mul_f32 v[22:23], v[22:23], v[254:255]
    v_permlane16_swap_b32 v144, v146
    v_permlane16_swap_b32 v145, v147
    v_cvt_pk_bf16_f32 v160, v16, v17
    v_cvt_pk_bf16_f32 v161, v18, v19
    v_cvt_pk_bf16_f32 v162, v20, v21
    v_cvt_pk_bf16_f32 v163, v22, v23
    v_pk_mul_f32 v[24:25], v[24:25], v[254:255]
    v_pk_mul_f32 v[26:27], v[26:27], v[254:255]
    v_pk_mul_f32 v[28:29], v[28:29], v[254:255]
    v_pk_mul_f32 v[30:31], v[30:31], v[254:255]
    v_permlane16_swap_b32 v160, v162
    v_permlane16_swap_b32 v161, v163
    v_cvt_pk_bf16_f32 v176, v24, v25
    v_cvt_pk_bf16_f32 v177, v26, v27
    v_cvt_pk_bf16_f32 v178, v28, v29
    v_cvt_pk_bf16_f32 v179, v30, v31
    v_pk_mul_f32 v[32:33], v[32:33], v[254:255]
    v_pk_mul_f32 v[34:35], v[34:35], v[254:255]
    v_pk_mul_f32 v[36:37], v[36:37], v[254:255]
    v_pk_mul_f32 v[38:39], v[38:39], v[254:255]
    v_permlane16_swap_b32 v176, v178
    v_permlane16_swap_b32 v177, v179
    v_cvt_pk_bf16_f32 v132, v32, v33
    v_cvt_pk_bf16_f32 v133, v34, v35
    v_cvt_pk_bf16_f32 v134, v36, v37
    v_cvt_pk_bf16_f32 v135, v38, v39
    v_pk_mul_f32 v[40:41], v[40:41], v[254:255]
    v_pk_mul_f32 v[42:43], v[42:43], v[254:255]
    v_pk_mul_f32 v[44:45], v[44:45], v[254:255]
    v_pk_mul_f32 v[46:47], v[46:47], v[254:255]
    v_permlane16_swap_b32 v132, v134
    v_permlane16_swap_b32 v133, v135
    v_cvt_pk_bf16_f32 v148, v40, v41
    v_cvt_pk_bf16_f32 v149, v42, v43
    v_cvt_pk_bf16_f32 v150, v44, v45
    v_cvt_pk_bf16_f32 v151, v46, v47
    v_pk_mul_f32 v[48:49], v[48:49], v[254:255]
    v_pk_mul_f32 v[50:51], v[50:51], v[254:255]
    v_pk_mul_f32 v[52:53], v[52:53], v[254:255]
    v_pk_mul_f32 v[54:55], v[54:55], v[254:255]
    v_permlane16_swap_b32 v148, v150
    v_permlane16_swap_b32 v149, v151
    v_cvt_pk_bf16_f32 v164, v48, v49
    v_cvt_pk_bf16_f32 v165, v50, v51
    v_cvt_pk_bf16_f32 v166, v52, v53
    v_cvt_pk_bf16_f32 v167, v54, v55
    v_pk_mul_f32 v[56:57], v[56:57], v[254:255]
    v_pk_mul_f32 v[58:59], v[58:59], v[254:255]
    v_pk_mul_f32 v[60:61], v[60:61], v[254:255]
    v_pk_mul_f32 v[62:63], v[62:63], v[254:255]
    v_permlane16_swap_b32 v164, v166
    v_permlane16_swap_b32 v165, v167
    v_cvt_pk_bf16_f32 v180, v56, v57
    v_cvt_pk_bf16_f32 v181, v58, v59
    v_cvt_pk_bf16_f32 v182, v60, v61
    v_cvt_pk_bf16_f32 v183, v62, v63
    v_pk_mul_f32 v[64:65], v[64:65], v[254:255]
    v_pk_mul_f32 v[66:67], v[66:67], v[254:255]
    v_pk_mul_f32 v[68:69], v[68:69], v[254:255]
    v_pk_mul_f32 v[70:71], v[70:71], v[254:255]
    v_permlane16_swap_b32 v180, v182
    v_permlane16_swap_b32 v181, v183
    v_cvt_pk_bf16_f32 v136, v64, v65
    v_cvt_pk_bf16_f32 v137, v66, v67
    v_cvt_pk_bf16_f32 v138, v68, v69
    v_cvt_pk_bf16_f32 v139, v70, v71
    v_pk_mul_f32 v[72:73], v[72:73], v[254:255]
    v_pk_mul_f32 v[74:75], v[74:75], v[254:255]
    v_pk_mul_f32 v[76:77], v[76:77], v[254:255]
    v_pk_mul_f32 v[78:79], v[78:79], v[254:255]
    v_permlane16_swap_b32 v136, v138
    v_permlane16_swap_b32 v137, v139
    v_cvt_pk_bf16_f32 v152, v72, v73
    v_cvt_pk_bf16_f32 v153, v74, v75
    v_cvt_pk_bf16_f32 v154, v76, v77
    v_cvt_pk_bf16_f32 v155, v78, v79
    v_pk_mul_f32 v[80:81], v[80:81], v[254:255]
    v_pk_mul_f32 v[82:83], v[82:83], v[254:255]
    v_pk_mul_f32 v[84:85], v[84:85], v[254:255]
    v_pk_mul_f32 v[86:87], v[86:87], v[254:255]
    v_permlane16_swap_b32 v152, v154
    v_permlane16_swap_b32 v153, v155
    v_cvt_pk_bf16_f32 v168, v80, v81
    v_cvt_pk_bf16_f32 v169, v82, v83
    v_cvt_pk_bf16_f32 v170, v84, v85
    v_cvt_pk_bf16_f32 v171, v86, v87
    v_pk_mul_f32 v[88:89], v[88:89], v[254:255]
    v_pk_mul_f32 v[90:91], v[90:91], v[254:255]
    v_pk_mul_f32 v[92:93], v[92:93], v[254:255]
    v_pk_mul_f32 v[94:95], v[94:95], v[254:255]
    v_permlane16_swap_b32 v168, v170
    v_permlane16_swap_b32 v169, v171
    v_cvt_pk_bf16_f32 v184, v88, v89
    v_cvt_pk_bf16_f32 v185, v90, v91
    v_cvt_pk_bf16_f32 v186, v92, v93
    v_cvt_pk_bf16_f32 v187, v94, v95
    v_pk_mul_f32 v[96:97], v[96:97], v[254:255]
    v_pk_mul_f32 v[98:99], v[98:99], v[254:255]
    v_pk_mul_f32 v[100:101], v[100:101], v[254:255]
    v_pk_mul_f32 v[102:103], v[102:103], v[254:255]
    v_permlane16_swap_b32 v184, v186
    v_permlane16_swap_b32 v185, v187
    v_cvt_pk_bf16_f32 v140, v96, v97
    v_cvt_pk_bf16_f32 v141, v98, v99
    v_cvt_pk_bf16_f32 v142, v100, v101
    v_cvt_pk_bf16_f32 v143, v102, v103
    v_pk_mul_f32 v[104:105], v[104:105], v[254:255]
    v_pk_mul_f32 v[106:107], v[106:107], v[254:255]
    v_pk_mul_f32 v[108:109], v[108:109], v[254:255]
    v_pk_mul_f32 v[110:111], v[110:111], v[254:255]
    v_permlane16_swap_b32 v140, v142
    v_permlane16_swap_b32 v141, v143
    v_cvt_pk_bf16_f32 v156, v104, v105
    v_cvt_pk_bf16_f32 v157, v106, v107
    v_cvt_pk_bf16_f32 v158, v108, v109
    v_cvt_pk_bf16_f32 v159, v110, v111
    v_pk_mul_f32 v[112:113], v[112:113], v[254:255]
    v_pk_mul_f32 v[114:115], v[114:115], v[254:255]
    v_pk_mul_f32 v[116:117], v[116:117], v[254:255]
    v_pk_mul_f32 v[118:119], v[118:119], v[254:255]
    v_permlane16_swap_b32 v156, v158
    v_permlane16_swap_b32 v157, v159
    v_cvt_pk_bf16_f32 v172, v112, v113
    v_cvt_pk_bf16_f32 v173, v114, v115
    v_cvt_pk_bf16_f32 v174, v116, v117
    v_cvt_pk_bf16_f32 v175, v118, v119
    v_pk_mul_f32 v[120:121], v[120:121], v[254:255]
    v_pk_mul_f32 v[122:123], v[122:123], v[254:255]
    v_pk_mul_f32 v[124:125], v[124:125], v[254:255]
    v_pk_mul_f32 v[126:127], v[126:127], v[254:255]
    v_permlane16_swap_b32 v172, v174
    v_permlane16_swap_b32 v173, v175
    v_cvt_pk_bf16_f32 v188, v120, v121
    v_cvt_pk_bf16_f32 v189, v122, v123
    v_cvt_pk_bf16_f32 v190, v124, v125
    v_cvt_pk_bf16_f32 v191, v126, v127
    s_mov_b32 s69, 0
    s_cmp_eq_u32 s64, 0
    v_permlane16_swap_b32 v188, v190
    v_permlane16_swap_b32 v189, v191
    s_cbranch_scc0 L_Aattn
    v_mov_b64 v[0:1], 0
    v_mov_b64 v[2:3], 0
    v_mov_b64 v[4:5], 0
    v_mov_b64 v[6:7], 0
    v_mov_b64 v[8:9], 0
    v_mov_b64 v[10:11], 0
    v_mov_b64 v[12:13], 0
    v_mov_b64 v[14:15], 0
    v_mov_b64 v[16:17], 0
    v_mov_b64 v[18:19], 0
    v_mov_b64 v[20:21], 0
    v_mov_b64 v[22:23], 0
    v_mov_b64 v[24:25], 0
    v_mov_b64 v[26:27], 0
    v_mov_b64 v[28:29], 0
    v_mov_b64 v[30:31], 0
    v_mov_b64 v[32:33], 0
    v_mov_b64 v[34:35], 0
    v_mov_b64 v[36:37], 0
    v_mov_b64 v[38:39], 0
    v_mov_b64 v[40:41], 0
    v_mov_b64 v[42:43], 0
    v_mov_b64 v[44:45], 0
    v_mov_b64 v[46:47], 0
    v_mov_b64 v[48:49], 0
    v_mov_b64 v[50:51], 0
    v_mov_b64 v[52:53], 0
    v_mov_b64 v[54:55], 0
    v_mov_b64 v[56:57], 0
    v_mov_b64 v[58:59], 0
    v_mov_b64 v[60:61], 0
    v_mov_b64 v[62:63], 0
    v_mov_b64 v[64:65], 0
    v_mov_b64 v[66:67], 0
    v_mov_b64 v[68:69], 0
    v_mov_b64 v[70:71], 0
    v_mov_b64 v[72:73], 0
    v_mov_b64 v[74:75], 0
    v_mov_b64 v[76:77], 0
    v_mov_b64 v[78:79], 0
    v_mov_b64 v[80:81], 0
    v_mov_b64 v[82:83], 0
    v_mov_b64 v[84:85], 0
    v_mov_b64 v[86:87], 0
    v_mov_b64 v[88:89], 0
    v_mov_b64 v[90:91], 0
    v_mov_b64 v[92:93], 0
    v_mov_b64 v[94:95], 0
    v_mov_b64 v[96:97], 0
    v_mov_b64 v[98:99], 0
    v_mov_b64 v[100:101], 0
    v_mov_b64 v[102:103], 0
    v_mov_b64 v[104:105], 0
    v_mov_b64 v[106:107], 0
    v_mov_b64 v[108:109], 0
    v_mov_b64 v[110:111], 0
    v_mov_b64 v[112:113], 0
    v_mov_b64 v[114:115], 0
    v_mov_b64 v[116:117], 0
    v_mov_b64 v[118:119], 0
    v_mov_b64 v[120:121], 0
    v_mov_b64 v[122:123], 0
    v_mov_b64 v[124:125], 0
    v_mov_b64 v[126:127], 0
    v_bfe_u32 v254, v253, 3, 1
    v_lshlrev_b32 v246, 14, v254
    v_bfe_u32 v254, v253, 4, 1
    v_lshl_add_u32 v246, v254, 11, v246
    v_lshrrev_b32 v254, 5, v253
    v_lshl_add_u32 v246, v254, 10, v246
    v_and_b32 v254, 7, v253
    v_lshl_add_u32 v246, v254, 4, v246
    v_add_u32 v249, 9248, v246
    v_add_u32 v248, 6208, v246
    v_add_u32 v247, 3168, v246
    v_add_u32 v246, 128, v246
    v_bfe_u32 v224, v253, 2, 3
    v_lshrrev_b32 v225, 5, v253
    v_lshl_add_u32 v224, v224, 1, v225
    v_mul_u32_u24 v251, 272, v224
    v_and_b32 v224, 3, v253
    v_lshl_add_u32 v251, v224, 3, v251
    v_add_u32 v251, 34816, v251
    v_lshrrev_b32 v254, 4, v253
    v_sub_u32 v255, 0, v254
    v_and_b32 v255, 3, v255
    v_xor_b32 v255, v255, v253
    v_and_b32 v255, 15, v255
    v_lshlrev_b32 v255, 4, v255
    v_lshl_add_u32 v255, v254, 12, v255
    s_bfm_b32 s74, s68, 0
    s_and_b32 s3, s74, 0x3000
    s_andn2_b32 s74, 0x0, s74
    s_or_b32 s3, s3, s74
    s_waitcnt vmcnt(0)
    s_barrier
    s_cmp_eq_u32 s68, 0
    s_cbranch_scc1 L_Bpause
L_Bgo:
    s_cmp_eq_u32 s69, 15
    s_cbranch_scc0 L_noE0
    s_barrier
L_noE0:
    s_waitcnt vmcnt(8)
    ds_read_b128 v[224:227], v242 offset:0
    ds_read_b128 v[228:231], v242 offset:64
    ds_read_b128 v[232:235], v242 offset:128
    s_waitcnt lgkmcnt(2)
    v_mfma_f32_16x16x32_bf16 v[192:195], v[224:227], v[128:131], 0
    v_mfma_f32_16x16x32_bf16 v[200:203], v[224:227], v[144:147], 0
    v_mfma_f32_16x16x32_bf16 v[208:211], v[224:227], v[160:163], 0
    v_mfma_f32_16x16x32_bf16 v[216:219], v[224:227], v[176:179], 0
    ds_read_b128 v[224:227], v242 offset:192
    s_waitcnt lgkmcnt(2)
    v_mfma_f32_16x16x32_bf16 v[192:195], v[228:231], v[132:135], v[192:195]
    v_mfma_f32_16x16x32_bf16 v[200:203], v[228:231], v[148:151], v[200:203]
    v_mfma_f32_16x16x32_bf16 v[208:211], v[228:231], v[164:167], v[208:211]
    v_mfma_f32_16x16x32_bf16 v[216:219], v[228:231], v[180:183], v[216:219]
    ds_read_b128 v[228:231], v242 offset:512
    s_waitcnt lgkmcnt(2)
    v_mfma_f32_16x16x32_bf16 v[192:195], v[232:235], v[136:139], v[192:195]
    v_mfma_f32_16x16x32_bf16 v[200:203], v[232:235], v[152:155], v[200:203]
    v_mfma_f32_16x16x32_bf16 v[208:211], v[232:235], v[168:171], v[208:211]
    v_mfma_f32_16x16x32_bf16 v[216:219], v[232:235], v[184:187], v[216:219]
    ds_read_b128 v[232:235], v242 offset:576
    s_waitcnt lgkmcnt(2)
    v_mfma_f32_16x16x32_bf16 v[192:195], v[224:227], v[140:143], v[192:195]
    v_mfma_f32_16x16x32_bf16 v[200:203], v[224:227], v[156:159], v[200:203]
    v_mfma_f32_16x16x32_bf16 v[208:211], v[224:227], v[172:175], v[208:211]
    v_mfma_f32_16x16x32_bf16 v[216:219], v[224:227], v[188:191], v[216:219]
    ds_read_b128 v[224:227], v242 offset:640
    s_waitcnt lgkmcnt(2)
    v_mfma_f32_16x16x32_bf16 v[196:199], v[228:231], v[128:131], 0
    v_mfma_f32_16x16x32_bf16 v[204:207], v[228:231], v[144:147], 0
    v_mfma_f32_16x16x32_bf16 v[212:215], v[228:231], v[160:163], 0
    v_mfma_f32_16x16x32_bf16 v[220:223], v[228:231], v[176:179], 0
    v_exp_f32 v192, v192
    ds_read_b128 v[228:231], v242 offset:704
    s_waitcnt lgkmcnt(2)
    v_mfma_f32_16x16x32_bf16 v[196:199], v[232:235], v[132:135], v[196:199]
    v_exp_f32 v193, v193
    v_mfma_f32_16x16x32_bf16 v[204:207], v[232:235], v[148:151], v[204:207]
    v_exp_f32 v194, v194
    v_mfma_f32_16x16x32_bf16 v[212:215], v[232:235], v[164:167], v[212:215]
    v_exp_f32 v195, v195
    v_mfma_f32_16x16x32_bf16 v[220:223], v[232:235], v[180:183], v[220:223]
    v_exp_f32 v200, v200
    s_waitcnt lgkmcnt(1)
    v_mfma_f32_16x16x32_bf16 v[196:199], v[224:227], v[136:139], v[196:199]
    v_exp_f32 v201, v201
    v_mfma_f32_16x16x32_bf16 v[204:207], v[224:227], v[152:155], v[204:207]
    v_exp_f32 v202, v202
    v_mfma_f32_16x16x32_bf16 v[212:215], v[224:227], v[168:171], v[212:215]
    v_exp_f32 v203, v203
    v_mfma_f32_16x16x32_bf16 v[220:223], v[224:227], v[184:187], v[220:223]
    v_exp_f32 v208, v208
    s_waitcnt lgkmcnt(0)
    v_mfma_f32_16x16x32_bf16 v[196:199], v[228:231], v[140:143], v[196:199]
    v_exp_f32 v209, v209
    v_mfma_f32_16x16x32_bf16 v[204:207], v[228:231], v[156:159], v[204:207]
    v_exp_f32 v210, v210
    v_mfma_f32_16x16x32_bf16 v[212:215], v[228:231], v[172:175], v[212:215]
    v_exp_f32 v211, v211
    v_mfma_f32_16x16x32_bf16 v[220:223], v[228:231], v[188:191], v[220:223]
    v_exp_f32 v216, v216
    s_cmp_eq_u32 s69, 15
    s_cbranch_scc1 L_Blast
    v_exp_f32 v217, v217
    v_exp_f32 v218, v218
    v_exp_f32 v219, v219
    v_cvt_pk_bf16_f32 v192, v192, v193
    v_cvt_pk_bf16_f32 v193, v194, v195
    v_cvt_pk_bf16_f32 v200, v200, v201
    v_cvt_pk_bf16_f32 v201, v202, v203
    v_cvt_pk_bf16_f32 v208, v208, v209
    v_cvt_pk_bf16_f32 v209, v210, v211
    v_cvt_pk_bf16_f32 v216, v216, v217
    v_cvt_pk_bf16_f32 v217, v218, v219
    s_add_u32 s70, s70, 8192
    s_and_b32 s70, s70, 0x1ffff
    s_add_u32 s69, s69, 1
    s_cmp_eq_u32 s69, s81
    s_cbranch_scc1 L_Bx0
    s_bitcmp1_b32 s3, s69
    s_cbranch_scc1 L_tk
    s_add_u32 s71, s70, 4096
    s_add_u32 m0, s73, 0
    s_waitcnt vmcnt(7)
    buffer_load_dwordx4 v244, s[32:35], s70 offen offset:0 nt lds
    s_add_u32 m0, s73, 4352
    s_waitcnt vmcnt(7)
    buffer_load_dwordx4 v244, s[32:35], s71 offen offset:0 nt lds
    s_add_u32 m0, s73, 128
    s_waitcnt vmcnt(7)
    buffer_load_dwordx4 v244, s[32:35], s70 offen offset:2048 nt lds
    s_add_u32 m0, s73, 4480
    s_waitcnt vmcnt(7)
    buffer_load_dwordx4 v244, s[32:35], s71 offen offset:2048 nt lds
    s_add_u32 m0, s73, 64
    s_waitcnt vmcnt(7)
    buffer_load_dwordx4 v244, s[32:35], s70 offen offset:1024 nt lds
    s_add_u32 m0, s73, 4416
    s_waitcnt vmcnt(7)
    buffer_load_dwordx4 v244, s[32:35], s71 offen offset:1024 nt lds
    s_add_u32 m0, s73, 192
    s_waitcnt vmcnt(7)
    buffer_load_dwordx4 v244, s[32:35], s70 offen offset:3072 nt lds
    s_add_u32 m0, s73, 4544
    s_waitcnt vmcnt(7)
    buffer_load_dwordx4 v244, s[32:35], s71 offen offset:3072 nt lds
L_lkb:
    s_waitcnt vmcnt(8)
L_Bpv:
    ds_read_b64_tr_b16 v[224:225], v243 offset:0
    ds_read_b64_tr_b16 v[226:227], v243 offset:512
    ds_read_b64_tr_b16 v[228:229], v243 offset:32
    ds_read_b64_tr_b16 v[230:231], v243 offset:544
    ds_read_b64_tr_b16 v[232:233], v243 offset:64
    ds_read_b64_tr_b16 v[234:235], v243 offset:576
    v_exp_f32 v196, v196
    v_exp_f32 v197, v197
    v_exp_f32 v198, v198
    v_exp_f32 v199, v199
    v_cvt_pk_bf16_f32 v194, v196, v197
    v_cvt_pk_bf16_f32 v195, v198, v199
    ds_read_b64_tr_b16 v[196:197], v243 offset:96
    ds_read_b64_tr_b16 v[198:199], v243 offset:608
    s_waitcnt lgkmcnt(6)
    v_mfma_f32_16x16x32_bf16 v[0:3], v[192:195], v[224:227], v[0:3]
    v_exp_f32 v204, v204
    v_exp_f32 v205, v205
    v_mfma_f32_4x4x4_16b_bf16 v[236:239], v[240:241], v[192:193], v[236:239] cbsz:2 abid:0
    s_waitcnt lgkmcnt(4)
    v_mfma_f32_16x16x32_bf16 v[4:7], v[192:195], v[228:231], v[4:7]
    v_exp_f32 v206, v206
    v_exp_f32 v207, v207
    s_waitcnt lgkmcnt(2)
    v_mfma_f32_16x16x32_bf16 v[32:35], v[192:195], v[232:235], v[32:35]
    v_cvt_pk_bf16_f32 v202, v204, v205
    v_cvt_pk_bf16_f32 v203, v206, v207
    v_mfma_f32_4x4x4_16b_bf16 v[236:239], v[240:241], v[194:195], v[236:239] cbsz:2 abid:0
    ds_read_b64_tr_b16 v[204:205], v243 offset:128
    ds_read_b64_tr_b16 v[206:207], v243 offset:640
    v_mfma_f32_16x16x32_bf16 v[8:11], v[200:203], v[224:227], v[8:11]
    v_exp_f32 v212, v212
    v_exp_f32 v213, v213
    v_mfma_f32_4x4x4_16b_bf16 v[236:239], v[240:241], v[200:201], v[236:239] cbsz:2 abid:1
    v_mfma_f32_16x16x32_bf16 v[12:15], v[200:203], v[228:231], v[12:15]
    v_exp_f32 v214, v214
    v_exp_f32 v215, v215
    v_mfma_f32_16x16x32_bf16 v[40:43], v[200:203], v[232:235], v[40:43]
    v_cvt_pk_bf16_f32 v210, v212, v213
    v_cvt_pk_bf16_f32 v211, v214, v215
    v_mfma_f32_4x4x4_16b_bf16 v[236:239], v[240:241], v[202:203], v[236:239] cbsz:2 abid:1
    ds_read_b64_tr_b16 v[212:213], v243 offset:160
    ds_read_b64_tr_b16 v[214:215], v243 offset:672
    v_mfma_f32_16x16x32_bf16 v[16:19], v[208:211], v[224:227], v[16:19]
    v_exp_f32 v220, v220
    v_exp_f32 v221, v221
    v_mfma_f32_4x4x4_16b_bf16 v[236:239], v[240:241], v[208:209], v[236:239] cbsz:2 abid:2
    v_mfma_f32_16x16x32_bf16 v[20:23], v[208:211], v[228:231], v[20:23]
    v_exp_f32 v222, v222
    v_exp_f32 v223, v223
    v_mfma_f32_16x16x32_bf16 v[48:51], v[208:211], v[232:235], v[48:51]
    v_cvt_pk_bf16_f32 v218, v220, v221
    v_cvt_pk_bf16_f32 v219, v222, v223
    v_mfma_f32_4x4x4_16b_bf16 v[236:239], v[240:241], v[210:211], v[236:239] cbsz:2 abid:2
    ds_read_b64_tr_b16 v[220:221], v243 offset:192
    ds_read_b64_tr_b16 v[222:223], v243 offset:704
    v_mfma_f32_16x16x32_bf16 v[24:27], v[216:219], v[224:227], v[24:27]
    v_mfma_f32_4x4x4_16b_bf16 v[236:239], v[240:241], v[216:217], v[236:239] cbsz:2 abid:3
    v_mfma_f32_16x16x32_bf16 v[28:31], v[216:219], v[228:231], v[28:31]
    v_mfma_f32_16x16x32_bf16 v[56:59], v[216:219], v[232:235], v[56:59]
    v_mfma_f32_4x4x4_16b_bf16 v[236:239], v[240:241], v[218:219], v[236:239] cbsz:2 abid:3
    ds_read_b64_tr_b16 v[224:225], v243 offset:224
    ds_read_b64_tr_b16 v[226:227], v243 offset:736
    s_waitcnt lgkmcnt(8)
    v_mfma_f32_16x16x32_bf16 v[60:63], v[216:219], v[196:199], v[60:63]
    v_mfma_f32_16x16x32_bf16 v[52:55], v[208:211], v[196:199], v[52:55]
    v_mfma_f32_16x16x32_bf16 v[44:47], v[200:203], v[196:199], v[44:47]
    v_mfma_f32_16x16x32_bf16 v[36:39], v[192:195], v[196:199], v[36:39]
    s_waitcnt lgkmcnt(6)
    v_mfma_f32_16x16x32_bf16 v[64:67], v[192:195], v[204:207], v[64:67]
    v_mfma_f32_16x16x32_bf16 v[72:75], v[200:203], v[204:207], v[72:75]
    v_mfma_f32_16x16x32_bf16 v[80:83], v[208:211], v[204:207], v[80:83]
    v_mfma_f32_16x16x32_bf16 v[88:91], v[216:219], v[204:207], v[88:91]
    s_waitcnt lgkmcnt(4)
    v_mfma_f32_16x16x32_bf16 v[92:95], v[216:219], v[212:215], v[92:95]
    v_mfma_f32_16x16x32_bf16 v[84:87], v[208:211], v[212:215], v[84:87]
    v_mfma_f32_16x16x32_bf16 v[76:79], v[200:203], v[212:215], v[76:79]
    v_mfma_f32_16x16x32_bf16 v[68:71], v[192:195], v[212:215], v[68:71]
    s_waitcnt lgkmcnt(2)
    v_mfma_f32_16x16x32_bf16 v[96:99], v[192:195], v[220:223], v[96:99]
    v_mfma_f32_16x16x32_bf16 v[104:107], v[200:203], v[220:223], v[104:107]
    v_mfma_f32_16x16x32_bf16 v[112:115], v[208:211], v[220:223], v[112:115]
    v_mfma_f32_16x16x32_bf16 v[120:123], v[216:219], v[220:223], v[120:123]
    s_waitcnt lgkmcnt(0)
    v_mfma_f32_16x16x32_bf16 v[124:127], v[216:219], v[224:227], v[124:127]
    v_mfma_f32_16x16x32_bf16 v[116:119], v[208:211], v[224:227], v[116:119]
    v_mfma_f32_16x16x32_bf16 v[108:111], v[200:203], v[224:227], v[108:111]
    v_mfma_f32_16x16x32_bf16 v[100:103], v[192:195], v[224:227], v[100:103]
    s_cmp_eq_u32 s69, s68
    s_cbranch_scc1 L_Bx
    s_add_u32 s71, s70, 4096
    s_add_u32 m0, s73, 8704
    s_waitcnt vmcnt(7)
    buffer_load_dwordx4 v245, s[36:39], s70 offen offset:0 nt lds
    s_add_u32 m0, s73, 12928
    s_waitcnt vmcnt(7)
    buffer_load_dwordx4 v245, s[36:39], s71 offen offset:0 nt lds
    s_add_u32 m0, s73, 8768
    s_waitcnt vmcnt(7)
    buffer_load_dwordx4 v245, s[36:39], s70 offen offset:2048 nt lds
    s_add_u32 m0, s73, 12992
    s_waitcnt vmcnt(7)
    buffer_load_dwordx4 v245, s[36:39], s71 offen offset:2048 nt lds
    s_add_u32 m0, s73, 8736
    s_waitcnt vmcnt(7)
    buffer_load_dwordx4 v245, s[36:39], s70 offen offset:1024 nt lds
    s_add_u32 m0, s73, 12960
    s_waitcnt vmcnt(7)
    buffer_load_dwordx4 v245, s[36:39], s71 offen offset:1024 nt lds
    s_add_u32 m0, s73, 8800
    s_waitcnt vmcnt(7)
    buffer_load_dwordx4 v245, s[36:39], s70 offen offset:3072 nt lds
    s_add_u32 m0, s73, 13024
    s_waitcnt vmcnt(7)
    buffer_load_dwordx4 v245, s[36:39], s71 offen offset:3072 nt lds
    s_branch L_Bgo
L_tk:
    s_add_u32 s71, s70, 4096
    s_add_u32 m0, s73, 0
    s_waitcnt vmcnt(6)
    buffer_load_dwordx4 v244, s[32:35], s70 offen offset:0 nt lds
    s_add_u32 m0, s73, 4352
    s_waitcnt vmcnt(6)
    buffer_load_dwordx4 v244, s[32:35], s71 offen offset:0 nt lds
    s_add_u32 m0, s73, 128
    s_waitcnt vmcnt(6)
    buffer_load_dwordx4 v244, s[32:35], s70 offen offset:2048 nt lds
    s_add_u32 m0, s73, 4480
    s_waitcnt vmcnt(6)
    buffer_load_dwordx4 v244, s[32:35], s71 offen offset:2048 nt lds
    s_add_u32 m0, s73, 64
    s_waitcnt vmcnt(6)
    buffer_load_dwordx4 v244, s[32:35], s70 offen offset:1024 nt lds
    s_add_u32 m0, s73, 4416
    s_waitcnt vmcnt(6)
    buffer_load_dwordx4 v244, s[32:35], s71 offen offset:1024 nt lds
    s_add_u32 m0, s73, 192
    s_waitcnt vmcnt(6)
    buffer_load_dwordx4 v244, s[32:35], s70 offen offset:3072 nt lds
    s_add_u32 m0, s73, 4544
    s_waitcnt vmcnt(6)
    buffer_load_dwordx4 v244, s[32:35], s71 offen offset:3072 nt lds
    s_branch L_lkb
L_Blast:
L_lastA:
    v_exp_f32 v217, v217
    v_exp_f32 v218, v218
    v_exp_f32 v219, v219
    v_exp_f32 v196, v196
    v_exp_f32 v197, v197
    v_exp_f32 v198, v198
    v_exp_f32 v199, v199
    v_exp_f32 v204, v204
    v_exp_f32 v205, v205
    v_exp_f32 v206, v206
    v_exp_f32 v207, v207
    v_exp_f32 v212, v212
    v_exp_f32 v213, v213
    v_exp_f32 v214, v214
    v_exp_f32 v215, v215
    v_exp_f32 v220, v220
    v_exp_f32 v221, v221
    v_exp_f32 v222, v222
    v_exp_f32 v223, v223
    v_add_f32 v236, v236, v192
    v_add_f32 v237, v237, v200
    v_add_f32 v238, v238, v208
    v_add_f32 v239, v239, v216
    v_add_f32 v236, v236, v193
    v_add_f32 v237, v237, v201
    v_add_f32 v238, v238, v209
    v_add_f32 v239, v239, v217
    v_add_f32 v236, v236, v194
    v_add_f32 v237, v237, v202
    v_add_f32 v238, v238, v210
    v_add_f32 v239, v239, v218
    v_add_f32 v236, v236, v195
    v_add_f32 v237, v237, v203
    v_add_f32 v238, v238, v211
    v_add_f32 v239, v239, v219
    v_add_f32 v236, v236, v196
    v_add_f32 v237, v237, v204
    v_add_f32 v238, v238, v212
    v_add_f32 v239, v239, v220
    v_add_f32 v236, v236, v197
    v_add_f32 v237, v237, v205
    v_add_f32 v238, v238, v213
    v_add_f32 v239, v239, v221
    v_add_f32 v236, v236, v198
    v_add_f32 v237, v237, v206
    v_add_f32 v238, v238, v214
    v_add_f32 v239, v239, v222
    v_add_f32 v236, v236, v199
    v_add_f32 v237, v237, v207
    v_add_f32 v238, v238, v215
    v_add_f32 v239, v239, v223
    v_mov_b32 v224, v236
    v_mov_b32 v225, v237
    v_mov_b32 v226, v238
    v_mov_b32 v227, v239
    v_permlane32_swap_b32 v236, v224
    v_permlane32_swap_b32 v237, v225
    v_permlane32_swap_b32 v238, v226
    v_permlane32_swap_b32 v239, v227
    v_add_f32 v236, v236, v224
    v_add_f32 v237, v237, v225
    v_add_f32 v238, v238, v226
    v_add_f32 v239, v239, v227
    v_mov_b32 v224, v236
    v_mov_b32 v225, v237
    v_mov_b32 v226, v238
    v_mov_b32 v227, v239
    v_permlane16_swap_b32 v236, v224
    v_permlane16_swap_b32 v237, v225
    v_permlane16_swap_b32 v238, v226
    v_permlane16_swap_b32 v239, v227
    v_add_f32 v236, v236, v224
    v_add_f32 v237, v237, v225
    v_add_f32 v238, v238, v226
    v_add_f32 v239, v239, v227
    v_min3_f32 v254, v236, v237, v238
    v_add_f32 v255, v236, v237
    v_min_f32 v254, v254, v239
    v_add_f32 v255, v255, v238
    v_add_f32 v255, v255, v239
    v_cmp_nle_f32 vcc, 0x30800000, v254
    s_cbranch_vccnz L_slow
    v_cmp_nge_f32 vcc, 0x4e800000, v255
    s_cbranch_vccnz L_slow
    v_rcp_f32 v236, v236
    v_rcp_f32 v237, v237
    v_rcp_f32 v238, v238
    v_rcp_f32 v239, v239
    v_and_b32 v255, 48, v253
    ds_bpermute_b32 v160, v255, v236 offset:0
    ds_bpermute_b32 v161, v255, v236 offset:4
    ds_bpermute_b32 v162, v255, v236 offset:8
    ds_bpermute_b32 v163, v255, v236 offset:12
    ds_bpermute_b32 v164, v255, v237 offset:0
    ds_bpermute_b32 v165, v255, v237 offset:4
    ds_bpermute_b32 v166, v255, v237 offset:8
    ds_bpermute_b32 v167, v255, v237 offset:12
    ds_bpermute_b32 v168, v255, v238 offset:0
    ds_bpermute_b32 v169, v255, v238 offset:4
    ds_bpermute_b32 v170, v255, v238 offset:8
    ds_bpermute_b32 v171, v255, v238 offset:12
    ds_bpermute_b32 v172, v255, v239 offset:0
    ds_bpermute_b32 v173, v255, v239 offset:4
    ds_bpermute_b32 v174, v255, v239 offset:8
    ds_bpermute_b32 v175, v255, v239 offset:12
    v_and_b32 v254, 15, v253
    v_mul_u32_u24 v254, 136, v254
    s_mul_i32 s74, s65, 17408
    s_add_u32 s74, s74, 34816
    v_lshrrev_b32 v224, 1, v255
    v_add3_u32 v254, v254, v224, s74
    v_pk_mul_f32 v[192:193], v[192:193], v[236:237] op_sel_hi:[1,0]
    v_pk_mul_f32 v[194:195], v[194:195], v[236:237] op_sel_hi:[1,0]
    v_pk_mul_f32 v[196:197], v[196:197], v[236:237] op_sel_hi:[1,0]
    v_pk_mul_f32 v[198:199], v[198:199], v[236:237] op_sel_hi:[1,0]
    v_pk_mul_f32 v[200:201], v[200:201], v[236:237] op_sel:[0,1]
    v_pk_mul_f32 v[202:203], v[202:203], v[236:237] op_sel:[0,1]
    v_pk_mul_f32 v[204:205], v[204:205], v[236:237] op_sel:[0,1]
    v_pk_mul_f32 v[206:207], v[206:207], v[236:237] op_sel:[0,1]
    v_pk_mul_f32 v[208:209], v[208:209], v[238:239] op_sel_hi:[1,0]
    v_pk_mul_f32 v[210:211], v[210:211], v[238:239] op_sel_hi:[1,0]
    v_pk_mul_f32 v[212:213], v[212:213], v[238:239] op_sel_hi:[1,0]
    v_pk_mul_f32 v[214:215], v[214:215], v[238:239] op_sel_hi:[1,0]
    v_pk_mul_f32 v[216:217], v[216:217], v[238:239] op_sel:[0,1]
    v_pk_mul_f32 v[218:219], v[218:219], v[238:239] op_sel:[0,1]
    v_pk_mul_f32 v[220:221], v[220:221], v[238:239] op_sel:[0,1]
    v_pk_mul_f32 v[222:223], v[222:223], v[238:239] op_sel:[0,1]
    v_cvt_pk_bf16_f32 v192, v192, v193
    v_cvt_pk_bf16_f32 v193, v194, v195
    v_cvt_pk_bf16_f32 v194, v196, v197
    v_cvt_pk_bf16_f32 v195, v198, v199
    v_cvt_pk_bf16_f32 v200, v200, v201
    v_cvt_pk_bf16_f32 v201, v202, v203
    v_cvt_pk_bf16_f32 v202, v204, v205
    v_cvt_pk_bf16_f32 v203, v206, v207
    v_cvt_pk_bf16_f32 v208, v208, v209
    v_cvt_pk_bf16_f32 v209, v210, v211
    v_cvt_pk_bf16_f32 v210, v212, v213
    v_cvt_pk_bf16_f32 v211, v214, v215
    v_cvt_pk_bf16_f32 v216, v216, v217
    v_cvt_pk_bf16_f32 v217, v218, v219
    v_cvt_pk_bf16_f32 v218, v220, v221
    v_cvt_pk_bf16_f32 v219, v222, v223
    s_waitcnt lgkmcnt(0)
    v_pk_mul_f32 v[0:1], v[0:1], v[160:161]
    v_pk_mul_f32 v[2:3], v[2:3], v[162:163]
    v_pk_mul_f32 v[4:5], v[4:5], v[160:161]
    v_pk_mul_f32 v[6:7], v[6:7], v[162:163]
    v_pk_mul_f32 v[8:9], v[8:9], v[164:165]
    v_pk_mul_f32 v[10:11], v[10:11], v[166:167]
    v_pk_mul_f32 v[12:13], v[12:13], v[164:165]
    v_pk_mul_f32 v[14:15], v[14:15], v[166:167]
    v_pk_mul_f32 v[16:17], v[16:17], v[168:169]
    v_pk_mul_f32 v[18:19], v[18:19], v[170:171]
    v_pk_mul_f32 v[20:21], v[20:21], v[168:169]
    v_pk_mul_f32 v[22:23], v[22:23], v[170:171]
    v_pk_mul_f32 v[24:25], v[24:25], v[172:173]
    v_pk_mul_f32 v[26:27], v[26:27], v[174:175]
    v_pk_mul_f32 v[28:29], v[28:29], v[172:173]
    v_pk_mul_f32 v[30:31], v[30:31], v[174:175]
    v_pk_mul_f32 v[32:33], v[32:33], v[160:161]
    v_pk_mul_f32 v[34:35], v[34:35], v[162:163]
    v_pk_mul_f32 v[36:37], v[36:37], v[160:161]
    v_pk_mul_f32 v[38:39], v[38:39], v[162:163]
    v_pk_mul_f32 v[40:41], v[40:41], v[164:165]
    v_pk_mul_f32 v[42:43], v[42:43], v[166:167]
    v_pk_mul_f32 v[44:45], v[44:45], v[164:165]
    v_pk_mul_f32 v[46:47], v[46:47], v[166:167]
    v_pk_mul_f32 v[48:49], v[48:49], v[168:169]
    v_pk_mul_f32 v[50:51], v[50:51], v[170:171]
    v_pk_mul_f32 v[52:53], v[52:53], v[168:169]
    v_pk_mul_f32 v[54:55], v[54:55], v[170:171]
    v_pk_mul_f32 v[56:57], v[56:57], v[172:173]
    v_pk_mul_f32 v[58:59], v[58:59], v[174:175]
    v_pk_mul_f32 v[60:61], v[60:61], v[172:173]
    v_pk_mul_f32 v[62:63], v[62:63], v[174:175]
    v_pk_mul_f32 v[64:65], v[64:65], v[160:161]
    v_pk_mul_f32 v[66:67], v[66:67], v[162:163]
    v_pk_mul_f32 v[68:69], v[68:69], v[160:161]
    v_pk_mul_f32 v[70:71], v[70:71], v[162:163]
    v_pk_mul_f32 v[72:73], v[72:73], v[164:165]
    v_pk_mul_f32 v[74:75], v[74:75], v[166:167]
    v_pk_mul_f32 v[76:77], v[76:77], v[164:165]
    v_pk_mul_f32 v[78:79], v[78:79], v[166:167]
    v_pk_mul_f32 v[80:81], v[80:81], v[168:169]
    v_pk_mul_f32 v[82:83], v[82:83], v[170:171]
    v_pk_mul_f32 v[84:85], v[84:85], v[168:169]
    v_pk_mul_f32 v[86:87], v[86:87], v[170:171]
    v_pk_mul_f32 v[88:89], v[88:89], v[172:173]
    v_pk_mul_f32 v[90:91], v[90:91], v[174:175]
    v_pk_mul_f32 v[92:93], v[92:93], v[172:173]
    v_pk_mul_f32 v[94:95], v[94:95], v[174:175]
    s_waitcnt vmcnt(0)
    ds_read_b64_tr_b16 v[128:129], v243 offset:0
    ds_read_b64_tr_b16 v[130:131], v243 offset:512
    ds_read_b64_tr_b16 v[132:133], v243 offset:32
    ds_read_b64_tr_b16 v[134:135], v243 offset:544
    ds_read_b64_tr_b16 v[136:137], v243 offset:64
    ds_read_b64_tr_b16 v[138:139], v243 offset:576
    ds_read_b64_tr_b16 v[140:141], v243 offset:96
    ds_read_b64_tr_b16 v[142:143], v243 offset:608
    v_pk_mul_f32 v[96:97], v[96:97], v[160:161]
    v_pk_mul_f32 v[98:99], v[98:99], v[162:163]
    v_pk_mul_f32 v[100:101], v[100:101], v[160:161]
    v_pk_mul_f32 v[102:103], v[102:103], v[162:163]
    ds_read_b64_tr_b16 v[144:145], v243 offset:128
    ds_read_b64_tr_b16 v[146:147], v243 offset:640
    v_pk_mul_f32 v[104:105], v[104:105], v[164:165]
    v_pk_mul_f32 v[106:107], v[106:107], v[166:167]
    v_pk_mul_f32 v[108:109], v[108:109], v[164:165]
    v_pk_mul_f32 v[110:111], v[110:111], v[166:167]
    ds_read_b64_tr_b16 v[148:149], v243 offset:160
    ds_read_b64_tr_b16 v[150:151], v243 offset:672
    v_pk_mul_f32 v[112:113], v[112:113], v[168:169]
    v_pk_mul_f32 v[114:115], v[114:115], v[170:171]
    v_pk_mul_f32 v[116:117], v[116:117], v[168:169]
    v_pk_mul_f32 v[118:119], v[118:119], v[170:171]
    ds_read_b64_tr_b16 v[152:153], v243 offset:192
    ds_read_b64_tr_b16 v[154:155], v243 offset:704
    v_pk_mul_f32 v[120:121], v[120:121], v[172:173]
    v_pk_mul_f32 v[122:123], v[122:123], v[174:175]
    v_pk_mul_f32 v[124:125], v[124:125], v[172:173]
    v_pk_mul_f32 v[126:127], v[126:127], v[174:175]
    ds_read_b64_tr_b16 v[156:157], v243 offset:224
    ds_read_b64_tr_b16 v[158:159], v243 offset:736
    s_waitcnt lgkmcnt(0)
    s_cmp_eq_u32 s64, 0
    s_cbranch_scc1 L_nb16
    s_barrier
L_nb16:
    v_mfma_f32_16x16x32_bf16 v[0:3], v[192:195], v[128:131], v[0:3]
    v_mfma_f32_16x16x32_bf16 v[4:7], v[192:195], v[132:135], v[4:7]
    v_mfma_f32_16x16x32_bf16 v[12:15], v[200:203], v[132:135], v[12:15]
    v_mfma_f32_16x16x32_bf16 v[8:11], v[200:203], v[128:131], v[8:11]
    v_mfma_f32_16x16x32_bf16 v[16:19], v[208:211], v[128:131], v[16:19]
    v_mfma_f32_16x16x32_bf16 v[20:23], v[208:211], v[132:135], v[20:23]
    v_mfma_f32_16x16x32_bf16 v[28:31], v[216:219], v[132:135], v[28:31]
    v_mfma_f32_16x16x32_bf16 v[24:27], v[216:219], v[128:131], v[24:27]
    v_mfma_f32_16x16x32_bf16 v[32:35], v[192:195], v[136:139], v[32:35]
    v_cvt_pk_bf16_f32 v0, v0, v1
    v_cvt_pk_bf16_f32 v1, v2, v3
    ds_write_b64 v254, v[0:1] offset:0
    v_mfma_f32_16x16x32_bf16 v[36:39], v[192:195], v[140:143], v[36:39]
    v_cvt_pk_bf16_f32 v4, v4, v5
    v_cvt_pk_bf16_f32 v5, v6, v7
    ds_write_b64 v254, v[4:5] offset:2176
    v_mfma_f32_16x16x32_bf16 v[44:47], v[200:203], v[140:143], v[44:47]
    v_cvt_pk_bf16_f32 v8, v8, v9
    v_cvt_pk_bf16_f32 v9, v10, v11
    ds_write_b64 v254, v[8:9] offset:32
    v_mfma_f32_16x16x32_bf16 v[40:43], v[200:203], v[136:139], v[40:43]
    v_cvt_pk_bf16_f32 v12, v12, v13
    v_cvt_pk_bf16_f32 v13, v14, v15
    ds_write_b64 v254, v[12:13] offset:2208
    v_mfma_f32_16x16x32_bf16 v[48:51], v[208:211], v[136:139], v[48:51]
    v_cvt_pk_bf16_f32 v16, v16, v17
    v_cvt_pk_bf16_f32 v17, v18, v19
    ds_write_b64 v254, v[16:17] offset:64
    v_mfma_f32_16x16x32_bf16 v[52:55], v[208:211], v[140:143], v[52:55]
    v_cvt_pk_bf16_f32 v20, v20, v21
    v_cvt_pk_bf16_f32 v21, v22, v23
    ds_write_b64 v254, v[20:21] offset:2240
    v_mfma_f32_16x16x32_bf16 v[60:63], v[216:219], v[140:143], v[60:63]
    v_cvt_pk_bf16_f32 v24, v24, v25
    v_cvt_pk_bf16_f32 v25, v26, v27
    ds_write_b64 v254, v[24:25] offset:96
    v_mfma_f32_16x16x32_bf16 v[56:59], v[216:219], v[136:139], v[56:59]
    v_cvt_pk_bf16_f32 v28, v28, v29
    v_cvt_pk_bf16_f32 v29, v30, v31
    ds_write_b64 v254, v[28:29] offset:2272
    v_mfma_f32_16x16x32_bf16 v[64:67], v[192:195], v[144:147], v[64:67]
    v_cvt_pk_bf16_f32 v32, v32, v33
    v_cvt_pk_bf16_f32 v33, v34, v35
    ds_write_b64 v254, v[32:33] offset:4352
    v_mfma_f32_16x16x32_bf16 v[68:71], v[192:195], v[148:151], v[68:71]
    v_cvt_pk_bf16_f32 v36, v36, v37
    v_cvt_pk_bf16_f32 v37, v38, v39
    ds_write_b64 v254, v[36:37] offset:6528
    v_mfma_f32_16x16x32_bf16 v[76:79], v[200:203], v[148:151], v[76:79]
    v_cvt_pk_bf16_f32 v40, v40, v41
    v_cvt_pk_bf16_f32 v41, v42, v43
    ds_write_b64 v254, v[40:41] offset:4384
    v_mfma_f32_16x16x32_bf16 v[72:75], v[200:203], v[144:147], v[72:75]
    v_cvt_pk_bf16_f32 v44, v44, v45
    v_cvt_pk_bf16_f32 v45, v46, v47
    ds_write_b64 v254, v[44:45] offset:6560
    v_mfma_f32_16x16x32_bf16 v[80:83], v[208:211], v[144:147], v[80:83]
    v_cvt_pk_bf16_f32 v48, v48, v49
    v_cvt_pk_bf16_f32 v49, v50, v51
    ds_write_b64 v254, v[48:49] offset:4416
    v_mfma_f32_16x16x32_bf16 v[84:87], v[208:211], v[148:151], v[84:87]
    v_cvt_pk_bf16_f32 v52, v52, v53
    v_cvt_pk_bf16_f32 v53, v54, v55
    ds_write_b64 v254, v[52:53] offset:6592
    v_mfma_f32_16x16x32_bf16 v[92:95], v[216:219], v[148:151], v[92:95]
    v_cvt_pk_bf16_f32 v56, v56, v57
    v_cvt_pk_bf16_f32 v57, v58, v59
    ds_write_b64 v254, v[56:57] offset:4448
    v_mfma_f32_16x16x32_bf16 v[88:91], v[216:219], v[144:147], v[88:91]
    v_cvt_pk_bf16_f32 v60, v60, v61
    v_cvt_pk_bf16_f32 v61, v62, v63
    ds_write_b64 v254, v[60:61] offset:6624
    v_mfma_f32_16x16x32_bf16 v[96:99], v[192:195], v[152:155], v[96:99]
    v_cvt_pk_bf16_f32 v64, v64, v65
    v_cvt_pk_bf16_f32 v65, v66, v67
    ds_write_b64 v254, v[64:65] offset:8704
    v_mfma_f32_16x16x32_bf16 v[100:103], v[192:195], v[156:159], v[100:103]
    v_cvt_pk_bf16_f32 v68, v68, v69
    v_cvt_pk_bf16_f32 v69, v70, v71
    ds_write_b64 v254, v[68:69] offset:10880
    v_mfma_f32_16x16x32_bf16 v[108:111], v[200:203], v[156:159], v[108:111]
    v_cvt_pk_bf16_f32 v72, v72, v73
    v_cvt_pk_bf16_f32 v73, v74, v75
    ds_write_b64 v254, v[72:73] offset:8736
    v_mfma_f32_16x16x32_bf16 v[104:107], v[200:203], v[152:155], v[104:107]
    v_cvt_pk_bf16_f32 v76, v76, v77
    v_cvt_pk_bf16_f32 v77, v78, v79
    ds_write_b64 v254, v[76:77] offset:10912
    v_mfma_f32_16x16x32_bf16 v[112:115], v[208:211], v[152:155], v[112:115]
    v_cvt_pk_bf16_f32 v80, v80, v81
    v_cvt_pk_bf16_f32 v81, v82, v83
    ds_write_b64 v254, v[80:81] offset:8768
    v_mfma_f32_16x16x32_bf16 v[116:119], v[208:211], v[156:159], v[116:119]
    v_cvt_pk_bf16_f32 v84, v84, v85
    v_cvt_pk_bf16_f32 v85, v86, v87
    ds_write_b64 v254, v[84:85] offset:10944
    v_mfma_f32_16x16x32_bf16 v[124:127], v[216:219], v[156:159], v[124:127]
    v_cvt_pk_bf16_f32 v88, v88, v89
    v_cvt_pk_bf16_f32 v89, v90, v91
    ds_write_b64 v254, v[88:89] offset:8800
    v_mfma_f32_16x16x32_bf16 v[120:123], v[216:219], v[152:155], v[120:123]
    v_cvt_pk_bf16_f32 v92, v92, v93
    v_cvt_pk_bf16_f32 v93, v94, v95
    ds_write_b64 v254, v[92:93] offset:10976
    v_cvt_pk_bf16_f32 v96, v96, v97
    v_cvt_pk_bf16_f32 v97, v98, v99
    ds_write_b64 v254, v[96:97] offset:13056
    v_cvt_pk_bf16_f32 v100, v100, v101
    v_cvt_pk_bf16_f32 v101, v102, v103
    ds_write_b64 v254, v[100:101] offset:15232
    v_cvt_pk_bf16_f32 v104, v104, v105
    v_cvt_pk_bf16_f32 v105, v106, v107
    ds_write_b64 v254, v[104:105] offset:13088
    v_cvt_pk_bf16_f32 v108, v108, v109
    v_cvt_pk_bf16_f32 v109, v110, v111
    ds_write_b64 v254, v[108:109] offset:15264
    v_cvt_pk_bf16_f32 v112, v112, v113
    v_cvt_pk_bf16_f32 v113, v114, v115
    ds_write_b64 v254, v[112:113] offset:13120
    v_cvt_pk_bf16_f32 v116, v116, v117
    v_cvt_pk_bf16_f32 v117, v118, v119
    ds_write_b64 v254, v[116:117] offset:15296
    v_cvt_pk_bf16_f32 v120, v120, v121
    v_cvt_pk_bf16_f32 v121, v122, v123
    ds_write_b64 v254, v[120:121] offset:13152
    v_cvt_pk_bf16_f32 v124, v124, v125
    v_cvt_pk_bf16_f32 v125, v126, v127
    ds_write_b64 v254, v[124:125] offset:15328
    s_branch L_Owr
L_Bx0:
    s_lshl_b32 s71, s65, 8
    s_add_u32 s71, s71, 0
    s_lshr_b32 s74, s83, 12
    s_xor_b32 s71, s71, s74
    s_add_u32 m0, s73, 0
    s_waitcnt vmcnt(7)
    buffer_load_dwordx4 v255, s[48:51], s71 offen offset:0 nt lds
    s_add_u32 m0, s73, 64
    s_waitcnt vmcnt(7)
    buffer_load_dwordx4 v255, s[48:51], s71 offen offset:1024 nt lds
    s_add_u32 m0, s73, 128
    s_waitcnt vmcnt(7)
    buffer_load_dwordx4 v255, s[48:51], s71 offen offset:2048 nt lds
    s_add_u32 m0, s73, 192
    s_waitcnt vmcnt(7)
    buffer_load_dwordx4 v255, s[48:51], s71 offen offset:3072 nt lds
    s_add_u32 s71, s71, 16384
    s_add_u32 m0, s73, 4352
    s_waitcnt vmcnt(7)
    buffer_load_dwordx4 v255, s[48:51], s71 offen offset:0 nt lds
    s_add_u32 m0, s73, 4416
    s_waitcnt vmcnt(7)
    buffer_load_dwordx4 v255, s[48:51], s71 offen offset:1024 nt lds
    s_add_u32 m0, s73, 4480
    s_waitcnt vmcnt(7)
    buffer_load_dwordx4 v255, s[48:51], s71 offen offset:2048 nt lds
    s_add_u32 m0, s73, 4544
    s_waitcnt vmcnt(7)
    buffer_load_dwordx4 v255, s[48:51], s71 offen offset:3072 nt lds
    s_branch L_lkb
L_Bv:
    s_add_u32 s71, s70, 4096
    s_add_u32 m0, s73, 8704
    s_waitcnt vmcnt(7)
    buffer_load_dwordx4 v245, s[36:39], s70 offen offset:0 nt lds
    s_add_u32 m0, s73, 12928
    s_waitcnt vmcnt(7)
    buffer_load_dwordx4 v245, s[36:39], s71 offen offset:0 nt lds
    s_add_u32 m0, s73, 8768
    s_waitcnt vmcnt(7)
    buffer_load_dwordx4 v245, s[36:39], s70 offen offset:2048 nt lds
    s_add_u32 m0, s73, 12992
    s_waitcnt vmcnt(7)
    buffer_load_dwordx4 v245, s[36:39], s71 offen offset:2048 nt lds
    s_add_u32 m0, s73, 8736
    s_waitcnt vmcnt(7)
    buffer_load_dwordx4 v245, s[36:39], s70 offen offset:1024 nt lds
    s_add_u32 m0, s73, 12960
    s_waitcnt vmcnt(7)
    buffer_load_dwordx4 v245, s[36:39], s71 offen offset:1024 nt lds
    s_add_u32 m0, s73, 8800
    s_waitcnt vmcnt(7)
    buffer_load_dwordx4 v245, s[36:39], s70 offen offset:3072 nt lds
    s_add_u32 m0, s73, 13024
    s_waitcnt vmcnt(7)
    buffer_load_dwordx4 v245, s[36:39], s71 offen offset:3072 nt lds
    s_branch L_Bpause
L_Bx:
    s_cmp_eq_u32 s80, 0
    s_cbranch_scc1 L_Bv
    s_lshl_b32 s71, s65, 8
    s_add_u32 s71, s71, 32768
    s_lshr_b32 s74, s83, 12
    s_xor_b32 s71, s71, s74
    s_add_u32 m0, s73, 8704
    s_waitcnt vmcnt(7)
    buffer_load_dwordx4 v255, s[48:51], s71 offen offset:0 nt lds
    s_add_u32 m0, s73, 8768
    s_waitcnt vmcnt(7)
    buffer_load_dwordx4 v255, s[48:51], s71 offen offset:1024 nt lds
    s_add_u32 m0, s73, 8832
    s_waitcnt vmcnt(7)
    buffer_load_dwordx4 v255, s[48:51], s71 offen offset:2048 nt lds
    s_add_u32 m0, s73, 8896
    s_waitcnt vmcnt(7)
    buffer_load_dwordx4 v255, s[48:51], s71 offen offset:3072 nt lds
    s_add_u32 s71, s71, 16384
    s_add_u32 m0, s73, 13056
    s_waitcnt vmcnt(7)
    buffer_load_dwordx4 v255, s[48:51], s71 offen offset:0 nt lds
    s_add_u32 m0, s73, 13120
    s_waitcnt vmcnt(7)
    buffer_load_dwordx4 v255, s[48:51], s71 offen offset:1024 nt lds
    s_add_u32 m0, s73, 13184
    s_waitcnt vmcnt(7)
    buffer_load_dwordx4 v255, s[48:51], s71 offen offset:2048 nt lds
    s_add_u32 m0, s73, 13248
    s_waitcnt vmcnt(7)
    buffer_load_dwordx4 v255, s[48:51], s71 offen offset:3072 nt lds
L_Bpause:
    s_barrier
    s_cmp_eq_u32 s65, 0
    s_cbranch_scc0 L_nochk
    s_mov_b32 s60, s26
    s_mov_b32 s61, s27
    s_mov_b32 s62, 256
    s_mov_b32 s63, 0x20000
    s_lshl_b32 s71, s67, 3
    s_mov_b64 exec, 1
    s_mov_b32 s75, 0x40000
L_pl5:
    buffer_load_dword v224, off, s[60:63], s71 sc1
    s_waitcnt vmcnt(0)
    v_readfirstlane_b32 s74, v224
    s_cmp_eq_u32 s74, 8
    s_cbranch_scc1 L_pl6
    s_sleep 3
    s_sub_u32 s75, s75, 1
    s_cmp_lg_u32 s75, 0
    s_cbranch_scc1 L_pl5
L_pl6:
    s_mov_b64 exec, -1
L_nochk:
    s_barrier
    s_waitcnt vmcnt(0)
    s_barrier
    s_barrier
    s_barrier
    s_add_u32 m0, s79, 34816
    s_nop 0
    buffer_load_dwordx4 v252, s[56:59], s77 offen offset:0 nt lds
    s_add_u32 m0, m0, s78
    s_nop 0
    buffer_load_dwordx4 v252, s[56:59], s77 offen offset:1024 nt lds
    s_add_u32 m0, m0, s78
    s_nop 0
    buffer_load_dwordx4 v252, s[56:59], s77 offen offset:2048 nt lds
    s_add_u32 m0, m0, s78
    s_nop 0
    buffer_load_dwordx4 v252, s[56:59], s77 offen offset:3072 nt lds
    s_add_u32 s77, s77, 8192
    s_and_b32 s77, s77, 0x1ffff
    s_add_u32 m0, s79, 52224
    s_nop 0
    buffer_load_dwordx4 v252, s[56:59], s77 offen offset:0 nt lds
    s_add_u32 m0, m0, s78
    s_nop 0
    buffer_load_dwordx4 v252, s[56:59], s77 offen offset:1024 nt lds
    s_add_u32 m0, m0, s78
    s_nop 0
    buffer_load_dwordx4 v252, s[56:59], s77 offen offset:2048 nt lds
    s_add_u32 m0, m0, s78
    s_nop 0
    buffer_load_dwordx4 v252, s[56:59], s77 offen offset:3072 nt lds
    s_add_u32 s77, s77, 8192
    s_and_b32 s77, s77, 0x1ffff
    s_waitcnt vmcnt(4)
    s_barrier
    s_add_u32 m0, s79, 69632
    s_nop 0
    buffer_load_dwordx4 v252, s[56:59], s77 offen offset:0 nt lds
    s_add_u32 m0, m0, s78
    s_nop 0
    buffer_load_dwordx4 v252, s[56:59], s77 offen offset:1024 nt lds
    s_add_u32 m0, m0, s78
    s_nop 0
    buffer_load_dwordx4 v252, s[56:59], s77 offen offset:2048 nt lds
    s_add_u32 m0, m0, s78
    s_nop 0
    buffer_load_dwordx4 v252, s[56:59], s77 offen offset:3072 nt lds
    s_add_u32 s77, s77, 8192
    s_and_b32 s77, s77, 0x1ffff
    s_waitcnt vmcnt(4)
    s_barrier
    s_add_u32 m0, s79, 87040
    s_nop 0
    buffer_load_dwordx4 v252, s[56:59], s77 offen offset:0 nt lds
    s_add_u32 m0, m0, s78
    s_nop 0
    buffer_load_dwordx4 v252, s[56:59], s77 offen offset:1024 nt lds
    s_add_u32 m0, m0, s78
    s_nop 0
    buffer_load_dwordx4 v252, s[56:59], s77 offen offset:2048 nt lds
    s_add_u32 m0, m0, s78
    s_nop 0
    buffer_load_dwordx4 v252, s[56:59], s77 offen offset:3072 nt lds
    s_add_u32 s77, s77, 8192
    s_and_b32 s77, s77, 0x1ffff
    s_waitcnt vmcnt(4)
    s_barrier
    s_add_u32 m0, s79, 34816
    s_nop 0
    buffer_load_dwordx4 v252, s[56:59], s77 offen offset:0 nt lds
    s_add_u32 m0, m0, s78
    s_nop 0
    buffer_load_dwordx4 v252, s[56:59], s77 offen offset:1024 nt lds
    s_add_u32 m0, m0, s78
    s_nop 0
    buffer_load_dwordx4 v252, s[56:59], s77 offen offset:2048 nt lds
    s_add_u32 m0, m0, s78
    s_nop 0
    buffer_load_dwordx4 v252, s[56:59], s77 offen offset:3072 nt lds
    s_add_u32 s77, s77, 8192
    s_and_b32 s77, s77, 0x1ffff
    s_waitcnt vmcnt(4)
    s_barrier
    s_add_u32 m0, s79, 52224
    s_nop 0
    buffer_load_dwordx4 v252, s[56:59], s77 offen offset:0 nt lds
    s_add_u32 m0, m0, s78
    s_nop 0
    buffer_load_dwordx4 v252, s[56:59], s77 offen offset:1024 nt lds
    s_add_u32 m0, m0, s78
    s_nop 0
    buffer_load_dwordx4 v252, s[56:59], s77 offen offset:2048 nt lds
    s_add_u32 m0, m0, s78
    s_nop 0
    buffer_load_dwordx4 v252, s[56:59], s77 offen offset:3072 nt lds
    s_add_u32 s77, s77, 8192
    s_and_b32 s77, s77, 0x1ffff
    s_waitcnt vmcnt(4)
    s_barrier
    s_add_u32 m0, s79, 69632
    s_nop 0
    buffer_load_dwordx4 v252, s[56:59], s77 offen offset:0 nt lds
    s_add_u32 m0, m0, s78
    s_nop 0
    buffer_load_dwordx4 v252, s[56:59], s77 offen offset:1024 nt lds
    s_add_u32 m0, m0, s78
    s_nop 0
    buffer_load_dwordx4 v252, s[56:59], s77 offen offset:2048 nt lds
    s_add_u32 m0, m0, s78
    s_nop 0
    buffer_load_dwordx4 v252, s[56:59], s77 offen offset:3072 nt lds
    s_add_u32 s77, s77, 8192
    s_and_b32 s77, s77, 0x1ffff
    s_waitcnt vmcnt(4)
    s_barrier
    s_add_u32 m0, s79, 87040
    s_nop 0
    buffer_load_dwordx4 v252, s[56:59], s77 offen offset:0 nt lds
    s_add_u32 m0, m0, s78
    s_nop 0
    buffer_load_dwordx4 v252, s[56:59], s77 offen offset:1024 nt lds
    s_add_u32 m0, m0, s78
    s_nop 0
    buffer_load_dwordx4 v252, s[56:59], s77 offen offset:2048 nt lds
    s_add_u32 m0, m0, s78
    s_nop 0
    buffer_load_dwordx4 v252, s[56:59], s77 offen offset:3072 nt lds
    s_add_u32 s77, s77, 8192
    s_and_b32 s77, s77, 0x1ffff
    s_waitcnt vmcnt(4)
    s_barrier
    s_add_u32 m0, s79, 34816
    s_nop 0
    buffer_load_dwordx4 v252, s[56:59], s77 offen offset:0 nt lds
    s_add_u32 m0, m0, s78
    s_nop 0
    buffer_load_dwordx4 v252, s[56:59], s77 offen offset:1024 nt lds
    s_add_u32 m0, m0, s78
    s_nop 0
    buffer_load_dwordx4 v252, s[56:59], s77 offen offset:2048 nt lds
    s_add_u32 m0, m0, s78
    s_nop 0
    buffer_load_dwordx4 v252, s[56:59], s77 offen offset:3072 nt lds
    s_add_u32 s77, s77, 8192
    s_and_b32 s77, s77, 0x1ffff
    s_waitcnt vmcnt(4)
    s_barrier
    s_add_u32 m0, s79, 52224
    s_nop 0
    buffer_load_dwordx4 v252, s[56:59], s77 offen offset:0 nt lds
    s_add_u32 m0, m0, s78
    s_nop 0
    buffer_load_dwordx4 v252, s[56:59], s77 offen offset:1024 nt lds
    s_add_u32 m0, m0, s78
    s_nop 0
    buffer_load_dwordx4 v252, s[56:59], s77 offen offset:2048 nt lds
    s_add_u32 m0, m0, s78
    s_nop 0
    buffer_load_dwordx4 v252, s[56:59], s77 offen offset:3072 nt lds
    s_add_u32 s77, s77, 8192
    s_and_b32 s77, s77, 0x1ffff
    s_waitcnt vmcnt(4)
    s_barrier
    s_add_u32 m0, s79, 69632
    s_nop 0
    buffer_load_dwordx4 v252, s[56:59], s77 offen offset:0 nt lds
    s_add_u32 m0, m0, s78
    s_nop 0
    buffer_load_dwordx4 v252, s[56:59], s77 offen offset:1024 nt lds
    s_add_u32 m0, m0, s78
    s_nop 0
    buffer_load_dwordx4 v252, s[56:59], s77 offen offset:2048 nt lds
    s_add_u32 m0, m0, s78
    s_nop 0
    buffer_load_dwordx4 v252, s[56:59], s77 offen offset:3072 nt lds
    s_add_u32 s77, s77, 8192
    s_and_b32 s77, s77, 0x1ffff
    s_waitcnt vmcnt(4)
    s_barrier
    s_add_u32 m0, s79, 87040
    s_nop 0
    buffer_load_dwordx4 v252, s[56:59], s77 offen offset:0 nt lds
    s_add_u32 m0, m0, s78
    s_nop 0
    buffer_load_dwordx4 v252, s[56:59], s77 offen offset:1024 nt lds
    s_add_u32 m0, m0, s78
    s_nop 0
    buffer_load_dwordx4 v252, s[56:59], s77 offen offset:2048 nt lds
    s_add_u32 m0, m0, s78
    s_nop 0
    buffer_load_dwordx4 v252, s[56:59], s77 offen offset:3072 nt lds
    s_add_u32 s77, s77, 8192
    s_and_b32 s77, s77, 0x1ffff
    s_waitcnt vmcnt(4)
    s_barrier
    s_add_u32 m0, s79, 34816
    s_nop 0
    buffer_load_dwordx4 v252, s[56:59], s77 offen offset:0 nt lds
    s_add_u32 m0, m0, s78
    s_nop 0
    buffer_load_dwordx4 v252, s[56:59], s77 offen offset:1024 nt lds
    s_add_u32 m0, m0, s78
    s_nop 0
    buffer_load_dwordx4 v252, s[56:59], s77 offen offset:2048 nt lds
    s_add_u32 m0, m0, s78
    s_nop 0
    buffer_load_dwordx4 v252, s[56:59], s77 offen offset:3072 nt lds
    s_add_u32 s77, s77, 8192
    s_and_b32 s77, s77, 0x1ffff
    s_waitcnt vmcnt(4)
    s_barrier
    s_add_u32 m0, s79, 52224
    s_nop 0
    buffer_load_dwordx4 v252, s[56:59], s77 offen offset:0 nt lds
    s_add_u32 m0, m0, s78
    s_nop 0
    buffer_load_dwordx4 v252, s[56:59], s77 offen offset:1024 nt lds
    s_add_u32 m0, m0, s78
    s_nop 0
    buffer_load_dwordx4 v252, s[56:59], s77 offen offset:2048 nt lds
    s_add_u32 m0, m0, s78
    s_nop 0
    buffer_load_dwordx4 v252, s[56:59], s77 offen offset:3072 nt lds
    s_add_u32 s77, s77, 8192
    s_and_b32 s77, s77, 0x1ffff
    s_waitcnt vmcnt(4)
    s_barrier
    s_add_u32 m0, s79, 69632
    s_nop 0
    buffer_load_dwordx4 v252, s[56:59], s77 offen offset:0 nt lds
    s_add_u32 m0, m0, s78
    s_nop 0
    buffer_load_dwordx4 v252, s[56:59], s77 offen offset:1024 nt lds
    s_add_u32 m0, m0, s78
    s_nop 0
    buffer_load_dwordx4 v252, s[56:59], s77 offen offset:2048 nt lds
    s_add_u32 m0, m0, s78
    s_nop 0
    buffer_load_dwordx4 v252, s[56:59], s77 offen offset:3072 nt lds
    s_add_u32 s77, s77, 8192
    s_and_b32 s77, s77, 0x1ffff
    s_waitcnt vmcnt(4)
    s_barrier
    s_add_u32 m0, s79, 87040
    s_nop 0
    buffer_load_dwordx4 v252, s[56:59], s77 offen offset:0 nt lds
    s_add_u32 m0, m0, s78
    s_nop 0
    buffer_load_dwordx4 v252, s[56:59], s77 offen offset:1024 nt lds
    s_add_u32 m0, m0, s78
    s_nop 0
    buffer_load_dwordx4 v252, s[56:59], s77 offen offset:2048 nt lds
    s_add_u32 m0, m0, s78
    s_nop 0
    buffer_load_dwordx4 v252, s[56:59], s77 offen offset:3072 nt lds
    s_add_u32 s77, s77, 8192
    s_and_b32 s77, s77, 0x1ffff
    s_waitcnt vmcnt(4)
    s_barrier
    s_waitcnt vmcnt(0)
    s_barrier
    s_add_u32 m0, s72, 0
    s_mov_b32 s76, 0
    buffer_load_dwordx4 v246, s[44:47], s76 offen offset:0 lds
    buffer_load_dwordx4 v247, s[44:47], s76 offen offset:1056 lds
    buffer_load_dwordx4 v248, s[44:47], s76 offen offset:2112 lds
    buffer_load_dwordx4 v249, s[44:47], s76 offen offset:3168 lds
    s_add_u32 m0, s72, 4352
    s_mov_b32 s76, 128
    buffer_load_dwordx4 v246, s[44:47], s76 offen offset:0 lds
    buffer_load_dwordx4 v247, s[44:47], s76 offen offset:1056 lds
    buffer_load_dwordx4 v248, s[44:47], s76 offen offset:2112 lds
    buffer_load_dwordx4 v249, s[44:47], s76 offen offset:3168 lds
    s_add_u32 m0, s72, 8704
    s_mov_b32 s76, 32768
    buffer_load_dwordx4 v246, s[44:47], s76 offen offset:0 lds
    buffer_load_dwordx4 v247, s[44:47], s76 offen offset:1056 lds
    buffer_load_dwordx4 v248, s[44:47], s76 offen offset:2112 lds
    buffer_load_dwordx4 v249, s[44:47], s76 offen offset:3168 lds
    s_lshl_b32 s74, s66, 19
    s_lshl_b32 s75, s65, 8
    s_add_u32 s74, s74, s75
    s_add_u32 s44, s22, s74
    s_addc_u32 s45, s23, 0
    s_sub_u32 s44, s44, 128
    s_subb_u32 s45, s45, 0
    s_sub_u32 s46, 4194432, s74
    s_mov_b32 s47, 0x20000
    s_barrier
    s_waitcnt vmcnt(0)
    s_barrier
    s_barrier
    s_cmp_eq_u32 s80, 0
    s_cbranch_scc1 L_Bgo
    s_add_u32 s71, s70, 4096
    s_add_u32 m0, s73, 0
    s_nop 0
    buffer_load_dwordx4 v244, s[32:35], s70 offen offset:0 nt lds
    s_add_u32 m0, s73, 4352
    s_nop 0
    buffer_load_dwordx4 v244, s[32:35], s71 offen offset:0 nt lds
    s_add_u32 m0, s73, 128
    s_nop 0
    buffer_load_dwordx4 v244, s[32:35], s70 offen offset:2048 nt lds
    s_add_u32 m0, s73, 4480
    s_nop 0
    buffer_load_dwordx4 v244, s[32:35], s71 offen offset:2048 nt lds
    s_add_u32 m0, s73, 64
    s_nop 0
    buffer_load_dwordx4 v244, s[32:35], s70 offen offset:1024 nt lds
    s_add_u32 m0, s73, 4416
    s_nop 0
    buffer_load_dwordx4 v244, s[32:35], s71 offen offset:1024 nt lds
    s_add_u32 m0, s73, 192
    s_nop 0
    buffer_load_dwordx4 v244, s[32:35], s70 offen offset:3072 nt lds
    s_add_u32 m0, s73, 4544
    s_nop 0
    buffer_load_dwordx4 v244, s[32:35], s71 offen offset:3072 nt lds
    s_add_u32 s71, s70, 4096
    s_add_u32 m0, s73, 8704
    s_nop 0
    buffer_load_dwordx4 v245, s[36:39], s70 offen offset:0 nt lds
    s_add_u32 m0, s73, 12928
    s_nop 0
    buffer_load_dwordx4 v245, s[36:39], s71 offen offset:0 nt lds
    s_add_u32 m0, s73, 8768
    s_nop 0
    buffer_load_dwordx4 v245, s[36:39], s70 offen offset:2048 nt lds
    s_add_u32 m0, s73, 12992
    s_nop 0
    buffer_load_dwordx4 v245, s[36:39], s71 offen offset:2048 nt lds
    s_add_u32 m0, s73, 8736
    s_nop 0
    buffer_load_dwordx4 v245, s[36:39], s70 offen offset:1024 nt lds
    s_add_u32 m0, s73, 12960
    s_nop 0
    buffer_load_dwordx4 v245, s[36:39], s71 offen offset:1024 nt lds
    s_add_u32 m0, s73, 8800
    s_nop 0
    buffer_load_dwordx4 v245, s[36:39], s70 offen offset:3072 nt lds
    s_add_u32 m0, s73, 13024
    s_nop 0
    buffer_load_dwordx4 v245, s[36:39], s71 offen offset:3072 nt lds
    s_branch L_Bgo
L_Aattn:
    s_mov_b32 s75, 17408
    s_barrier
    ds_read_b128 v[224:227], v242 offset:0
    ds_read_b128 v[228:231], v242 offset:64
    ds_read_b128 v[232:235], v242 offset:128
    ds_read_b128 v[244:247], v242 offset:192
    s_waitcnt lgkmcnt(2)
    v_mfma_f32_16x16x32_bf16 v[192:195], v[224:227], v[128:131], 0
    ds_read_b128 v[248:251], v242 offset:512
    v_mfma_f32_16x16x32_bf16 v[200:203], v[224:227], v[144:147], 0
    ds_read_b128 v[252:255], v242 offset:576
    v_mfma_f32_16x16x32_bf16 v[208:211], v[224:227], v[160:163], 0
    v_mfma_f32_16x16x32_bf16 v[216:219], v[224:227], v[176:179], 0
    ds_read_b128 v[224:227], v242 offset:640
    v_mfma_f32_16x16x32_bf16 v[192:195], v[228:231], v[132:135], v[192:195]
    s_add_u32 s69, s69, 1
    s_and_b32 s74, s69, 3
    v_mfma_f32_16x16x32_bf16 v[200:203], v[228:231], v[148:151], v[200:203]
    s_cselect_b32 s79, s75, 0xffff3400
    v_mfma_f32_16x16x32_bf16 v[208:211], v[228:231], v[164:167], v[208:211]
    v_mfma_f32_16x16x32_bf16 v[216:219], v[228:231], v[180:183], v[216:219]
    ds_read_b128 v[228:231], v242 offset:704
    s_waitcnt lgkmcnt(4)
    v_mfma_f32_16x16x32_bf16 v[192:195], v[232:235], v[136:139], v[192:195]
    v_add_u32 v242, s79, v242
    v_mfma_f32_16x16x32_bf16 v[200:203], v[232:235], v[152:155], v[200:203]
    v_mfma_f32_16x16x32_bf16 v[208:211], v[232:235], v[168:171], v[208:211]
    v_mfma_f32_16x16x32_bf16 v[216:219], v[232:235], v[184:187], v[216:219]
    ds_read_b64_tr_b16 v[232:233], v243 offset:0
    ds_read_b64_tr_b16 v[234:235], v243 offset:512
    v_mfma_f32_16x16x32_bf16 v[192:195], v[244:247], v[140:143], v[192:195]
    v_mfma_f32_16x16x32_bf16 v[200:203], v[244:247], v[156:159], v[200:203]
    v_mfma_f32_16x16x32_bf16 v[208:211], v[244:247], v[172:175], v[208:211]
    v_mfma_f32_16x16x32_bf16 v[216:219], v[244:247], v[188:191], v[216:219]
    ds_read_b64_tr_b16 v[244:245], v243 offset:32
    ds_read_b64_tr_b16 v[246:247], v243 offset:544
    s_waitcnt lgkmcnt(4)
    v_mfma_f32_16x16x32_bf16 v[196:199], v[248:251], v[128:131], 0
    v_mfma_f32_16x16x32_bf16 v[204:207], v[248:251], v[144:147], 0
    v_exp_f32 v192, v192
    v_mfma_f32_16x16x32_bf16 v[212:215], v[248:251], v[160:163], 0
    v_exp_f32 v193, v193
    v_mfma_f32_16x16x32_bf16 v[220:223], v[248:251], v[176:179], 0
    ds_read_b64_tr_b16 v[248:249], v243 offset:64
    ds_read_b64_tr_b16 v[250:251], v243 offset:576
    v_mfma_f32_16x16x32_bf16 v[196:199], v[252:255], v[132:135], v[196:199]
    v_exp_f32 v194, v194
    v_mfma_f32_16x16x32_bf16 v[204:207], v[252:255], v[148:151], v[204:207]
    v_exp_f32 v195, v195
    v_mfma_f32_16x16x32_bf16 v[212:215], v[252:255], v[164:167], v[212:215]
    v_exp_f32 v200, v200
    v_mfma_f32_16x16x32_bf16 v[220:223], v[252:255], v[180:183], v[220:223]
    ds_read_b64_tr_b16 v[252:253], v243 offset:96
    ds_read_b64_tr_b16 v[254:255], v243 offset:608
    v_mfma_f32_16x16x32_bf16 v[196:199], v[224:227], v[136:139], v[196:199]
    v_exp_f32 v201, v201
    v_mfma_f32_16x16x32_bf16 v[204:207], v[224:227], v[152:155], v[204:207]
    v_exp_f32 v202, v202
    v_mfma_f32_16x16x32_bf16 v[212:215], v[224:227], v[168:171], v[212:215]
    v_exp_f32 v203, v203
    v_mfma_f32_16x16x32_bf16 v[220:223], v[224:227], v[184:187], v[220:223]
    ds_read_b64_tr_b16 v[224:225], v243 offset:128
    ds_read_b64_tr_b16 v[226:227], v243 offset:640
    v_mfma_f32_16x16x32_bf16 v[196:199], v[228:231], v[140:143], v[196:199]
    v_exp_f32 v208, v208
    v_mfma_f32_16x16x32_bf16 v[204:207], v[228:231], v[156:159], v[204:207]
    v_exp_f32 v209, v209
    v_mfma_f32_16x16x32_bf16 v[212:215], v[228:231], v[172:175], v[212:215]
    v_exp_f32 v210, v210
    v_mfma_f32_16x16x32_bf16 v[220:223], v[228:231], v[188:191], v[220:223]
    v_exp_f32 v211, v211
    ds_read_b64_tr_b16 v[228:229], v243 offset:160
    ds_read_b64_tr_b16 v[230:231], v243 offset:672
    v_exp_f32 v196, v196
    v_exp_f32 v197, v197
    v_exp_f32 v198, v198
    v_exp_f32 v199, v199
    v_cvt_pk_bf16_f32 v192, v192, v193
    v_cvt_pk_bf16_f32 v193, v194, v195
    v_cvt_pk_bf16_f32 v194, v196, v197
    v_cvt_pk_bf16_f32 v195, v198, v199
    ds_read_b64_tr_b16 v[196:197], v243 offset:192
    ds_read_b64_tr_b16 v[198:199], v243 offset:704
    s_waitcnt lgkmcnt(6)
    v_mfma_f32_16x16x32_bf16 v[0:3], v[192:195], v[232:235], 0
    v_exp_f32 v204, v204
    v_mfma_f32_16x16x32_bf16 v[4:7], v[192:195], v[244:247], 0
    v_exp_f32 v205, v205
    v_mfma_f32_16x16x32_bf16 v[32:35], v[192:195], v[248:251], 0
    v_exp_f32 v206, v206
    v_mfma_f32_16x16x32_bf16 v[36:39], v[192:195], v[252:255], 0
    s_waitcnt lgkmcnt(2)
    v_exp_f32 v207, v207
    v_mfma_f32_16x16x32_bf16 v[64:67], v[192:195], v[224:227], 0
    v_cvt_pk_bf16_f32 v200, v200, v201
    v_cvt_pk_bf16_f32 v201, v202, v203
    v_mfma_f32_16x16x32_bf16 v[68:71], v[192:195], v[228:231], 0
    v_cvt_pk_bf16_f32 v202, v204, v205
    v_cvt_pk_bf16_f32 v203, v206, v207
    ds_read_b64_tr_b16 v[204:205], v243 offset:224
    ds_read_b64_tr_b16 v[206:207], v243 offset:736
    v_mfma_f32_16x16x32_bf16 v[76:79], v[200:203], v[228:231], 0
    v_exp_f32 v212, v212
    v_mfma_f32_4x4x4_16b_bf16 v[236:239], v[240:241], v[192:193], v[236:239] cbsz:2 abid:0
    v_mfma_f32_16x16x32_bf16 v[72:75], v[200:203], v[224:227], 0
    v_exp_f32 v213, v213
    v_mfma_f32_16x16x32_bf16 v[44:47], v[200:203], v[252:255], 0
    v_exp_f32 v214, v214
    v_mfma_f32_4x4x4_16b_bf16 v[236:239], v[240:241], v[194:195], v[236:239] cbsz:2 abid:0
    v_mfma_f32_16x16x32_bf16 v[40:43], v[200:203], v[248:251], 0
    v_exp_f32 v215, v215
    v_mfma_f32_16x16x32_bf16 v[12:15], v[200:203], v[244:247], 0
    v_cvt_pk_bf16_f32 v208, v208, v209
    v_cvt_pk_bf16_f32 v209, v210, v211
    v_mfma_f32_16x16x32_bf16 v[8:11], v[200:203], v[232:235], 0
    v_cvt_pk_bf16_f32 v210, v212, v213
    v_cvt_pk_bf16_f32 v211, v214, v215
    v_add_u32 v243, s79, v243
    v_mfma_f32_4x4x4_16b_bf16 v[236:239], v[240:241], v[200:201], v[236:239] cbsz:2 abid:1
    v_mfma_f32_16x16x32_bf16 v[16:19], v[208:211], v[232:235], 0
    v_exp_f32 v216, v216
    v_mfma_f32_16x16x32_bf16 v[20:23], v[208:211], v[244:247], 0
    v_exp_f32 v217, v217
    v_mfma_f32_4x4x4_16b_bf16 v[236:239], v[240:241], v[202:203], v[236:239] cbsz:2 abid:1
    v_mfma_f32_16x16x32_bf16 v[48:51], v[208:211], v[248:251], 0
    v_exp_f32 v218, v218
    v_mfma_f32_16x16x32_bf16 v[52:55], v[208:211], v[252:255], 0
    v_exp_f32 v219, v219
    v_mfma_f32_4x4x4_16b_bf16 v[236:239], v[240:241], v[208:209], v[236:239] cbsz:2 abid:2
    v_mfma_f32_16x16x32_bf16 v[80:83], v[208:211], v[224:227], 0
    v_exp_f32 v220, v220
    v_mfma_f32_16x16x32_bf16 v[84:87], v[208:211], v[228:231], 0
    v_exp_f32 v221, v221
    s_waitcnt lgkmcnt(0)
    v_mfma_f32_16x16x32_bf16 v[96:99], v[192:195], v[196:199], 0
    v_exp_f32 v222, v222
    v_mfma_f32_16x16x32_bf16 v[100:103], v[192:195], v[204:207], 0
    v_exp_f32 v223, v223
    v_mfma_f32_16x16x32_bf16 v[108:111], v[200:203], v[204:207], 0
    v_cvt_pk_bf16_f32 v216, v216, v217
    v_cvt_pk_bf16_f32 v217, v218, v219
    v_mfma_f32_16x16x32_bf16 v[104:107], v[200:203], v[196:199], 0
    v_cvt_pk_bf16_f32 v218, v220, v221
    v_cvt_pk_bf16_f32 v219, v222, v223
    v_mfma_f32_4x4x4_16b_bf16 v[236:239], v[240:241], v[210:211], v[236:239] cbsz:2 abid:2
    s_barrier
    v_mfma_f32_16x16x32_bf16 v[88:91], v[216:219], v[224:227], 0
    ds_read_b128 v[224:227], v242 offset:0
    v_mfma_f32_16x16x32_bf16 v[92:95], v[216:219], v[228:231], 0
    ds_read_b128 v[228:231], v242 offset:64
    v_mfma_f32_16x16x32_bf16 v[24:27], v[216:219], v[232:235], 0
    ds_read_b128 v[232:235], v242 offset:128
    v_mfma_f32_16x16x32_bf16 v[28:31], v[216:219], v[244:247], 0
    ds_read_b128 v[244:247], v242 offset:192
    v_mfma_f32_4x4x4_16b_bf16 v[236:239], v[240:241], v[216:217], v[236:239] cbsz:2 abid:3
    v_mfma_f32_16x16x32_bf16 v[56:59], v[216:219], v[248:251], 0
    s_cmp_eq_u32 s69, 15
    v_mfma_f32_16x16x32_bf16 v[60:63], v[216:219], v[252:255], 0
    v_mfma_f32_4x4x4_16b_bf16 v[236:239], v[240:241], v[218:219], v[236:239] cbsz:2 abid:3
    v_mfma_f32_16x16x32_bf16 v[120:123], v[216:219], v[196:199], 0
    v_mfma_f32_16x16x32_bf16 v[124:127], v[216:219], v[204:207], 0
    v_mfma_f32_16x16x32_bf16 v[116:119], v[208:211], v[204:207], 0
    v_mfma_f32_16x16x32_bf16 v[112:115], v[208:211], v[196:199], 0
L_Aloop:
    s_waitcnt lgkmcnt(2)
    v_mfma_f32_16x16x32_bf16 v[192:195], v[224:227], v[128:131], 0
    ds_read_b128 v[248:251], v242 offset:512
    v_mfma_f32_16x16x32_bf16 v[200:203], v[224:227], v[144:147], 0
    ds_read_b128 v[252:255], v242 offset:576
    v_mfma_f32_16x16x32_bf16 v[208:211], v[224:227], v[160:163], 0
    v_mfma_f32_16x16x32_bf16 v[216:219], v[224:227], v[176:179], 0
    ds_read_b128 v[224:227], v242 offset:640
    v_mfma_f32_16x16x32_bf16 v[192:195], v[228:231], v[132:135], v[192:195]
    s_add_u32 s69, s69, 1
    s_and_b32 s74, s69, 3
    v_mfma_f32_16x16x32_bf16 v[200:203], v[228:231], v[148:151], v[200:203]
    s_cselect_b32 s79, s75, 0xffff3400
    v_mfma_f32_16x16x32_bf16 v[208:211], v[228:231], v[164:167], v[208:211]
    v_mfma_f32_16x16x32_bf16 v[216:219], v[228:231], v[180:183], v[216:219]
    ds_read_b128 v[228:231], v242 offset:704
    s_waitcnt lgkmcnt(4)
    v_mfma_f32_16x16x32_bf16 v[192:195], v[232:235], v[136:139], v[192:195]
    v_add_u32 v242, s79, v242
    v_mfma_f32_16x16x32_bf16 v[200:203], v[232:235], v[152:155], v[200:203]
    v_mfma_f32_16x16x32_bf16 v[208:211], v[232:235], v[168:171], v[208:211]
    v_mfma_f32_16x16x32_bf16 v[216:219], v[232:235], v[184:187], v[216:219]
    ds_read_b64_tr_b16 v[232:233], v243 offset:0
    ds_read_b64_tr_b16 v[234:235], v243 offset:512
    v_mfma_f32_16x16x32_bf16 v[192:195], v[244:247], v[140:143], v[192:195]
    v_mfma_f32_16x16x32_bf16 v[200:203], v[244:247], v[156:159], v[200:203]
    v_mfma_f32_16x16x32_bf16 v[208:211], v[244:247], v[172:175], v[208:211]
    v_mfma_f32_16x16x32_bf16 v[216:219], v[244:247], v[188:191], v[216:219]
    ds_read_b64_tr_b16 v[244:245], v243 offset:32
    ds_read_b64_tr_b16 v[246:247], v243 offset:544
    s_waitcnt lgkmcnt(4)
    v_mfma_f32_16x16x32_bf16 v[196:199], v[248:251], v[128:131], 0
    v_mfma_f32_16x16x32_bf16 v[204:207], v[248:251], v[144:147], 0
    v_exp_f32 v192, v192
    v_mfma_f32_16x16x32_bf16 v[212:215], v[248:251], v[160:163], 0
    v_exp_f32 v193, v193
    v_mfma_f32_16x16x32_bf16 v[220:223], v[248:251], v[176:179], 0
    ds_read_b64_tr_b16 v[248:249], v243 offset:64
    ds_read_b64_tr_b16 v[250:251], v243 offset:576
    v_mfma_f32_16x16x32_bf16 v[196:199], v[252:255], v[132:135], v[196:199]
    v_exp_f32 v194, v194
    v_mfma_f32_16x16x32_bf16 v[204:207], v[252:255], v[148:151], v[204:207]
    v_exp_f32 v195, v195
    v_mfma_f32_16x16x32_bf16 v[212:215], v[252:255], v[164:167], v[212:215]
    v_exp_f32 v200, v200
    v_mfma_f32_16x16x32_bf16 v[220:223], v[252:255], v[180:183], v[220:223]
    ds_read_b64_tr_b16 v[252:253], v243 offset:96
    ds_read_b64_tr_b16 v[254:255], v243 offset:608
    v_mfma_f32_16x16x32_bf16 v[196:199], v[224:227], v[136:139], v[196:199]
    v_exp_f32 v201, v201
    v_mfma_f32_16x16x32_bf16 v[204:207], v[224:227], v[152:155], v[204:207]
    v_exp_f32 v202, v202
    v_mfma_f32_16x16x32_bf16 v[212:215], v[224:227], v[168:171], v[212:215]
    v_exp_f32 v203, v203
    v_mfma_f32_16x16x32_bf16 v[220:223], v[224:227], v[184:187], v[220:223]
    ds_read_b64_tr_b16 v[224:225], v243 offset:128
    ds_read_b64_tr_b16 v[226:227], v243 offset:640
    v_mfma_f32_16x16x32_bf16 v[196:199], v[228:231], v[140:143], v[196:199]
    v_exp_f32 v208, v208
    v_mfma_f32_16x16x32_bf16 v[204:207], v[228:231], v[156:159], v[204:207]
    v_exp_f32 v209, v209
    v_mfma_f32_16x16x32_bf16 v[212:215], v[228:231], v[172:175], v[212:215]
    v_exp_f32 v210, v210
    v_mfma_f32_16x16x32_bf16 v[220:223], v[228:231], v[188:191], v[220:223]
    v_exp_f32 v211, v211
    ds_read_b64_tr_b16 v[228:229], v243 offset:160
    ds_read_b64_tr_b16 v[230:231], v243 offset:672
    v_exp_f32 v196, v196
    v_exp_f32 v197, v197
    v_exp_f32 v198, v198
    v_exp_f32 v199, v199
    v_cvt_pk_bf16_f32 v192, v192, v193
    v_cvt_pk_bf16_f32 v193, v194, v195
    v_cvt_pk_bf16_f32 v194, v196, v197
    v_cvt_pk_bf16_f32 v195, v198, v199
    ds_read_b64_tr_b16 v[196:197], v243 offset:192
    ds_read_b64_tr_b16 v[198:199], v243 offset:704
    s_waitcnt lgkmcnt(6)
    v_mfma_f32_16x16x32_bf16 v[0:3], v[192:195], v[232:235], v[0:3]
    v_exp_f32 v204, v204
    v_mfma_f32_16x16x32_bf16 v[4:7], v[192:195], v[244:247], v[4:7]
    v_exp_f32 v205, v205
    v_mfma_f32_16x16x32_bf16 v[32:35], v[192:195], v[248:251], v[32:35]
    v_exp_f32 v206, v206
    v_mfma_f32_16x16x32_bf16 v[36:39], v[192:195], v[252:255], v[36:39]
    s_waitcnt lgkmcnt(2)
    v_exp_f32 v207, v207
    v_mfma_f32_16x16x32_bf16 v[64:67], v[192:195], v[224:227], v[64:67]
    v_cvt_pk_bf16_f32 v200, v200, v201
    v_cvt_pk_bf16_f32 v201, v202, v203
    v_mfma_f32_16x16x32_bf16 v[68:71], v[192:195], v[228:231], v[68:71]
    v_cvt_pk_bf16_f32 v202, v204, v205
    v_cvt_pk_bf16_f32 v203, v206, v207
    ds_read_b64_tr_b16 v[204:205], v243 offset:224
    ds_read_b64_tr_b16 v[206:207], v243 offset:736
    v_mfma_f32_16x16x32_bf16 v[76:79], v[200:203], v[228:231], v[76:79]
    v_exp_f32 v212, v212
    v_mfma_f32_4x4x4_16b_bf16 v[236:239], v[240:241], v[192:193], v[236:239] cbsz:2 abid:0
    v_mfma_f32_16x16x32_bf16 v[72:75], v[200:203], v[224:227], v[72:75]
    v_exp_f32 v213, v213
    v_mfma_f32_16x16x32_bf16 v[44:47], v[200:203], v[252:255], v[44:47]
    v_exp_f32 v214, v214
    v_mfma_f32_4x4x4_16b_bf16 v[236:239], v[240:241], v[194:195], v[236:239] cbsz:2 abid:0
    v_mfma_f32_16x16x32_bf16 v[40:43], v[200:203], v[248:251], v[40:43]
    v_exp_f32 v215, v215
    v_mfma_f32_16x16x32_bf16 v[12:15], v[200:203], v[244:247], v[12:15]
    v_cvt_pk_bf16_f32 v208, v208, v209
    v_cvt_pk_bf16_f32 v209, v210, v211
    v_mfma_f32_16x16x32_bf16 v[8:11], v[200:203], v[232:235], v[8:11]
    v_cvt_pk_bf16_f32 v210, v212, v213
    v_cvt_pk_bf16_f32 v211, v214, v215
    v_add_u32 v243, s79, v243
    v_mfma_f32_4x4x4_16b_bf16 v[236:239], v[240:241], v[200:201], v[236:239] cbsz:2 abid:1
    v_mfma_f32_16x16x32_bf16 v[16:19], v[208:211], v[232:235], v[16:19]
    v_exp_f32 v216, v216
    v_mfma_f32_16x16x32_bf16 v[20:23], v[208:211], v[244:247], v[20:23]
    v_exp_f32 v217, v217
    v_mfma_f32_4x4x4_16b_bf16 v[236:239], v[240:241], v[202:203], v[236:239] cbsz:2 abid:1
    v_mfma_f32_16x16x32_bf16 v[48:51], v[208:211], v[248:251], v[48:51]
    v_exp_f32 v218, v218
    v_mfma_f32_16x16x32_bf16 v[52:55], v[208:211], v[252:255], v[52:55]
    v_exp_f32 v219, v219
    v_mfma_f32_4x4x4_16b_bf16 v[236:239], v[240:241], v[208:209], v[236:239] cbsz:2 abid:2
    v_mfma_f32_16x16x32_bf16 v[80:83], v[208:211], v[224:227], v[80:83]
    v_exp_f32 v220, v220
    v_mfma_f32_16x16x32_bf16 v[84:87], v[208:211], v[228:231], v[84:87]
    v_exp_f32 v221, v221
    s_waitcnt lgkmcnt(0)
    v_mfma_f32_16x16x32_bf16 v[96:99], v[192:195], v[196:199], v[96:99]
    v_exp_f32 v222, v222
    v_mfma_f32_16x16x32_bf16 v[100:103], v[192:195], v[204:207], v[100:103]
    v_exp_f32 v223, v223
    v_mfma_f32_16x16x32_bf16 v[108:111], v[200:203], v[204:207], v[108:111]
    v_cvt_pk_bf16_f32 v216, v216, v217
    v_cvt_pk_bf16_f32 v217, v218, v219
    v_mfma_f32_16x16x32_bf16 v[104:107], v[200:203], v[196:199], v[104:107]
    v_cvt_pk_bf16_f32 v218, v220, v221
    v_cvt_pk_bf16_f32 v219, v222, v223
    v_mfma_f32_4x4x4_16b_bf16 v[236:239], v[240:241], v[210:211], v[236:239] cbsz:2 abid:2
    s_barrier
    v_mfma_f32_16x16x32_bf16 v[88:91], v[216:219], v[224:227], v[88:91]
    ds_read_b128 v[224:227], v242 offset:0
    v_mfma_f32_16x16x32_bf16 v[92:95], v[216:219], v[228:231], v[92:95]
    ds_read_b128 v[228:231], v242 offset:64
    v_mfma_f32_16x16x32_bf16 v[24:27], v[216:219], v[232:235], v[24:27]
    ds_read_b128 v[232:235], v242 offset:128
    v_mfma_f32_16x16x32_bf16 v[28:31], v[216:219], v[244:247], v[28:31]
    ds_read_b128 v[244:247], v242 offset:192
    v_mfma_f32_4x4x4_16b_bf16 v[236:239], v[240:241], v[216:217], v[236:239] cbsz:2 abid:3
    v_mfma_f32_16x16x32_bf16 v[56:59], v[216:219], v[248:251], v[56:59]
    s_cmp_eq_u32 s69, 15
    v_mfma_f32_16x16x32_bf16 v[60:63], v[216:219], v[252:255], v[60:63]
    v_mfma_f32_4x4x4_16b_bf16 v[236:239], v[240:241], v[218:219], v[236:239] cbsz:2 abid:3
    v_mfma_f32_16x16x32_bf16 v[120:123], v[216:219], v[196:199], v[120:123]
    v_mfma_f32_16x16x32_bf16 v[124:127], v[216:219], v[204:207], v[124:127]
    v_mfma_f32_16x16x32_bf16 v[116:119], v[208:211], v[204:207], v[116:119]
    v_mfma_f32_16x16x32_bf16 v[112:115], v[208:211], v[196:199], v[112:115]
    s_cbranch_scc0 L_Aloop
    s_waitcnt lgkmcnt(2)
    v_mfma_f32_16x16x32_bf16 v[192:195], v[224:227], v[128:131], 0
    ds_read_b128 v[248:251], v242 offset:512
    v_mfma_f32_16x16x32_bf16 v[200:203], v[224:227], v[144:147], 0
    ds_read_b128 v[252:255], v242 offset:576
    v_mfma_f32_16x16x32_bf16 v[208:211], v[224:227], v[160:163], 0
    v_mfma_f32_16x16x32_bf16 v[216:219], v[224:227], v[176:179], 0
    ds_read_b128 v[224:227], v242 offset:640
    v_mfma_f32_16x16x32_bf16 v[192:195], v[228:231], v[132:135], v[192:195]
    v_mfma_f32_16x16x32_bf16 v[200:203], v[228:231], v[148:151], v[200:203]
    v_mfma_f32_16x16x32_bf16 v[208:211], v[228:231], v[164:167], v[208:211]
    v_mfma_f32_16x16x32_bf16 v[216:219], v[228:231], v[180:183], v[216:219]
    ds_read_b128 v[228:231], v242 offset:704
    s_waitcnt lgkmcnt(4)
    v_mfma_f32_16x16x32_bf16 v[192:195], v[232:235], v[136:139], v[192:195]
    v_mfma_f32_16x16x32_bf16 v[200:203], v[232:235], v[152:155], v[200:203]
    v_mfma_f32_16x16x32_bf16 v[208:211], v[232:235], v[168:171], v[208:211]
    v_mfma_f32_16x16x32_bf16 v[216:219], v[232:235], v[184:187], v[216:219]
    v_mfma_f32_16x16x32_bf16 v[192:195], v[244:247], v[140:143], v[192:195]
    v_mfma_f32_16x16x32_bf16 v[200:203], v[244:247], v[156:159], v[200:203]
    v_mfma_f32_16x16x32_bf16 v[208:211], v[244:247], v[172:175], v[208:211]
    v_mfma_f32_16x16x32_bf16 v[216:219], v[244:247], v[188:191], v[216:219]
    s_waitcnt lgkmcnt(0)
    v_mfma_f32_16x16x32_bf16 v[196:199], v[248:251], v[128:131], 0
    v_mfma_f32_16x16x32_bf16 v[204:207], v[248:251], v[144:147], 0
    s_nop 1
    v_exp_f32 v192, v192
    v_mfma_f32_16x16x32_bf16 v[212:215], v[248:251], v[160:163], 0
    v_exp_f32 v193, v193
    v_mfma_f32_16x16x32_bf16 v[220:223], v[248:251], v[176:179], 0
    v_exp_f32 v194, v194
    v_mfma_f32_16x16x32_bf16 v[196:199], v[252:255], v[132:135], v[196:199]
    v_exp_f32 v195, v195
    v_mfma_f32_16x16x32_bf16 v[204:207], v[252:255], v[148:151], v[204:207]
    v_exp_f32 v200, v200
    v_mfma_f32_16x16x32_bf16 v[212:215], v[252:255], v[164:167], v[212:215]
    v_exp_f32 v201, v201
    v_mfma_f32_16x16x32_bf16 v[220:223], v[252:255], v[180:183], v[220:223]
    v_exp_f32 v202, v202
    v_mfma_f32_16x16x32_bf16 v[196:199], v[224:227], v[136:139], v[196:199]
    v_exp_f32 v203, v203
    v_mfma_f32_16x16x32_bf16 v[204:207], v[224:227], v[152:155], v[204:207]
    v_exp_f32 v208, v208
    v_mfma_f32_16x16x32_bf16 v[212:215], v[224:227], v[168:171], v[212:215]
    v_exp_f32 v209, v209
    v_mfma_f32_16x16x32_bf16 v[220:223], v[224:227], v[184:187], v[220:223]
    v_exp_f32 v210, v210
    v_mfma_f32_16x16x32_bf16 v[196:199], v[228:231], v[140:143], v[196:199]
    v_exp_f32 v211, v211
    v_mfma_f32_16x16x32_bf16 v[204:207], v[228:231], v[156:159], v[204:207]
    v_exp_f32 v216, v216
    v_mfma_f32_16x16x32_bf16 v[212:215], v[228:231], v[172:175], v[212:215]
    v_mfma_f32_16x16x32_bf16 v[220:223], v[228:231], v[188:191], v[220:223]
    v_mbcnt_lo_u32_b32 v253, -1, 0
    v_mbcnt_hi_u32_b32 v253, -1, v253
    v_lshlrev_b32 v245, 4, v253
    v_and_b32 v224, 3, v253
    v_bfe_u32 v225, v253, 2, 2
    v_mul_u32_u24 v250, 1056, v225
    v_lshl_add_u32 v250, v224, 3, v250
    v_lshrrev_b32 v226, 4, v253
    v_lshl_add_u32 v250, v226, 7, v250
    v_add_u32 v250, s72, v250
    v_bfe_u32 v254, v253, 3, 1
    v_lshlrev_b32 v246, 14, v254
    v_bfe_u32 v254, v253, 4, 1
    v_lshl_add_u32 v246, v254, 11, v246
    v_lshrrev_b32 v254, 5, v253
    v_lshl_add_u32 v246, v254, 10, v246
    v_and_b32 v254, 7, v253
    v_lshl_add_u32 v246, v254, 4, v246
    v_add_u32 v249, 9248, v246
    v_add_u32 v248, 6208, v246
    v_add_u32 v247, 3168, v246
    v_add_u32 v246, 128, v246
    v_bfe_u32 v224, v253, 2, 3
    v_lshrrev_b32 v225, 5, v253
    v_lshl_add_u32 v224, v224, 1, v225
    v_mul_u32_u24 v251, 272, v224
    v_and_b32 v224, 3, v253
    v_lshl_add_u32 v251, v224, 3, v251
    v_add_u32 v251, 34816, v251
    s_branch L_lastA
L_Oepi:
L_slow_back:
    v_rcp_f32 v236, v236
    v_rcp_f32 v237, v237
    v_rcp_f32 v238, v238
    v_rcp_f32 v239, v239
    v_and_b32 v255, 48, v253
    ds_bpermute_b32 v160, v255, v236 offset:0
    ds_bpermute_b32 v161, v255, v236 offset:4
    ds_bpermute_b32 v162, v255, v236 offset:8
    ds_bpermute_b32 v163, v255, v236 offset:12
    ds_bpermute_b32 v164, v255, v237 offset:0
    ds_bpermute_b32 v165, v255, v237 offset:4
    ds_bpermute_b32 v166, v255, v237 offset:8
    ds_bpermute_b32 v167, v255, v237 offset:12
    ds_bpermute_b32 v168, v255, v238 offset:0
    ds_bpermute_b32 v169, v255, v238 offset:4
    ds_bpermute_b32 v170, v255, v238 offset:8
    ds_bpermute_b32 v171, v255, v238 offset:12
    ds_bpermute_b32 v172, v255, v239 offset:0
    ds_bpermute_b32 v173, v255, v239 offset:4
    ds_bpermute_b32 v174, v255, v239 offset:8
    ds_bpermute_b32 v175, v255, v239 offset:12
    v_and_b32 v254, 15, v253
    v_mul_u32_u24 v254, 136, v254
    s_mul_i32 s74, s65, 17408
    s_add_u32 s74, s74, 34816
    v_lshrrev_b32 v224, 1, v255
    v_add3_u32 v254, v254, v224, s74
    s_waitcnt lgkmcnt(0)
    v_pk_mul_f32 v[0:1], v[0:1], v[160:161]
    v_pk_mul_f32 v[2:3], v[2:3], v[162:163]
    v_pk_mul_f32 v[4:5], v[4:5], v[160:161]
    v_pk_mul_f32 v[6:7], v[6:7], v[162:163]
    v_cvt_pk_bf16_f32 v0, v0, v1
    v_cvt_pk_bf16_f32 v1, v2, v3
    ds_write_b64 v254, v[0:1] offset:0
    v_cvt_pk_bf16_f32 v4, v4, v5
    v_cvt_pk_bf16_f32 v5, v6, v7
    ds_write_b64 v254, v[4:5] offset:2176
    v_pk_mul_f32 v[8:9], v[8:9], v[164:165]
    v_pk_mul_f32 v[10:11], v[10:11], v[166:167]
    v_pk_mul_f32 v[12:13], v[12:13], v[164:165]
    v_pk_mul_f32 v[14:15], v[14:15], v[166:167]
    v_cvt_pk_bf16_f32 v8, v8, v9
    v_cvt_pk_bf16_f32 v9, v10, v11
    ds_write_b64 v254, v[8:9] offset:32
    v_cvt_pk_bf16_f32 v12, v12, v13
    v_cvt_pk_bf16_f32 v13, v14, v15
    ds_write_b64 v254, v[12:13] offset:2208
    v_pk_mul_f32 v[16:17], v[16:17], v[168:169]
    v_pk_mul_f32 v[18:19], v[18:19], v[170:171]
    v_pk_mul_f32 v[20:21], v[20:21], v[168:169]
    v_pk_mul_f32 v[22:23], v[22:23], v[170:171]
    v_cvt_pk_bf16_f32 v16, v16, v17
    v_cvt_pk_bf16_f32 v17, v18, v19
    ds_write_b64 v254, v[16:17] offset:64
    v_cvt_pk_bf16_f32 v20, v20, v21
    v_cvt_pk_bf16_f32 v21, v22, v23
    ds_write_b64 v254, v[20:21] offset:2240
    v_pk_mul_f32 v[24:25], v[24:25], v[172:173]
    v_pk_mul_f32 v[26:27], v[26:27], v[174:175]
    v_pk_mul_f32 v[28:29], v[28:29], v[172:173]
    v_pk_mul_f32 v[30:31], v[30:31], v[174:175]
    v_cvt_pk_bf16_f32 v24, v24, v25
    v_cvt_pk_bf16_f32 v25, v26, v27
    ds_write_b64 v254, v[24:25] offset:96
    v_cvt_pk_bf16_f32 v28, v28, v29
    v_cvt_pk_bf16_f32 v29, v30, v31
    ds_write_b64 v254, v[28:29] offset:2272
    v_pk_mul_f32 v[32:33], v[32:33], v[160:161]
    v_pk_mul_f32 v[34:35], v[34:35], v[162:163]
    v_pk_mul_f32 v[36:37], v[36:37], v[160:161]
    v_pk_mul_f32 v[38:39], v[38:39], v[162:163]
    v_cvt_pk_bf16_f32 v32, v32, v33
    v_cvt_pk_bf16_f32 v33, v34, v35
    ds_write_b64 v254, v[32:33] offset:4352
    v_cvt_pk_bf16_f32 v36, v36, v37
    v_cvt_pk_bf16_f32 v37, v38, v39
    ds_write_b64 v254, v[36:37] offset:6528
    v_pk_mul_f32 v[40:41], v[40:41], v[164:165]
    v_pk_mul_f32 v[42:43], v[42:43], v[166:167]
    v_pk_mul_f32 v[44:45], v[44:45], v[164:165]
    v_pk_mul_f32 v[46:47], v[46:47], v[166:167]
    v_cvt_pk_bf16_f32 v40, v40, v41
    v_cvt_pk_bf16_f32 v41, v42, v43
    ds_write_b64 v254, v[40:41] offset:4384
    v_cvt_pk_bf16_f32 v44, v44, v45
    v_cvt_pk_bf16_f32 v45, v46, v47
    ds_write_b64 v254, v[44:45] offset:6560
    v_pk_mul_f32 v[48:49], v[48:49], v[168:169]
    v_pk_mul_f32 v[50:51], v[50:51], v[170:171]
    v_pk_mul_f32 v[52:53], v[52:53], v[168:169]
    v_pk_mul_f32 v[54:55], v[54:55], v[170:171]
    v_cvt_pk_bf16_f32 v48, v48, v49
    v_cvt_pk_bf16_f32 v49, v50, v51
    ds_write_b64 v254, v[48:49] offset:4416
    v_cvt_pk_bf16_f32 v52, v52, v53
    v_cvt_pk_bf16_f32 v53, v54, v55
    ds_write_b64 v254, v[52:53] offset:6592
    v_pk_mul_f32 v[56:57], v[56:57], v[172:173]
    v_pk_mul_f32 v[58:59], v[58:59], v[174:175]
    v_pk_mul_f32 v[60:61], v[60:61], v[172:173]
    v_pk_mul_f32 v[62:63], v[62:63], v[174:175]
    v_cvt_pk_bf16_f32 v56, v56, v57
    v_cvt_pk_bf16_f32 v57, v58, v59
    ds_write_b64 v254, v[56:57] offset:4448
    v_cvt_pk_bf16_f32 v60, v60, v61
    v_cvt_pk_bf16_f32 v61, v62, v63
    ds_write_b64 v254, v[60:61] offset:6624
    v_pk_mul_f32 v[64:65], v[64:65], v[160:161]
    v_pk_mul_f32 v[66:67], v[66:67], v[162:163]
    v_pk_mul_f32 v[68:69], v[68:69], v[160:161]
    v_pk_mul_f32 v[70:71], v[70:71], v[162:163]
    v_cvt_pk_bf16_f32 v64, v64, v65
    v_cvt_pk_bf16_f32 v65, v66, v67
    ds_write_b64 v254, v[64:65] offset:8704
    v_cvt_pk_bf16_f32 v68, v68, v69
    v_cvt_pk_bf16_f32 v69, v70, v71
    ds_write_b64 v254, v[68:69] offset:10880
    v_pk_mul_f32 v[72:73], v[72:73], v[164:165]
    v_pk_mul_f32 v[74:75], v[74:75], v[166:167]
    v_pk_mul_f32 v[76:77], v[76:77], v[164:165]
    v_pk_mul_f32 v[78:79], v[78:79], v[166:167]
    v_cvt_pk_bf16_f32 v72, v72, v73
    v_cvt_pk_bf16_f32 v73, v74, v75
    ds_write_b64 v254, v[72:73] offset:8736
    v_cvt_pk_bf16_f32 v76, v76, v77
    v_cvt_pk_bf16_f32 v77, v78, v79
    ds_write_b64 v254, v[76:77] offset:10912
    v_pk_mul_f32 v[80:81], v[80:81], v[168:169]
    v_pk_mul_f32 v[82:83], v[82:83], v[170:171]
    v_pk_mul_f32 v[84:85], v[84:85], v[168:169]
    v_pk_mul_f32 v[86:87], v[86:87], v[170:171]
    v_cvt_pk_bf16_f32 v80, v80, v81
    v_cvt_pk_bf16_f32 v81, v82, v83
    ds_write_b64 v254, v[80:81] offset:8768
    v_cvt_pk_bf16_f32 v84, v84, v85
    v_cvt_pk_bf16_f32 v85, v86, v87
    ds_write_b64 v254, v[84:85] offset:10944
    v_pk_mul_f32 v[88:89], v[88:89], v[172:173]
    v_pk_mul_f32 v[90:91], v[90:91], v[174:175]
    v_pk_mul_f32 v[92:93], v[92:93], v[172:173]
    v_pk_mul_f32 v[94:95], v[94:95], v[174:175]
    v_cvt_pk_bf16_f32 v88, v88, v89
    v_cvt_pk_bf16_f32 v89, v90, v91
    ds_write_b64 v254, v[88:89] offset:8800
    v_cvt_pk_bf16_f32 v92, v92, v93
    v_cvt_pk_bf16_f32 v93, v94, v95
    ds_write_b64 v254, v[92:93] offset:10976
    v_pk_mul_f32 v[96:97], v[96:97], v[160:161]
    v_pk_mul_f32 v[98:99], v[98:99], v[162:163]
    v_pk_mul_f32 v[100:101], v[100:101], v[160:161]
    v_pk_mul_f32 v[102:103], v[102:103], v[162:163]
    v_cvt_pk_bf16_f32 v96, v96, v97
    v_cvt_pk_bf16_f32 v97, v98, v99
    ds_write_b64 v254, v[96:97] offset:13056
    v_cvt_pk_bf16_f32 v100, v100, v101
    v_cvt_pk_bf16_f32 v101, v102, v103
    ds_write_b64 v254, v[100:101] offset:15232
    v_pk_mul_f32 v[104:105], v[104:105], v[164:165]
    v_pk_mul_f32 v[106:107], v[106:107], v[166:167]
    v_pk_mul_f32 v[108:109], v[108:109], v[164:165]
    v_pk_mul_f32 v[110:111], v[110:111], v[166:167]
    v_cvt_pk_bf16_f32 v104, v104, v105
    v_cvt_pk_bf16_f32 v105, v106, v107
    ds_write_b64 v254, v[104:105] offset:13088
    v_cvt_pk_bf16_f32 v108, v108, v109
    v_cvt_pk_bf16_f32 v109, v110, v111
    ds_write_b64 v254, v[108:109] offset:15264
    v_pk_mul_f32 v[112:113], v[112:113], v[168:169]
    v_pk_mul_f32 v[114:115], v[114:115], v[170:171]
    v_pk_mul_f32 v[116:117], v[116:117], v[168:169]
    v_pk_mul_f32 v[118:119], v[118:119], v[170:171]
    v_cvt_pk_bf16_f32 v112, v112, v113
    v_cvt_pk_bf16_f32 v113, v114, v115
    ds_write_b64 v254, v[112:113] offset:13120
    v_cvt_pk_bf16_f32 v116, v116, v117
    v_cvt_pk_bf16_f32 v117, v118, v119
    ds_write_b64 v254, v[116:117] offset:15296
    v_pk_mul_f32 v[120:121], v[120:121], v[172:173]
    v_pk_mul_f32 v[122:123], v[122:123], v[174:175]
    v_pk_mul_f32 v[124:125], v[124:125], v[172:173]
    v_pk_mul_f32 v[126:127], v[126:127], v[174:175]
    v_cvt_pk_bf16_f32 v120, v120, v121
    v_cvt_pk_bf16_f32 v121, v122, v123
    ds_write_b64 v254, v[120:121] offset:13152
    v_cvt_pk_bf16_f32 v124, v124, v125
    v_cvt_pk_bf16_f32 v125, v126, v127
    ds_write_b64 v254, v[124:125] offset:15328
L_Owr:
    s_waitcnt lgkmcnt(0)
    s_barrier
    s_waitcnt vmcnt(8)
    ds_read_b64_tr_b16 v[160:161], v251 offset:0
    ds_read_b64_tr_b16 v[162:163], v251 offset:136
    ds_read_b64_tr_b16 v[164:165], v251 offset:32
    ds_read_b64_tr_b16 v[166:167], v251 offset:168
    ds_read_b64_tr_b16 v[168:169], v251 offset:64
    ds_read_b64_tr_b16 v[170:171], v251 offset:200
    ds_read_b64_tr_b16 v[172:173], v251 offset:96
    ds_read_b64_tr_b16 v[174:175], v251 offset:232
    ds_read_b64_tr_b16 v[128:129], v250 offset:0
    ds_read_b64_tr_b16 v[130:131], v250 offset:512
    ds_read_b64_tr_b16 v[132:133], v250 offset:32
    ds_read_b64_tr_b16 v[134:135], v250 offset:544
    ds_read_b64_tr_b16 v[136:137], v250 offset:64
    ds_read_b64_tr_b16 v[138:139], v250 offset:576
    ds_read_b64_tr_b16 v[140:141], v250 offset:96
    ds_read_b64_tr_b16 v[142:143], v250 offset:608
    s_waitcnt lgkmcnt(0)
    v_mfma_f32_16x16x32_bf16 v[0:3], v[128:131], v[160:163], 0
    s_add_u32 m0, s72, 0
    s_mov_b32 s76, 32896
    v_mfma_f32_16x16x32_bf16 v[8:11], v[128:131], v[164:167], 0
    ds_read_b64_tr_b16 v[176:177], v251 offset:4352
    ds_read_b64_tr_b16 v[178:179], v251 offset:4488
    v_mfma_f32_16x16x32_bf16 v[16:19], v[128:131], v[168:171], 0
    buffer_load_dwordx4 v246, s[44:47], s76 offen offset:0 lds
    v_mfma_f32_16x16x32_bf16 v[24:27], v[128:131], v[172:175], 0
    ds_read_b64_tr_b16 v[180:181], v251 offset:4384
    ds_read_b64_tr_b16 v[182:183], v251 offset:4520
    v_mfma_f32_16x16x32_bf16 v[28:31], v[132:135], v[172:175], 0
    buffer_load_dwordx4 v247, s[44:47], s76 offen offset:1056 lds
    s_waitcnt vmcnt(6)
    v_mfma_f32_16x16x32_bf16 v[20:23], v[132:135], v[168:171], 0
    ds_read_b64_tr_b16 v[144:145], v250 offset:4352
    ds_read_b64_tr_b16 v[146:147], v250 offset:4864
    v_mfma_f32_16x16x32_bf16 v[12:15], v[132:135], v[164:167], 0
    buffer_load_dwordx4 v248, s[44:47], s76 offen offset:2112 lds
    v_mfma_f32_16x16x32_bf16 v[4:7], v[132:135], v[160:163], 0
    ds_read_b64_tr_b16 v[148:149], v250 offset:4384
    ds_read_b64_tr_b16 v[150:151], v250 offset:4896
    v_mfma_f32_16x16x32_bf16 v[32:35], v[136:139], v[160:163], 0
    buffer_load_dwordx4 v249, s[44:47], s76 offen offset:3168 lds
    v_mfma_f32_16x16x32_bf16 v[40:43], v[136:139], v[164:167], 0
    ds_read_b64_tr_b16 v[152:153], v250 offset:4416
    ds_read_b64_tr_b16 v[154:155], v250 offset:4928
    v_mfma_f32_16x16x32_bf16 v[48:51], v[136:139], v[168:171], 0
    ds_read_b64_tr_b16 v[156:157], v250 offset:4448
    ds_read_b64_tr_b16 v[158:159], v250 offset:4960
    v_mfma_f32_16x16x32_bf16 v[56:59], v[136:139], v[172:175], 0
    v_mfma_f32_16x16x32_bf16 v[60:63], v[140:143], v[172:175], 0
    v_mfma_f32_16x16x32_bf16 v[52:55], v[140:143], v[168:171], 0
    v_mfma_f32_16x16x32_bf16 v[44:47], v[140:143], v[164:167], 0
    v_mfma_f32_16x16x32_bf16 v[36:39], v[140:143], v[160:163], 0
    s_waitcnt lgkmcnt(0)
    v_mfma_f32_16x16x32_bf16 v[64:67], v[144:147], v[160:163], 0
    s_add_u32 m0, s72, 4352
    s_mov_b32 s76, 65536
    v_mfma_f32_16x16x32_bf16 v[72:75], v[144:147], v[164:167], 0
    ds_read_b64_tr_b16 v[184:185], v251 offset:4416
    ds_read_b64_tr_b16 v[186:187], v251 offset:4552
    v_mfma_f32_16x16x32_bf16 v[80:83], v[144:147], v[168:171], 0
    buffer_load_dwordx4 v246, s[44:47], s76 offen offset:0 lds
    v_mfma_f32_16x16x32_bf16 v[88:91], v[144:147], v[172:175], 0
    ds_read_b64_tr_b16 v[188:189], v251 offset:4448
    ds_read_b64_tr_b16 v[190:191], v251 offset:4584
    v_mfma_f32_16x16x32_bf16 v[92:95], v[148:151], v[172:175], 0
    buffer_load_dwordx4 v247, s[44:47], s76 offen offset:1056 lds
    s_waitcnt vmcnt(6)
    v_mfma_f32_16x16x32_bf16 v[84:87], v[148:151], v[168:171], 0
    ds_read_b64_tr_b16 v[128:129], v250 offset:8704
    ds_read_b64_tr_b16 v[130:131], v250 offset:9216
    v_mfma_f32_16x16x32_bf16 v[76:79], v[148:151], v[164:167], 0
    buffer_load_dwordx4 v248, s[44:47], s76 offen offset:2112 lds
    v_mfma_f32_16x16x32_bf16 v[68:71], v[148:151], v[160:163], 0
    ds_read_b64_tr_b16 v[132:133], v250 offset:8736
    ds_read_b64_tr_b16 v[134:135], v250 offset:9248
    v_mfma_f32_16x16x32_bf16 v[96:99], v[152:155], v[160:163], 0
    buffer_load_dwordx4 v249, s[44:47], s76 offen offset:3168 lds
    v_mfma_f32_16x16x32_bf16 v[104:107], v[152:155], v[164:167], 0
    ds_read_b64_tr_b16 v[136:137], v250 offset:8768
    ds_read_b64_tr_b16 v[138:139], v250 offset:9280
    v_mfma_f32_16x16x32_bf16 v[112:115], v[152:155], v[168:171], 0
    ds_read_b64_tr_b16 v[140:141], v250 offset:8800
    ds_read_b64_tr_b16 v[142:143], v250 offset:9312
    v_mfma_f32_16x16x32_bf16 v[120:123], v[152:155], v[172:175], 0
    v_mfma_f32_16x16x32_bf16 v[124:127], v[156:159], v[172:175], 0
    v_mfma_f32_16x16x32_bf16 v[116:119], v[156:159], v[168:171], 0
    v_mfma_f32_16x16x32_bf16 v[108:111], v[156:159], v[164:167], 0
    v_mfma_f32_16x16x32_bf16 v[100:103], v[156:159], v[160:163], 0
    s_waitcnt lgkmcnt(0)
    v_mfma_f32_16x16x32_bf16 v[0:3], v[128:131], v[176:179], v[0:3]
    s_add_u32 m0, s72, 8704
    s_mov_b32 s76, 65664
    v_mfma_f32_16x16x32_bf16 v[8:11], v[128:131], v[180:183], v[8:11]
    ds_read_b64_tr_b16 v[160:161], v251 offset:8704
    ds_read_b64_tr_b16 v[162:163], v251 offset:8840
    v_mfma_f32_16x16x32_bf16 v[16:19], v[128:131], v[184:187], v[16:19]
    buffer_load_dwordx4 v246, s[44:47], s76 offen offset:0 lds
    v_mfma_f32_16x16x32_bf16 v[24:27], v[128:131], v[188:191], v[24:27]
    ds_read_b64_tr_b16 v[164:165], v251 offset:8736
    ds_read_b64_tr_b16 v[166:167], v251 offset:8872
    v_mfma_f32_16x16x32_bf16 v[28:31], v[132:135], v[188:191], v[28:31]
    buffer_load_dwordx4 v247, s[44:47], s76 offen offset:1056 lds
    s_waitcnt vmcnt(6)
    v_mfma_f32_16x16x32_bf16 v[20:23], v[132:135], v[184:187], v[20:23]
    ds_read_b64_tr_b16 v[144:145], v250 offset:0
    ds_read_b64_tr_b16 v[146:147], v250 offset:512
    v_mfma_f32_16x16x32_bf16 v[12:15], v[132:135], v[180:183], v[12:15]
    buffer_load_dwordx4 v248, s[44:47], s76 offen offset:2112 lds
    v_mfma_f32_16x16x32_bf16 v[4:7], v[132:135], v[176:179], v[4:7]
    ds_read_b64_tr_b16 v[148:149], v250 offset:32
    ds_read_b64_tr_b16 v[150:151], v250 offset:544
    v_mfma_f32_16x16x32_bf16 v[32:35], v[136:139], v[176:179], v[32:35]
    buffer_load_dwordx4 v249, s[44:47], s76 offen offset:3168 lds
    v_mfma_f32_16x16x32_bf16 v[40:43], v[136:139], v[180:183], v[40:43]
    ds_read_b64_tr_b16 v[152:153], v250 offset:64
    ds_read_b64_tr_b16 v[154:155], v250 offset:576
    v_mfma_f32_16x16x32_bf16 v[48:51], v[136:139], v[184:187], v[48:51]
    ds_read_b64_tr_b16 v[156:157], v250 offset:96
    ds_read_b64_tr_b16 v[158:159], v250 offset:608
    v_mfma_f32_16x16x32_bf16 v[56:59], v[136:139], v[188:191], v[56:59]
    v_mfma_f32_16x16x32_bf16 v[60:63], v[140:143], v[188:191], v[60:63]
    v_mfma_f32_16x16x32_bf16 v[52:55], v[140:143], v[184:187], v[52:55]
    v_mfma_f32_16x16x32_bf16 v[44:47], v[140:143], v[180:183], v[44:47]
    v_mfma_f32_16x16x32_bf16 v[36:39], v[140:143], v[176:179], v[36:39]
    s_waitcnt lgkmcnt(0)
    v_mfma_f32_16x16x32_bf16 v[64:67], v[144:147], v[176:179], v[64:67]
    s_add_u32 m0, s72, 0
    s_mov_b32 s76, 98304
    v_mfma_f32_16x16x32_bf16 v[72:75], v[144:147], v[180:183], v[72:75]
    ds_read_b64_tr_b16 v[168:169], v251 offset:8768
    ds_read_b64_tr_b16 v[170:171], v251 offset:8904
    v_mfma_f32_16x16x32_bf16 v[80:83], v[144:147], v[184:187], v[80:83]
    buffer_load_dwordx4 v246, s[44:47], s76 offen offset:0 lds
    v_mfma_f32_16x16x32_bf16 v[88:91], v[144:147], v[188:191], v[88:91]
    ds_read_b64_tr_b16 v[172:173], v251 offset:8800
    ds_read_b64_tr_b16 v[174:175], v251 offset:8936
    v_mfma_f32_16x16x32_bf16 v[92:95], v[148:151], v[188:191], v[92:95]
    buffer_load_dwordx4 v247, s[44:47], s76 offen offset:1056 lds
    s_waitcnt vmcnt(6)
    v_mfma_f32_16x16x32_bf16 v[84:87], v[148:151], v[184:187], v[84:87]
    ds_read_b64_tr_b16 v[128:129], v250 offset:4352
    ds_read_b64_tr_b16 v[130:131], v250 offset:4864
    v_mfma_f32_16x16x32_bf16 v[76:79], v[148:151], v[180:183], v[76:79]
    buffer_load_dwordx4 v248, s[44:47], s76 offen offset:2112 lds
    v_mfma_f32_16x16x32_bf16 v[68:71], v[148:151], v[176:179], v[68:71]
    ds_read_b64_tr_b16 v[132:133], v250 offset:4384
    ds_read_b64_tr_b16 v[134:135], v250 offset:4896
    v_mfma_f32_16x16x32_bf16 v[96:99], v[152:155], v[176:179], v[96:99]
    buffer_load_dwordx4 v249, s[44:47], s76 offen offset:3168 lds
    v_mfma_f32_16x16x32_bf16 v[104:107], v[152:155], v[180:183], v[104:107]
    ds_read_b64_tr_b16 v[136:137], v250 offset:4416
    ds_read_b64_tr_b16 v[138:139], v250 offset:4928
    v_mfma_f32_16x16x32_bf16 v[112:115], v[152:155], v[184:187], v[112:115]
    ds_read_b64_tr_b16 v[140:141], v250 offset:4448
    ds_read_b64_tr_b16 v[142:143], v250 offset:4960
    v_mfma_f32_16x16x32_bf16 v[120:123], v[152:155], v[188:191], v[120:123]
    v_mfma_f32_16x16x32_bf16 v[124:127], v[156:159], v[188:191], v[124:127]
    v_mfma_f32_16x16x32_bf16 v[116:119], v[156:159], v[184:187], v[116:119]
    v_mfma_f32_16x16x32_bf16 v[108:111], v[156:159], v[180:183], v[108:111]
    v_mfma_f32_16x16x32_bf16 v[100:103], v[156:159], v[176:179], v[100:103]
    s_waitcnt lgkmcnt(0)
    v_mfma_f32_16x16x32_bf16 v[0:3], v[128:131], v[160:163], v[0:3]
    s_add_u32 m0, s72, 4352
    s_mov_b32 s76, 98432
    v_mfma_f32_16x16x32_bf16 v[8:11], v[128:131], v[164:167], v[8:11]
    ds_read_b64_tr_b16 v[176:177], v251 offset:13056
    ds_read_b64_tr_b16 v[178:179], v251 offset:13192
    v_mfma_f32_16x16x32_bf16 v[16:19], v[128:131], v[168:171], v[16:19]
    buffer_load_dwordx4 v246, s[44:47], s76 offen offset:0 lds
    v_mfma_f32_16x16x32_bf16 v[24:27], v[128:131], v[172:175], v[24:27]
    ds_read_b64_tr_b16 v[180:181], v251 offset:13088
    ds_read_b64_tr_b16 v[182:183], v251 offset:13224
    v_mfma_f32_16x16x32_bf16 v[28:31], v[132:135], v[172:175], v[28:31]
    buffer_load_dwordx4 v247, s[44:47], s76 offen offset:1056 lds
    s_waitcnt vmcnt(6)
    v_mfma_f32_16x16x32_bf16 v[20:23], v[132:135], v[168:171], v[20:23]
    ds_read_b64_tr_b16 v[144:145], v250 offset:8704
    ds_read_b64_tr_b16 v[146:147], v250 offset:9216
    v_mfma_f32_16x16x32_bf16 v[12:15], v[132:135], v[164:167], v[12:15]
    buffer_load_dwordx4 v248, s[44:47], s76 offen offset:2112 lds
    v_mfma_f32_16x16x32_bf16 v[4:7], v[132:135], v[160:163], v[4:7]
    ds_read_b64_tr_b16 v[148:149], v250 offset:8736
    ds_read_b64_tr_b16 v[150:151], v250 offset:9248
    v_mfma_f32_16x16x32_bf16 v[32:35], v[136:139], v[160:163], v[32:35]
    buffer_load_dwordx4 v249, s[44:47], s76 offen offset:3168 lds
    v_mfma_f32_16x16x32_bf16 v[40:43], v[136:139], v[164:167], v[40:43]
    ds_read_b64_tr_b16 v[152:153], v250 offset:8768
    ds_read_b64_tr_b16 v[154:155], v250 offset:9280
    v_mfma_f32_16x16x32_bf16 v[48:51], v[136:139], v[168:171], v[48:51]
    ds_read_b64_tr_b16 v[156:157], v250 offset:8800
    ds_read_b64_tr_b16 v[158:159], v250 offset:9312
    v_mfma_f32_16x16x32_bf16 v[56:59], v[136:139], v[172:175], v[56:59]
    v_mfma_f32_16x16x32_bf16 v[60:63], v[140:143], v[172:175], v[60:63]
    v_mfma_f32_16x16x32_bf16 v[52:55], v[140:143], v[168:171], v[52:55]
    v_mfma_f32_16x16x32_bf16 v[44:47], v[140:143], v[164:167], v[44:47]
    v_mfma_f32_16x16x32_bf16 v[36:39], v[140:143], v[160:163], v[36:39]
    s_waitcnt lgkmcnt(0)
    v_mfma_f32_16x16x32_bf16 v[64:67], v[144:147], v[160:163], v[64:67]
    s_add_u32 m0, s72, 8704
    s_mov_b32 s76, 131072
    v_mfma_f32_16x16x32_bf16 v[72:75], v[144:147], v[164:167], v[72:75]
    ds_read_b64_tr_b16 v[184:185], v251 offset:13120
    ds_read_b64_tr_b16 v[186:187], v251 offset:13256
    v_mfma_f32_16x16x32_bf16 v[80:83], v[144:147], v[168:171], v[80:83]
    buffer_load_dwordx4 v246, s[44:47], s76 offen offset:0 lds
    v_mfma_f32_16x16x32_bf16 v[88:91], v[144:147], v[172:175], v[88:91]
    ds_read_b64_tr_b16 v[188:189], v251 offset:13152
    ds_read_b64_tr_b16 v[190:191], v251 offset:13288
    v_mfma_f32_16x16x32_bf16 v[92:95], v[148:151], v[172:175], v[92:95]
    buffer_load_dwordx4 v247, s[44:47], s76 offen offset:1056 lds
    s_waitcnt vmcnt(6)
    v_mfma_f32_16x16x32_bf16 v[84:87], v[148:151], v[168:171], v[84:87]
    ds_read_b64_tr_b16 v[128:129], v250 offset:0
    ds_read_b64_tr_b16 v[130:131], v250 offset:512
    v_mfma_f32_16x16x32_bf16 v[76:79], v[148:151], v[164:167], v[76:79]
    buffer_load_dwordx4 v248, s[44:47], s76 offen offset:2112 lds
    v_mfma_f32_16x16x32_bf16 v[68:71], v[148:151], v[160:163], v[68:71]
    ds_read_b64_tr_b16 v[132:133], v250 offset:32
    ds_read_b64_tr_b16 v[134:135], v250 offset:544
    v_mfma_f32_16x16x32_bf16 v[96:99], v[152:155], v[160:163], v[96:99]
    buffer_load_dwordx4 v249, s[44:47], s76 offen offset:3168 lds
    v_mfma_f32_16x16x32_bf16 v[104:107], v[152:155], v[164:167], v[104:107]
    ds_read_b64_tr_b16 v[136:137], v250 offset:64
    ds_read_b64_tr_b16 v[138:139], v250 offset:576
    v_mfma_f32_16x16x32_bf16 v[112:115], v[152:155], v[168:171], v[112:115]
    ds_read_b64_tr_b16 v[140:141], v250 offset:96
    ds_read_b64_tr_b16 v[142:143], v250 offset:608
    v_mfma_f32_16x16x32_bf16 v[120:123], v[152:155], v[172:175], v[120:123]
    v_mfma_f32_16x16x32_bf16 v[124:127], v[156:159], v[172:175], v[124:127]
    v_mfma_f32_16x16x32_bf16 v[116:119], v[156:159], v[168:171], v[116:119]
    v_mfma_f32_16x16x32_bf16 v[108:111], v[156:159], v[164:167], v[108:111]
    v_mfma_f32_16x16x32_bf16 v[100:103], v[156:159], v[160:163], v[100:103]
    s_waitcnt lgkmcnt(0)
    v_mfma_f32_16x16x32_bf16 v[0:3], v[128:131], v[176:179], v[0:3]
    s_add_u32 m0, s72, 0
    s_mov_b32 s76, 131200
    v_mfma_f32_16x16x32_bf16 v[8:11], v[128:131], v[180:183], v[8:11]
    ds_read_b64_tr_b16 v[160:161], v251 offset:17408
    ds_read_b64_tr_b16 v[162:163], v251 offset:17544
    v_mfma_f32_16x16x32_bf16 v[16:19], v[128:131], v[184:187], v[16:19]
    buffer_load_dwordx4 v246, s[44:47], s76 offen offset:0 lds
    v_mfma_f32_16x16x32_bf16 v[24:27], v[128:131], v[188:191], v[24:27]
    ds_read_b64_tr_b16 v[164:165], v251 offset:17440
    ds_read_b64_tr_b16 v[166:167], v251 offset:17576
    v_mfma_f32_16x16x32_bf16 v[28:31], v[132:135], v[188:191], v[28:31]
    buffer_load_dwordx4 v247, s[44:47], s76 offen offset:1056 lds
    s_waitcnt vmcnt(6)
    v_mfma_f32_16x16x32_bf16 v[20:23], v[132:135], v[184:187], v[20:23]
    ds_read_b64_tr_b16 v[144:145], v250 offset:4352
    ds_read_b64_tr_b16 v[146:147], v250 offset:4864
    v_mfma_f32_16x16x32_bf16 v[12:15], v[132:135], v[180:183], v[12:15]
    buffer_load_dwordx4 v248, s[44:47], s76 offen offset:2112 lds
    v_mfma_f32_16x16x32_bf16 v[4:7], v[132:135], v[176:179], v[4:7]
    ds_read_b64_tr_b16 v[148:149], v250 offset:4384
    ds_read_b64_tr_b16 v[150:151], v250 offset:4896
    v_mfma_f32_16x16x32_bf16 v[32:35], v[136:139], v[176:179], v[32:35]
    buffer_load_dwordx4 v249, s[44:47], s76 offen offset:3168 lds
    v_mfma_f32_16x16x32_bf16 v[40:43], v[136:139], v[180:183], v[40:43]
    ds_read_b64_tr_b16 v[152:153], v250 offset:4416
    ds_read_b64_tr_b16 v[154:155], v250 offset:4928
    v_mfma_f32_16x16x32_bf16 v[48:51], v[136:139], v[184:187], v[48:51]
    ds_read_b64_tr_b16 v[156:157], v250 offset:4448
    ds_read_b64_tr_b16 v[158:159], v250 offset:4960
    v_mfma_f32_16x16x32_bf16 v[56:59], v[136:139], v[188:191], v[56:59]
    v_mfma_f32_16x16x32_bf16 v[60:63], v[140:143], v[188:191], v[60:63]
    v_mfma_f32_16x16x32_bf16 v[52:55], v[140:143], v[184:187], v[52:55]
    v_mfma_f32_16x16x32_bf16 v[44:47], v[140:143], v[180:183], v[44:47]
    v_mfma_f32_16x16x32_bf16 v[36:39], v[140:143], v[176:179], v[36:39]
    s_waitcnt lgkmcnt(0)
    v_mfma_f32_16x16x32_bf16 v[64:67], v[144:147], v[176:179], v[64:67]
    s_add_u32 m0, s72, 4352
    s_mov_b32 s76, 163840
    v_mfma_f32_16x16x32_bf16 v[72:75], v[144:147], v[180:183], v[72:75]
    ds_read_b64_tr_b16 v[168:169], v251 offset:17472
    ds_read_b64_tr_b16 v[170:171], v251 offset:17608
    v_mfma_f32_16x16x32_bf16 v[80:83], v[144:147], v[184:187], v[80:83]
    buffer_load_dwordx4 v246, s[44:47], s76 offen offset:0 lds
    v_mfma_f32_16x16x32_bf16 v[88:91], v[144:147], v[188:191], v[88:91]
    ds_read_b64_tr_b16 v[172:173], v251 offset:17504
    ds_read_b64_tr_b16 v[174:175], v251 offset:17640
    v_mfma_f32_16x16x32_bf16 v[92:95], v[148:151], v[188:191], v[92:95]
    buffer_load_dwordx4 v247, s[44:47], s76 offen offset:1056 lds
    s_waitcnt vmcnt(6)
    v_mfma_f32_16x16x32_bf16 v[84:87], v[148:151], v[184:187], v[84:87]
    ds_read_b64_tr_b16 v[128:129], v250 offset:8704
    ds_read_b64_tr_b16 v[130:131], v250 offset:9216
    v_mfma_f32_16x16x32_bf16 v[76:79], v[148:151], v[180:183], v[76:79]
    buffer_load_dwordx4 v248, s[44:47], s76 offen offset:2112 lds
    v_mfma_f32_16x16x32_bf16 v[68:71], v[148:151], v[176:179], v[68:71]
    ds_read_b64_tr_b16 v[132:133], v250 offset:8736
    ds_read_b64_tr_b16 v[134:135], v250 offset:9248
    v_mfma_f32_16x16x32_bf16 v[96:99], v[152:155], v[176:179], v[96:99]
    buffer_load_dwordx4 v249, s[44:47], s76 offen offset:3168 lds
    v_mfma_f32_16x16x32_bf16 v[104:107], v[152:155], v[180:183], v[104:107]
    ds_read_b64_tr_b16 v[136:137], v250 offset:8768
    ds_read_b64_tr_b16 v[138:139], v250 offset:9280
    v_mfma_f32_16x16x32_bf16 v[112:115], v[152:155], v[184:187], v[112:115]
    ds_read_b64_tr_b16 v[140:141], v250 offset:8800
    ds_read_b64_tr_b16 v[142:143], v250 offset:9312
    v_mfma_f32_16x16x32_bf16 v[120:123], v[152:155], v[188:191], v[120:123]
    v_mfma_f32_16x16x32_bf16 v[124:127], v[156:159], v[188:191], v[124:127]
    v_mfma_f32_16x16x32_bf16 v[116:119], v[156:159], v[184:187], v[116:119]
    v_mfma_f32_16x16x32_bf16 v[108:111], v[156:159], v[180:183], v[108:111]
    v_mfma_f32_16x16x32_bf16 v[100:103], v[156:159], v[176:179], v[100:103]
    s_waitcnt lgkmcnt(0)
    v_mfma_f32_16x16x32_bf16 v[0:3], v[128:131], v[160:163], v[0:3]
    s_add_u32 m0, s72, 8704
    s_mov_b32 s76, 163968
    v_mfma_f32_16x16x32_bf16 v[8:11], v[128:131], v[164:167], v[8:11]
    ds_read_b64_tr_b16 v[176:177], v251 offset:21760
    ds_read_b64_tr_b16 v[178:179], v251 offset:21896
    v_mfma_f32_16x16x32_bf16 v[16:19], v[128:131], v[168:171], v[16:19]
    buffer_load_dwordx4 v246, s[44:47], s76 offen offset:0 lds
    v_mfma_f32_16x16x32_bf16 v[24:27], v[128:131], v[172:175], v[24:27]
    ds_read_b64_tr_b16 v[180:181], v251 offset:21792
    ds_read_b64_tr_b16 v[182:183], v251 offset:21928
    v_mfma_f32_16x16x32_bf16 v[28:31], v[132:135], v[172:175], v[28:31]
    buffer_load_dwordx4 v247, s[44:47], s76 offen offset:1056 lds
    s_waitcnt vmcnt(6)
    v_mfma_f32_16x16x32_bf16 v[20:23], v[132:135], v[168:171], v[20:23]
    ds_read_b64_tr_b16 v[144:145], v250 offset:0
    ds_read_b64_tr_b16 v[146:147], v250 offset:512
    v_mfma_f32_16x16x32_bf16 v[12:15], v[132:135], v[164:167], v[12:15]
    buffer_load_dwordx4 v248, s[44:47], s76 offen offset:2112 lds
    v_mfma_f32_16x16x32_bf16 v[4:7], v[132:135], v[160:163], v[4:7]
    ds_read_b64_tr_b16 v[148:149], v250 offset:32
    ds_read_b64_tr_b16 v[150:151], v250 offset:544
    v_mfma_f32_16x16x32_bf16 v[32:35], v[136:139], v[160:163], v[32:35]
    buffer_load_dwordx4 v249, s[44:47], s76 offen offset:3168 lds
    v_mfma_f32_16x16x32_bf16 v[40:43], v[136:139], v[164:167], v[40:43]
    ds_read_b64_tr_b16 v[152:153], v250 offset:64
    ds_read_b64_tr_b16 v[154:155], v250 offset:576
    v_mfma_f32_16x16x32_bf16 v[48:51], v[136:139], v[168:171], v[48:51]
    ds_read_b64_tr_b16 v[156:157], v250 offset:96
    ds_read_b64_tr_b16 v[158:159], v250 offset:608
    v_mfma_f32_16x16x32_bf16 v[56:59], v[136:139], v[172:175], v[56:59]
    v_mfma_f32_16x16x32_bf16 v[60:63], v[140:143], v[172:175], v[60:63]
    v_mfma_f32_16x16x32_bf16 v[52:55], v[140:143], v[168:171], v[52:55]
    v_mfma_f32_16x16x32_bf16 v[44:47], v[140:143], v[164:167], v[44:47]
    v_mfma_f32_16x16x32_bf16 v[36:39], v[140:143], v[160:163], v[36:39]
    s_waitcnt lgkmcnt(0)
    v_mfma_f32_16x16x32_bf16 v[64:67], v[144:147], v[160:163], v[64:67]
    s_add_u32 m0, s72, 0
    s_mov_b32 s76, 196608
    v_mfma_f32_16x16x32_bf16 v[72:75], v[144:147], v[164:167], v[72:75]
    ds_read_b64_tr_b16 v[184:185], v251 offset:21824
    ds_read_b64_tr_b16 v[186:187], v251 offset:21960
    v_mfma_f32_16x16x32_bf16 v[80:83], v[144:147], v[168:171], v[80:83]
    buffer_load_dwordx4 v246, s[44:47], s76 offen offset:0 lds
    v_mfma_f32_16x16x32_bf16 v[88:91], v[144:147], v[172:175], v[88:91]
    ds_read_b64_tr_b16 v[188:189], v251 offset:21856
    ds_read_b64_tr_b16 v[190:191], v251 offset:21992
    v_mfma_f32_16x16x32_bf16 v[92:95], v[148:151], v[172:175], v[92:95]
    buffer_load_dwordx4 v247, s[44:47], s76 offen offset:1056 lds
    s_waitcnt vmcnt(6)
    v_mfma_f32_16x16x32_bf16 v[84:87], v[148:151], v[168:171], v[84:87]
    ds_read_b64_tr_b16 v[128:129], v250 offset:4352
    ds_read_b64_tr_b16 v[130:131], v250 offset:4864
    v_mfma_f32_16x16x32_bf16 v[76:79], v[148:151], v[164:167], v[76:79]
    buffer_load_dwordx4 v248, s[44:47], s76 offen offset:2112 lds
    v_mfma_f32_16x16x32_bf16 v[68:71], v[148:151], v[160:163], v[68:71]
    ds_read_b64_tr_b16 v[132:133], v250 offset:4384
    ds_read_b64_tr_b16 v[134:135], v250 offset:4896
    v_mfma_f32_16x16x32_bf16 v[96:99], v[152:155], v[160:163], v[96:99]
    buffer_load_dwordx4 v249, s[44:47], s76 offen offset:3168 lds
    v_mfma_f32_16x16x32_bf16 v[104:107], v[152:155], v[164:167], v[104:107]
    ds_read_b64_tr_b16 v[136:137], v250 offset:4416
    ds_read_b64_tr_b16 v[138:139], v250 offset:4928
    v_mfma_f32_16x16x32_bf16 v[112:115], v[152:155], v[168:171], v[112:115]
    ds_read_b64_tr_b16 v[140:141], v250 offset:4448
    ds_read_b64_tr_b16 v[142:143], v250 offset:4960
    v_mfma_f32_16x16x32_bf16 v[120:123], v[152:155], v[172:175], v[120:123]
    v_mfma_f32_16x16x32_bf16 v[124:127], v[156:159], v[172:175], v[124:127]
    v_mfma_f32_16x16x32_bf16 v[116:119], v[156:159], v[168:171], v[116:119]
    v_mfma_f32_16x16x32_bf16 v[108:111], v[156:159], v[164:167], v[108:111]
    v_mfma_f32_16x16x32_bf16 v[100:103], v[156:159], v[160:163], v[100:103]
    s_waitcnt lgkmcnt(0)
    v_mfma_f32_16x16x32_bf16 v[0:3], v[128:131], v[176:179], v[0:3]
    s_add_u32 m0, s72, 4352
    s_mov_b32 s76, 196736
    v_mfma_f32_16x16x32_bf16 v[8:11], v[128:131], v[180:183], v[8:11]
    ds_read_b64_tr_b16 v[160:161], v251 offset:26112
    ds_read_b64_tr_b16 v[162:163], v251 offset:26248
    v_mfma_f32_16x16x32_bf16 v[16:19], v[128:131], v[184:187], v[16:19]
    buffer_load_dwordx4 v246, s[44:47], s76 offen offset:0 lds
    v_mfma_f32_16x16x32_bf16 v[24:27], v[128:131], v[188:191], v[24:27]
    ds_read_b64_tr_b16 v[164:165], v251 offset:26144
    ds_read_b64_tr_b16 v[166:167], v251 offset:26280
    v_mfma_f32_16x16x32_bf16 v[28:31], v[132:135], v[188:191], v[28:31]
    buffer_load_dwordx4 v247, s[44:47], s76 offen offset:1056 lds
    s_waitcnt vmcnt(6)
    v_mfma_f32_16x16x32_bf16 v[20:23], v[132:135], v[184:187], v[20:23]
    ds_read_b64_tr_b16 v[144:145], v250 offset:8704
    ds_read_b64_tr_b16 v[146:147], v250 offset:9216
    v_mfma_f32_16x16x32_bf16 v[12:15], v[132:135], v[180:183], v[12:15]
    buffer_load_dwordx4 v248, s[44:47], s76 offen offset:2112 lds
    v_mfma_f32_16x16x32_bf16 v[4:7], v[132:135], v[176:179], v[4:7]
    ds_read_b64_tr_b16 v[148:149], v250 offset:8736
    ds_read_b64_tr_b16 v[150:151], v250 offset:9248
    v_mfma_f32_16x16x32_bf16 v[32:35], v[136:139], v[176:179], v[32:35]
    buffer_load_dwordx4 v249, s[44:47], s76 offen offset:3168 lds
    v_mfma_f32_16x16x32_bf16 v[40:43], v[136:139], v[180:183], v[40:43]
    ds_read_b64_tr_b16 v[152:153], v250 offset:8768
    ds_read_b64_tr_b16 v[154:155], v250 offset:9280
    v_mfma_f32_16x16x32_bf16 v[48:51], v[136:139], v[184:187], v[48:51]
    ds_read_b64_tr_b16 v[156:157], v250 offset:8800
    ds_read_b64_tr_b16 v[158:159], v250 offset:9312
    v_mfma_f32_16x16x32_bf16 v[56:59], v[136:139], v[188:191], v[56:59]
    v_mfma_f32_16x16x32_bf16 v[60:63], v[140:143], v[188:191], v[60:63]
    v_mfma_f32_16x16x32_bf16 v[52:55], v[140:143], v[184:187], v[52:55]
    v_mfma_f32_16x16x32_bf16 v[44:47], v[140:143], v[180:183], v[44:47]
    v_mfma_f32_16x16x32_bf16 v[36:39], v[140:143], v[176:179], v[36:39]
    s_waitcnt lgkmcnt(0)
    v_mfma_f32_16x16x32_bf16 v[64:67], v[144:147], v[176:179], v[64:67]
    s_add_u32 m0, s72, 8704
    s_mov_b32 s76, 229376
    v_mfma_f32_16x16x32_bf16 v[72:75], v[144:147], v[180:183], v[72:75]
    ds_read_b64_tr_b16 v[168:169], v251 offset:26176
    ds_read_b64_tr_b16 v[170:171], v251 offset:26312
    v_mfma_f32_16x16x32_bf16 v[80:83], v[144:147], v[184:187], v[80:83]
    buffer_load_dwordx4 v246, s[44:47], s76 offen offset:0 lds
    v_mfma_f32_16x16x32_bf16 v[88:91], v[144:147], v[188:191], v[88:91]
    ds_read_b64_tr_b16 v[172:173], v251 offset:26208
    ds_read_b64_tr_b16 v[174:175], v251 offset:26344
    v_mfma_f32_16x16x32_bf16 v[92:95], v[148:151], v[188:191], v[92:95]
    buffer_load_dwordx4 v247, s[44:47], s76 offen offset:1056 lds
    s_waitcnt vmcnt(6)
    v_mfma_f32_16x16x32_bf16 v[84:87], v[148:151], v[184:187], v[84:87]
    ds_read_b64_tr_b16 v[128:129], v250 offset:0
    ds_read_b64_tr_b16 v[130:131], v250 offset:512
    v_mfma_f32_16x16x32_bf16 v[76:79], v[148:151], v[180:183], v[76:79]
    buffer_load_dwordx4 v248, s[44:47], s76 offen offset:2112 lds
    v_mfma_f32_16x16x32_bf16 v[68:71], v[148:151], v[176:179], v[68:71]
    ds_read_b64_tr_b16 v[132:133], v250 offset:32
    ds_read_b64_tr_b16 v[134:135], v250 offset:544
    v_mfma_f32_16x16x32_bf16 v[96:99], v[152:155], v[176:179], v[96:99]
    buffer_load_dwordx4 v249, s[44:47], s76 offen offset:3168 lds
    v_mfma_f32_16x16x32_bf16 v[104:107], v[152:155], v[180:183], v[104:107]
    ds_read_b64_tr_b16 v[136:137], v250 offset:64
    ds_read_b64_tr_b16 v[138:139], v250 offset:576
    v_mfma_f32_16x16x32_bf16 v[112:115], v[152:155], v[184:187], v[112:115]
    ds_read_b64_tr_b16 v[140:141], v250 offset:96
    ds_read_b64_tr_b16 v[142:143], v250 offset:608
    v_mfma_f32_16x16x32_bf16 v[120:123], v[152:155], v[188:191], v[120:123]
    v_mfma_f32_16x16x32_bf16 v[124:127], v[156:159], v[188:191], v[124:127]
    v_mfma_f32_16x16x32_bf16 v[116:119], v[156:159], v[184:187], v[116:119]
    v_mfma_f32_16x16x32_bf16 v[108:111], v[156:159], v[180:183], v[108:111]
    v_mfma_f32_16x16x32_bf16 v[100:103], v[156:159], v[176:179], v[100:103]
    s_waitcnt lgkmcnt(0)
    v_mfma_f32_16x16x32_bf16 v[0:3], v[128:131], v[160:163], v[0:3]
    s_add_u32 m0, s72, 0
    s_mov_b32 s76, 229504
    v_mfma_f32_16x16x32_bf16 v[8:11], v[128:131], v[164:167], v[8:11]
    ds_read_b64_tr_b16 v[176:177], v251 offset:30464
    ds_read_b64_tr_b16 v[178:179], v251 offset:30600
    v_mfma_f32_16x16x32_bf16 v[16:19], v[128:131], v[168:171], v[16:19]
    buffer_load_dwordx4 v246, s[44:47], s76 offen offset:0 lds
    v_mfma_f32_16x16x32_bf16 v[24:27], v[128:131], v[172:175], v[24:27]
    ds_read_b64_tr_b16 v[180:181], v251 offset:30496
    ds_read_b64_tr_b16 v[182:183], v251 offset:30632
    v_mfma_f32_16x16x32_bf16 v[28:31], v[132:135], v[172:175], v[28:31]
    buffer_load_dwordx4 v247, s[44:47], s76 offen offset:1056 lds
    s_waitcnt vmcnt(6)
    v_mfma_f32_16x16x32_bf16 v[20:23], v[132:135], v[168:171], v[20:23]
    ds_read_b64_tr_b16 v[144:145], v250 offset:4352
    ds_read_b64_tr_b16 v[146:147], v250 offset:4864
    v_mfma_f32_16x16x32_bf16 v[12:15], v[132:135], v[164:167], v[12:15]
    buffer_load_dwordx4 v248, s[44:47], s76 offen offset:2112 lds
    v_mfma_f32_16x16x32_bf16 v[4:7], v[132:135], v[160:163], v[4:7]
    ds_read_b64_tr_b16 v[148:149], v250 offset:4384
    ds_read_b64_tr_b16 v[150:151], v250 offset:4896
    v_mfma_f32_16x16x32_bf16 v[32:35], v[136:139], v[160:163], v[32:35]
    buffer_load_dwordx4 v249, s[44:47], s76 offen offset:3168 lds
    v_mfma_f32_16x16x32_bf16 v[40:43], v[136:139], v[164:167], v[40:43]
    ds_read_b64_tr_b16 v[152:153], v250 offset:4416
    ds_read_b64_tr_b16 v[154:155], v250 offset:4928
    v_mfma_f32_16x16x32_bf16 v[48:51], v[136:139], v[168:171], v[48:51]
    ds_read_b64_tr_b16 v[156:157], v250 offset:4448
    ds_read_b64_tr_b16 v[158:159], v250 offset:4960
    v_mfma_f32_16x16x32_bf16 v[56:59], v[136:139], v[172:175], v[56:59]
    v_mfma_f32_16x16x32_bf16 v[60:63], v[140:143], v[172:175], v[60:63]
    v_mfma_f32_16x16x32_bf16 v[52:55], v[140:143], v[168:171], v[52:55]
    v_mfma_f32_16x16x32_bf16 v[44:47], v[140:143], v[164:167], v[44:47]
    v_mfma_f32_16x16x32_bf16 v[36:39], v[140:143], v[160:163], v[36:39]
    s_waitcnt lgkmcnt(0)
    v_mfma_f32_16x16x32_bf16 v[64:67], v[144:147], v[160:163], v[64:67]
    s_add_u32 m0, s72, 4352
    s_mov_b32 s76, 262144
    v_mfma_f32_16x16x32_bf16 v[72:75], v[144:147], v[164:167], v[72:75]
    ds_read_b64_tr_b16 v[184:185], v251 offset:30528
    ds_read_b64_tr_b16 v[186:187], v251 offset:30664
    v_mfma_f32_16x16x32_bf16 v[80:83], v[144:147], v[168:171], v[80:83]
    buffer_load_dwordx4 v246, s[44:47], s76 offen offset:0 lds
    v_mfma_f32_16x16x32_bf16 v[88:91], v[144:147], v[172:175], v[88:91]
    ds_read_b64_tr_b16 v[188:189], v251 offset:30560
    ds_read_b64_tr_b16 v[190:191], v251 offset:30696
    v_mfma_f32_16x16x32_bf16 v[92:95], v[148:151], v[172:175], v[92:95]
    buffer_load_dwordx4 v247, s[44:47], s76 offen offset:1056 lds
    s_waitcnt vmcnt(6)
    v_mfma_f32_16x16x32_bf16 v[84:87], v[148:151], v[168:171], v[84:87]
    ds_read_b64_tr_b16 v[128:129], v250 offset:8704
    ds_read_b64_tr_b16 v[130:131], v250 offset:9216
    v_mfma_f32_16x16x32_bf16 v[76:79], v[148:151], v[164:167], v[76:79]
    buffer_load_dwordx4 v248, s[44:47], s76 offen offset:2112 lds
    v_mfma_f32_16x16x32_bf16 v[68:71], v[148:151], v[160:163], v[68:71]
    ds_read_b64_tr_b16 v[132:133], v250 offset:8736
    ds_read_b64_tr_b16 v[134:135], v250 offset:9248
    v_mfma_f32_16x16x32_bf16 v[96:99], v[152:155], v[160:163], v[96:99]
    buffer_load_dwordx4 v249, s[44:47], s76 offen offset:3168 lds
    v_mfma_f32_16x16x32_bf16 v[104:107], v[152:155], v[164:167], v[104:107]
    ds_read_b64_tr_b16 v[136:137], v250 offset:8768
    ds_read_b64_tr_b16 v[138:139], v250 offset:9280
    v_mfma_f32_16x16x32_bf16 v[112:115], v[152:155], v[168:171], v[112:115]
    ds_read_b64_tr_b16 v[140:141], v250 offset:8800
    ds_read_b64_tr_b16 v[142:143], v250 offset:9312
    v_mfma_f32_16x16x32_bf16 v[120:123], v[152:155], v[172:175], v[120:123]
    v_mfma_f32_16x16x32_bf16 v[124:127], v[156:159], v[172:175], v[124:127]
    v_mfma_f32_16x16x32_bf16 v[116:119], v[156:159], v[168:171], v[116:119]
    v_mfma_f32_16x16x32_bf16 v[108:111], v[156:159], v[164:167], v[108:111]
    v_mfma_f32_16x16x32_bf16 v[100:103], v[156:159], v[160:163], v[100:103]
    s_waitcnt lgkmcnt(0)
    v_mfma_f32_16x16x32_bf16 v[0:3], v[128:131], v[176:179], v[0:3]
    s_add_u32 m0, s72, 8704
    s_mov_b32 s76, 262272
    v_mfma_f32_16x16x32_bf16 v[8:11], v[128:131], v[180:183], v[8:11]
    ds_read_b64_tr_b16 v[160:161], v251 offset:34816
    ds_read_b64_tr_b16 v[162:163], v251 offset:34952
    v_mfma_f32_16x16x32_bf16 v[16:19], v[128:131], v[184:187], v[16:19]
    buffer_load_dwordx4 v246, s[44:47], s76 offen offset:0 lds
    v_mfma_f32_16x16x32_bf16 v[24:27], v[128:131], v[188:191], v[24:27]
    ds_read_b64_tr_b16 v[164:165], v251 offset:34848
    ds_read_b64_tr_b16 v[166:167], v251 offset:34984
    v_mfma_f32_16x16x32_bf16 v[28:31], v[132:135], v[188:191], v[28:31]
    buffer_load_dwordx4 v247, s[44:47], s76 offen offset:1056 lds
    s_waitcnt vmcnt(6)
    v_mfma_f32_16x16x32_bf16 v[20:23], v[132:135], v[184:187], v[20:23]
    ds_read_b64_tr_b16 v[144:145], v250 offset:0
    ds_read_b64_tr_b16 v[146:147], v250 offset:512
    v_mfma_f32_16x16x32_bf16 v[12:15], v[132:135], v[180:183], v[12:15]
    buffer_load_dwordx4 v248, s[44:47], s76 offen offset:2112 lds
    v_mfma_f32_16x16x32_bf16 v[4:7], v[132:135], v[176:179], v[4:7]
    ds_read_b64_tr_b16 v[148:149], v250 offset:32
    ds_read_b64_tr_b16 v[150:151], v250 offset:544
    v_mfma_f32_16x16x32_bf16 v[32:35], v[136:139], v[176:179], v[32:35]
    buffer_load_dwordx4 v249, s[44:47], s76 offen offset:3168 lds
    v_mfma_f32_16x16x32_bf16 v[40:43], v[136:139], v[180:183], v[40:43]
    ds_read_b64_tr_b16 v[152:153], v250 offset:64
    ds_read_b64_tr_b16 v[154:155], v250 offset:576
    v_mfma_f32_16x16x32_bf16 v[48:51], v[136:139], v[184:187], v[48:51]
    ds_read_b64_tr_b16 v[156:157], v250 offset:96
    ds_read_b64_tr_b16 v[158:159], v250 offset:608
    v_mfma_f32_16x16x32_bf16 v[56:59], v[136:139], v[188:191], v[56:59]
    v_mfma_f32_16x16x32_bf16 v[60:63], v[140:143], v[188:191], v[60:63]
    v_mfma_f32_16x16x32_bf16 v[52:55], v[140:143], v[184:187], v[52:55]
    v_mfma_f32_16x16x32_bf16 v[44:47], v[140:143], v[180:183], v[44:47]
    v_mfma_f32_16x16x32_bf16 v[36:39], v[140:143], v[176:179], v[36:39]
    s_waitcnt lgkmcnt(0)
    v_mfma_f32_16x16x32_bf16 v[64:67], v[144:147], v[176:179], v[64:67]
    s_add_u32 m0, s72, 0
    s_mov_b32 s76, 294912
    v_mfma_f32_16x16x32_bf16 v[72:75], v[144:147], v[180:183], v[72:75]
    ds_read_b64_tr_b16 v[168:169], v251 offset:34880
    ds_read_b64_tr_b16 v[170:171], v251 offset:35016
    v_mfma_f32_16x16x32_bf16 v[80:83], v[144:147], v[184:187], v[80:83]
    buffer_load_dwordx4 v246, s[44:47], s76 offen offset:0 lds
    v_mfma_f32_16x16x32_bf16 v[88:91], v[144:147], v[188:191], v[88:91]
    ds_read_b64_tr_b16 v[172:173], v251 offset:34912
    ds_read_b64_tr_b16 v[174:175], v251 offset:35048
    v_mfma_f32_16x16x32_bf16 v[92:95], v[148:151], v[188:191], v[92:95]
    buffer_load_dwordx4 v247, s[44:47], s76 offen offset:1056 lds
    s_waitcnt vmcnt(6)
    v_mfma_f32_16x16x32_bf16 v[84:87], v[148:151], v[184:187], v[84:87]
    ds_read_b64_tr_b16 v[128:129], v250 offset:4352
    ds_read_b64_tr_b16 v[130:131], v250 offset:4864
    v_mfma_f32_16x16x32_bf16 v[76:79], v[148:151], v[180:183], v[76:79]
    buffer_load_dwordx4 v248, s[44:47], s76 offen offset:2112 lds
    v_mfma_f32_16x16x32_bf16 v[68:71], v[148:151], v[176:179], v[68:71]
    ds_read_b64_tr_b16 v[132:133], v250 offset:4384
    ds_read_b64_tr_b16 v[134:135], v250 offset:4896
    v_mfma_f32_16x16x32_bf16 v[96:99], v[152:155], v[176:179], v[96:99]
    buffer_load_dwordx4 v249, s[44:47], s76 offen offset:3168 lds
    v_mfma_f32_16x16x32_bf16 v[104:107], v[152:155], v[180:183], v[104:107]
    ds_read_b64_tr_b16 v[136:137], v250 offset:4416
    ds_read_b64_tr_b16 v[138:139], v250 offset:4928
    v_mfma_f32_16x16x32_bf16 v[112:115], v[152:155], v[184:187], v[112:115]
    ds_read_b64_tr_b16 v[140:141], v250 offset:4448
    ds_read_b64_tr_b16 v[142:143], v250 offset:4960
    v_mfma_f32_16x16x32_bf16 v[120:123], v[152:155], v[188:191], v[120:123]
    v_mfma_f32_16x16x32_bf16 v[124:127], v[156:159], v[188:191], v[124:127]
    v_mfma_f32_16x16x32_bf16 v[116:119], v[156:159], v[184:187], v[116:119]
    v_mfma_f32_16x16x32_bf16 v[108:111], v[156:159], v[180:183], v[108:111]
    v_mfma_f32_16x16x32_bf16 v[100:103], v[156:159], v[176:179], v[100:103]
    s_waitcnt lgkmcnt(0)
    v_mfma_f32_16x16x32_bf16 v[0:3], v[128:131], v[160:163], v[0:3]
    s_add_u32 m0, s72, 4352
    s_mov_b32 s76, 295040
    v_mfma_f32_16x16x32_bf16 v[8:11], v[128:131], v[164:167], v[8:11]
    ds_read_b64_tr_b16 v[176:177], v251 offset:39168
    ds_read_b64_tr_b16 v[178:179], v251 offset:39304
    v_mfma_f32_16x16x32_bf16 v[16:19], v[128:131], v[168:171], v[16:19]
    buffer_load_dwordx4 v246, s[44:47], s76 offen offset:0 lds
    v_mfma_f32_16x16x32_bf16 v[24:27], v[128:131], v[172:175], v[24:27]
    ds_read_b64_tr_b16 v[180:181], v251 offset:39200
    ds_read_b64_tr_b16 v[182:183], v251 offset:39336
    v_mfma_f32_16x16x32_bf16 v[28:31], v[132:135], v[172:175], v[28:31]
    buffer_load_dwordx4 v247, s[44:47], s76 offen offset:1056 lds
    s_waitcnt vmcnt(6)
    v_mfma_f32_16x16x32_bf16 v[20:23], v[132:135], v[168:171], v[20:23]
    ds_read_b64_tr_b16 v[144:145], v250 offset:8704
    ds_read_b64_tr_b16 v[146:147], v250 offset:9216
    v_mfma_f32_16x16x32_bf16 v[12:15], v[132:135], v[164:167], v[12:15]
    buffer_load_dwordx4 v248, s[44:47], s76 offen offset:2112 lds
    v_mfma_f32_16x16x32_bf16 v[4:7], v[132:135], v[160:163], v[4:7]
    ds_read_b64_tr_b16 v[148:149], v250 offset:8736
    ds_read_b64_tr_b16 v[150:151], v250 offset:9248
    v_mfma_f32_16x16x32_bf16 v[32:35], v[136:139], v[160:163], v[32:35]
    buffer_load_dwordx4 v249, s[44:47], s76 offen offset:3168 lds
    v_mfma_f32_16x16x32_bf16 v[40:43], v[136:139], v[164:167], v[40:43]
    ds_read_b64_tr_b16 v[152:153], v250 offset:8768
    ds_read_b64_tr_b16 v[154:155], v250 offset:9280
    v_mfma_f32_16x16x32_bf16 v[48:51], v[136:139], v[168:171], v[48:51]
    ds_read_b64_tr_b16 v[156:157], v250 offset:8800
    ds_read_b64_tr_b16 v[158:159], v250 offset:9312
    v_mfma_f32_16x16x32_bf16 v[56:59], v[136:139], v[172:175], v[56:59]
    v_mfma_f32_16x16x32_bf16 v[60:63], v[140:143], v[172:175], v[60:63]
    v_mfma_f32_16x16x32_bf16 v[52:55], v[140:143], v[168:171], v[52:55]
    v_mfma_f32_16x16x32_bf16 v[44:47], v[140:143], v[164:167], v[44:47]
    v_mfma_f32_16x16x32_bf16 v[36:39], v[140:143], v[160:163], v[36:39]
    s_waitcnt lgkmcnt(0)
    v_mfma_f32_16x16x32_bf16 v[64:67], v[144:147], v[160:163], v[64:67]
    s_add_u32 m0, s72, 8704
    s_mov_b32 s76, 327680
    v_mfma_f32_16x16x32_bf16 v[72:75], v[144:147], v[164:167], v[72:75]
    ds_read_b64_tr_b16 v[184:185], v251 offset:39232
    ds_read_b64_tr_b16 v[186:187], v251 offset:39368
    v_mfma_f32_16x16x32_bf16 v[80:83], v[144:147], v[168:171], v[80:83]
    buffer_load_dwordx4 v246, s[44:47], s76 offen offset:0 lds
    v_mfma_f32_16x16x32_bf16 v[88:91], v[144:147], v[172:175], v[88:91]
    ds_read_b64_tr_b16 v[188:189], v251 offset:39264
    ds_read_b64_tr_b16 v[190:191], v251 offset:39400
    v_mfma_f32_16x16x32_bf16 v[92:95], v[148:151], v[172:175], v[92:95]
    buffer_load_dwordx4 v247, s[44:47], s76 offen offset:1056 lds
    s_waitcnt vmcnt(6)
    v_mfma_f32_16x16x32_bf16 v[84:87], v[148:151], v[168:171], v[84:87]
    ds_read_b64_tr_b16 v[128:129], v250 offset:0
    ds_read_b64_tr_b16 v[130:131], v250 offset:512
    v_mfma_f32_16x16x32_bf16 v[76:79], v[148:151], v[164:167], v[76:79]
    buffer_load_dwordx4 v248, s[44:47], s76 offen offset:2112 lds
    v_mfma_f32_16x16x32_bf16 v[68:71], v[148:151], v[160:163], v[68:71]
    ds_read_b64_tr_b16 v[132:133], v250 offset:32
    ds_read_b64_tr_b16 v[134:135], v250 offset:544
    v_mfma_f32_16x16x32_bf16 v[96:99], v[152:155], v[160:163], v[96:99]
    buffer_load_dwordx4 v249, s[44:47], s76 offen offset:3168 lds
    v_mfma_f32_16x16x32_bf16 v[104:107], v[152:155], v[164:167], v[104:107]
    ds_read_b64_tr_b16 v[136:137], v250 offset:64
    ds_read_b64_tr_b16 v[138:139], v250 offset:576
    v_mfma_f32_16x16x32_bf16 v[112:115], v[152:155], v[168:171], v[112:115]
    ds_read_b64_tr_b16 v[140:141], v250 offset:96
    ds_read_b64_tr_b16 v[142:143], v250 offset:608
    v_mfma_f32_16x16x32_bf16 v[120:123], v[152:155], v[172:175], v[120:123]
    v_mfma_f32_16x16x32_bf16 v[124:127], v[156:159], v[172:175], v[124:127]
    v_mfma_f32_16x16x32_bf16 v[116:119], v[156:159], v[168:171], v[116:119]
    v_mfma_f32_16x16x32_bf16 v[108:111], v[156:159], v[164:167], v[108:111]
    v_mfma_f32_16x16x32_bf16 v[100:103], v[156:159], v[160:163], v[100:103]
    s_waitcnt lgkmcnt(0)
    v_mfma_f32_16x16x32_bf16 v[0:3], v[128:131], v[176:179], v[0:3]
    s_add_u32 m0, s72, 0
    s_mov_b32 s76, 327808
    v_mfma_f32_16x16x32_bf16 v[8:11], v[128:131], v[180:183], v[8:11]
    ds_read_b64_tr_b16 v[160:161], v251 offset:43520
    ds_read_b64_tr_b16 v[162:163], v251 offset:43656
    v_mfma_f32_16x16x32_bf16 v[16:19], v[128:131], v[184:187], v[16:19]
    buffer_load_dwordx4 v246, s[44:47], s76 offen offset:0 lds
    v_mfma_f32_16x16x32_bf16 v[24:27], v[128:131], v[188:191], v[24:27]
    ds_read_b64_tr_b16 v[164:165], v251 offset:43552
    ds_read_b64_tr_b16 v[166:167], v251 offset:43688
    v_mfma_f32_16x16x32_bf16 v[28:31], v[132:135], v[188:191], v[28:31]
    buffer_load_dwordx4 v247, s[44:47], s76 offen offset:1056 lds
    s_waitcnt vmcnt(6)
    v_mfma_f32_16x16x32_bf16 v[20:23], v[132:135], v[184:187], v[20:23]
    ds_read_b64_tr_b16 v[144:145], v250 offset:4352
    ds_read_b64_tr_b16 v[146:147], v250 offset:4864
    v_mfma_f32_16x16x32_bf16 v[12:15], v[132:135], v[180:183], v[12:15]
    buffer_load_dwordx4 v248, s[44:47], s76 offen offset:2112 lds
    v_mfma_f32_16x16x32_bf16 v[4:7], v[132:135], v[176:179], v[4:7]
    ds_read_b64_tr_b16 v[148:149], v250 offset:4384
    ds_read_b64_tr_b16 v[150:151], v250 offset:4896
    v_mfma_f32_16x16x32_bf16 v[32:35], v[136:139], v[176:179], v[32:35]
    buffer_load_dwordx4 v249, s[44:47], s76 offen offset:3168 lds
    v_mfma_f32_16x16x32_bf16 v[40:43], v[136:139], v[180:183], v[40:43]
    ds_read_b64_tr_b16 v[152:153], v250 offset:4416
    ds_read_b64_tr_b16 v[154:155], v250 offset:4928
    v_mfma_f32_16x16x32_bf16 v[48:51], v[136:139], v[184:187], v[48:51]
    ds_read_b64_tr_b16 v[156:157], v250 offset:4448
    ds_read_b64_tr_b16 v[158:159], v250 offset:4960
    v_mfma_f32_16x16x32_bf16 v[56:59], v[136:139], v[188:191], v[56:59]
    v_mfma_f32_16x16x32_bf16 v[60:63], v[140:143], v[188:191], v[60:63]
    v_mfma_f32_16x16x32_bf16 v[52:55], v[140:143], v[184:187], v[52:55]
    v_mfma_f32_16x16x32_bf16 v[44:47], v[140:143], v[180:183], v[44:47]
    v_mfma_f32_16x16x32_bf16 v[36:39], v[140:143], v[176:179], v[36:39]
    s_waitcnt lgkmcnt(0)
    v_mfma_f32_16x16x32_bf16 v[64:67], v[144:147], v[176:179], v[64:67]
    s_add_u32 m0, s72, 4352
    s_mov_b32 s76, 360448
    v_mfma_f32_16x16x32_bf16 v[72:75], v[144:147], v[180:183], v[72:75]
    ds_read_b64_tr_b16 v[168:169], v251 offset:43584
    ds_read_b64_tr_b16 v[170:171], v251 offset:43720
    v_mfma_f32_16x16x32_bf16 v[80:83], v[144:147], v[184:187], v[80:83]
    buffer_load_dwordx4 v246, s[44:47], s76 offen offset:0 lds
    v_mfma_f32_16x16x32_bf16 v[88:91], v[144:147], v[188:191], v[88:91]
    ds_read_b64_tr_b16 v[172:173], v251 offset:43616
    ds_read_b64_tr_b16 v[174:175], v251 offset:43752
    v_mfma_f32_16x16x32_bf16 v[92:95], v[148:151], v[188:191], v[92:95]
    buffer_load_dwordx4 v247, s[44:47], s76 offen offset:1056 lds
    s_waitcnt vmcnt(6)
    v_mfma_f32_16x16x32_bf16 v[84:87], v[148:151], v[184:187], v[84:87]
    ds_read_b64_tr_b16 v[128:129], v250 offset:8704
    ds_read_b64_tr_b16 v[130:131], v250 offset:9216
    v_mfma_f32_16x16x32_bf16 v[76:79], v[148:151], v[180:183], v[76:79]
    buffer_load_dwordx4 v248, s[44:47], s76 offen offset:2112 lds
    v_mfma_f32_16x16x32_bf16 v[68:71], v[148:151], v[176:179], v[68:71]
    ds_read_b64_tr_b16 v[132:133], v250 offset:8736
    ds_read_b64_tr_b16 v[134:135], v250 offset:9248
    v_mfma_f32_16x16x32_bf16 v[96:99], v[152:155], v[176:179], v[96:99]
    buffer_load_dwordx4 v249, s[44:47], s76 offen offset:3168 lds
    v_mfma_f32_16x16x32_bf16 v[104:107], v[152:155], v[180:183], v[104:107]
    ds_read_b64_tr_b16 v[136:137], v250 offset:8768
    ds_read_b64_tr_b16 v[138:139], v250 offset:9280
    v_mfma_f32_16x16x32_bf16 v[112:115], v[152:155], v[184:187], v[112:115]
    ds_read_b64_tr_b16 v[140:141], v250 offset:8800
    ds_read_b64_tr_b16 v[142:143], v250 offset:9312
    v_mfma_f32_16x16x32_bf16 v[120:123], v[152:155], v[188:191], v[120:123]
    v_mfma_f32_16x16x32_bf16 v[124:127], v[156:159], v[188:191], v[124:127]
    v_mfma_f32_16x16x32_bf16 v[116:119], v[156:159], v[184:187], v[116:119]
    v_mfma_f32_16x16x32_bf16 v[108:111], v[156:159], v[180:183], v[108:111]
    v_mfma_f32_16x16x32_bf16 v[100:103], v[156:159], v[176:179], v[100:103]
    s_waitcnt lgkmcnt(0)
    v_mfma_f32_16x16x32_bf16 v[0:3], v[128:131], v[160:163], v[0:3]
    s_add_u32 m0, s72, 8704
    s_mov_b32 s76, 360576
    v_mfma_f32_16x16x32_bf16 v[8:11], v[128:131], v[164:167], v[8:11]
    ds_read_b64_tr_b16 v[176:177], v251 offset:47872
    ds_read_b64_tr_b16 v[178:179], v251 offset:48008
    v_mfma_f32_16x16x32_bf16 v[16:19], v[128:131], v[168:171], v[16:19]
    buffer_load_dwordx4 v246, s[44:47], s76 offen offset:0 lds
    v_mfma_f32_16x16x32_bf16 v[24:27], v[128:131], v[172:175], v[24:27]
    ds_read_b64_tr_b16 v[180:181], v251 offset:47904
    ds_read_b64_tr_b16 v[182:183], v251 offset:48040
    v_mfma_f32_16x16x32_bf16 v[28:31], v[132:135], v[172:175], v[28:31]
    buffer_load_dwordx4 v247, s[44:47], s76 offen offset:1056 lds
    s_waitcnt vmcnt(6)
    v_mfma_f32_16x16x32_bf16 v[20:23], v[132:135], v[168:171], v[20:23]
    ds_read_b64_tr_b16 v[144:145], v250 offset:0
    ds_read_b64_tr_b16 v[146:147], v250 offset:512
    v_mfma_f32_16x16x32_bf16 v[12:15], v[132:135], v[164:167], v[12:15]
    buffer_load_dwordx4 v248, s[44:47], s76 offen offset:2112 lds
    v_mfma_f32_16x16x32_bf16 v[4:7], v[132:135], v[160:163], v[4:7]
    ds_read_b64_tr_b16 v[148:149], v250 offset:32
    ds_read_b64_tr_b16 v[150:151], v250 offset:544
    v_mfma_f32_16x16x32_bf16 v[32:35], v[136:139], v[160:163], v[32:35]
    buffer_load_dwordx4 v249, s[44:47], s76 offen offset:3168 lds
    v_mfma_f32_16x16x32_bf16 v[40:43], v[136:139], v[164:167], v[40:43]
    ds_read_b64_tr_b16 v[152:153], v250 offset:64
    ds_read_b64_tr_b16 v[154:155], v250 offset:576
    v_mfma_f32_16x16x32_bf16 v[48:51], v[136:139], v[168:171], v[48:51]
    ds_read_b64_tr_b16 v[156:157], v250 offset:96
    ds_read_b64_tr_b16 v[158:159], v250 offset:608
    v_mfma_f32_16x16x32_bf16 v[56:59], v[136:139], v[172:175], v[56:59]
    v_mfma_f32_16x16x32_bf16 v[60:63], v[140:143], v[172:175], v[60:63]
    v_mfma_f32_16x16x32_bf16 v[52:55], v[140:143], v[168:171], v[52:55]
    v_mfma_f32_16x16x32_bf16 v[44:47], v[140:143], v[164:167], v[44:47]
    v_mfma_f32_16x16x32_bf16 v[36:39], v[140:143], v[160:163], v[36:39]
    s_waitcnt lgkmcnt(0)
    v_mfma_f32_16x16x32_bf16 v[64:67], v[144:147], v[160:163], v[64:67]
    s_add_u32 m0, s72, 0
    s_mov_b32 s76, 393216
    v_mfma_f32_16x16x32_bf16 v[72:75], v[144:147], v[164:167], v[72:75]
    ds_read_b64_tr_b16 v[184:185], v251 offset:47936
    ds_read_b64_tr_b16 v[186:187], v251 offset:48072
    v_mfma_f32_16x16x32_bf16 v[80:83], v[144:147], v[168:171], v[80:83]
    buffer_load_dwordx4 v246, s[44:47], s76 offen offset:0 lds
    v_mfma_f32_16x16x32_bf16 v[88:91], v[144:147], v[172:175], v[88:91]
    ds_read_b64_tr_b16 v[188:189], v251 offset:47968
    ds_read_b64_tr_b16 v[190:191], v251 offset:48104
    v_mfma_f32_16x16x32_bf16 v[92:95], v[148:151], v[172:175], v[92:95]
    buffer_load_dwordx4 v247, s[44:47], s76 offen offset:1056 lds
    s_waitcnt vmcnt(6)
    v_mfma_f32_16x16x32_bf16 v[84:87], v[148:151], v[168:171], v[84:87]
    ds_read_b64_tr_b16 v[128:129], v250 offset:4352
    ds_read_b64_tr_b16 v[130:131], v250 offset:4864
    v_mfma_f32_16x16x32_bf16 v[76:79], v[148:151], v[164:167], v[76:79]
    buffer_load_dwordx4 v248, s[44:47], s76 offen offset:2112 lds
    v_mfma_f32_16x16x32_bf16 v[68:71], v[148:151], v[160:163], v[68:71]
    ds_read_b64_tr_b16 v[132:133], v250 offset:4384
    ds_read_b64_tr_b16 v[134:135], v250 offset:4896
    v_mfma_f32_16x16x32_bf16 v[96:99], v[152:155], v[160:163], v[96:99]
    buffer_load_dwordx4 v249, s[44:47], s76 offen offset:3168 lds
    v_mfma_f32_16x16x32_bf16 v[104:107], v[152:155], v[164:167], v[104:107]
    ds_read_b64_tr_b16 v[136:137], v250 offset:4416
    ds_read_b64_tr_b16 v[138:139], v250 offset:4928
    v_mfma_f32_16x16x32_bf16 v[112:115], v[152:155], v[168:171], v[112:115]
    ds_read_b64_tr_b16 v[140:141], v250 offset:4448
    ds_read_b64_tr_b16 v[142:143], v250 offset:4960
    v_mfma_f32_16x16x32_bf16 v[120:123], v[152:155], v[172:175], v[120:123]
    v_mfma_f32_16x16x32_bf16 v[124:127], v[156:159], v[172:175], v[124:127]
    v_mfma_f32_16x16x32_bf16 v[116:119], v[156:159], v[168:171], v[116:119]
    v_mfma_f32_16x16x32_bf16 v[108:111], v[156:159], v[164:167], v[108:111]
    v_mfma_f32_16x16x32_bf16 v[100:103], v[156:159], v[160:163], v[100:103]
    s_waitcnt lgkmcnt(0)
    v_mfma_f32_16x16x32_bf16 v[0:3], v[128:131], v[176:179], v[0:3]
    s_add_u32 m0, s72, 4352
    s_mov_b32 s76, 393344
    v_mfma_f32_16x16x32_bf16 v[8:11], v[128:131], v[180:183], v[8:11]
    ds_read_b64_tr_b16 v[160:161], v251 offset:52224
    ds_read_b64_tr_b16 v[162:163], v251 offset:52360
    v_mfma_f32_16x16x32_bf16 v[16:19], v[128:131], v[184:187], v[16:19]
    buffer_load_dwordx4 v246, s[44:47], s76 offen offset:0 lds
    v_mfma_f32_16x16x32_bf16 v[24:27], v[128:131], v[188:191], v[24:27]
    ds_read_b64_tr_b16 v[164:165], v251 offset:52256
    ds_read_b64_tr_b16 v[166:167], v251 offset:52392
    v_mfma_f32_16x16x32_bf16 v[28:31], v[132:135], v[188:191], v[28:31]
    buffer_load_dwordx4 v247, s[44:47], s76 offen offset:1056 lds
    s_waitcnt vmcnt(6)
    v_mfma_f32_16x16x32_bf16 v[20:23], v[132:135], v[184:187], v[20:23]
    ds_read_b64_tr_b16 v[144:145], v250 offset:8704
    ds_read_b64_tr_b16 v[146:147], v250 offset:9216
    v_mfma_f32_16x16x32_bf16 v[12:15], v[132:135], v[180:183], v[12:15]
    buffer_load_dwordx4 v248, s[44:47], s76 offen offset:2112 lds
    v_mfma_f32_16x16x32_bf16 v[4:7], v[132:135], v[176:179], v[4:7]
    ds_read_b64_tr_b16 v[148:149], v250 offset:8736
    ds_read_b64_tr_b16 v[150:151], v250 offset:9248
    v_mfma_f32_16x16x32_bf16 v[32:35], v[136:139], v[176:179], v[32:35]
    buffer_load_dwordx4 v249, s[44:47], s76 offen offset:3168 lds
    v_mfma_f32_16x16x32_bf16 v[40:43], v[136:139], v[180:183], v[40:43]
    ds_read_b64_tr_b16 v[152:153], v250 offset:8768
    ds_read_b64_tr_b16 v[154:155], v250 offset:9280
    v_mfma_f32_16x16x32_bf16 v[48:51], v[136:139], v[184:187], v[48:51]
    ds_read_b64_tr_b16 v[156:157], v250 offset:8800
    ds_read_b64_tr_b16 v[158:159], v250 offset:9312
    v_mfma_f32_16x16x32_bf16 v[56:59], v[136:139], v[188:191], v[56:59]
    v_mfma_f32_16x16x32_bf16 v[60:63], v[140:143], v[188:191], v[60:63]
    v_mfma_f32_16x16x32_bf16 v[52:55], v[140:143], v[184:187], v[52:55]
    v_mfma_f32_16x16x32_bf16 v[44:47], v[140:143], v[180:183], v[44:47]
    v_mfma_f32_16x16x32_bf16 v[36:39], v[140:143], v[176:179], v[36:39]
    s_waitcnt lgkmcnt(0)
    v_mfma_f32_16x16x32_bf16 v[64:67], v[144:147], v[176:179], v[64:67]
    s_add_u32 m0, s72, 8704
    s_mov_b32 s76, 425984
    v_mfma_f32_16x16x32_bf16 v[72:75], v[144:147], v[180:183], v[72:75]
    ds_read_b64_tr_b16 v[168:169], v251 offset:52288
    ds_read_b64_tr_b16 v[170:171], v251 offset:52424
    v_mfma_f32_16x16x32_bf16 v[80:83], v[144:147], v[184:187], v[80:83]
    buffer_load_dwordx4 v246, s[44:47], s76 offen offset:0 lds
    v_mfma_f32_16x16x32_bf16 v[88:91], v[144:147], v[188:191], v[88:91]
    ds_read_b64_tr_b16 v[172:173], v251 offset:52320
    ds_read_b64_tr_b16 v[174:175], v251 offset:52456
    v_mfma_f32_16x16x32_bf16 v[92:95], v[148:151], v[188:191], v[92:95]
    buffer_load_dwordx4 v247, s[44:47], s76 offen offset:1056 lds
    s_waitcnt vmcnt(6)
    v_mfma_f32_16x16x32_bf16 v[84:87], v[148:151], v[184:187], v[84:87]
    ds_read_b64_tr_b16 v[128:129], v250 offset:0
    ds_read_b64_tr_b16 v[130:131], v250 offset:512
    v_mfma_f32_16x16x32_bf16 v[76:79], v[148:151], v[180:183], v[76:79]
    buffer_load_dwordx4 v248, s[44:47], s76 offen offset:2112 lds
    v_mfma_f32_16x16x32_bf16 v[68:71], v[148:151], v[176:179], v[68:71]
    ds_read_b64_tr_b16 v[132:133], v250 offset:32
    ds_read_b64_tr_b16 v[134:135], v250 offset:544
    v_mfma_f32_16x16x32_bf16 v[96:99], v[152:155], v[176:179], v[96:99]
    buffer_load_dwordx4 v249, s[44:47], s76 offen offset:3168 lds
    v_mfma_f32_16x16x32_bf16 v[104:107], v[152:155], v[180:183], v[104:107]
    ds_read_b64_tr_b16 v[136:137], v250 offset:64
    ds_read_b64_tr_b16 v[138:139], v250 offset:576
    v_mfma_f32_16x16x32_bf16 v[112:115], v[152:155], v[184:187], v[112:115]
    ds_read_b64_tr_b16 v[140:141], v250 offset:96
    ds_read_b64_tr_b16 v[142:143], v250 offset:608
    v_mfma_f32_16x16x32_bf16 v[120:123], v[152:155], v[188:191], v[120:123]
    v_mfma_f32_16x16x32_bf16 v[124:127], v[156:159], v[188:191], v[124:127]
    v_mfma_f32_16x16x32_bf16 v[116:119], v[156:159], v[184:187], v[116:119]
    v_mfma_f32_16x16x32_bf16 v[108:111], v[156:159], v[180:183], v[108:111]
    v_mfma_f32_16x16x32_bf16 v[100:103], v[156:159], v[176:179], v[100:103]
    s_waitcnt lgkmcnt(0)
    v_mfma_f32_16x16x32_bf16 v[0:3], v[128:131], v[160:163], v[0:3]
    s_add_u32 m0, s72, 0
    s_mov_b32 s76, 426112
    v_mfma_f32_16x16x32_bf16 v[8:11], v[128:131], v[164:167], v[8:11]
    ds_read_b64_tr_b16 v[176:177], v251 offset:56576
    ds_read_b64_tr_b16 v[178:179], v251 offset:56712
    v_mfma_f32_16x16x32_bf16 v[16:19], v[128:131], v[168:171], v[16:19]
    buffer_load_dwordx4 v246, s[44:47], s76 offen offset:0 lds
    v_mfma_f32_16x16x32_bf16 v[24:27], v[128:131], v[172:175], v[24:27]
    ds_read_b64_tr_b16 v[180:181], v251 offset:56608
    ds_read_b64_tr_b16 v[182:183], v251 offset:56744
    v_mfma_f32_16x16x32_bf16 v[28:31], v[132:135], v[172:175], v[28:31]
    buffer_load_dwordx4 v247, s[44:47], s76 offen offset:1056 lds
    s_waitcnt vmcnt(6)
    v_mfma_f32_16x16x32_bf16 v[20:23], v[132:135], v[168:171], v[20:23]
    ds_read_b64_tr_b16 v[144:145], v250 offset:4352
    ds_read_b64_tr_b16 v[146:147], v250 offset:4864
    v_mfma_f32_16x16x32_bf16 v[12:15], v[132:135], v[164:167], v[12:15]
    buffer_load_dwordx4 v248, s[44:47], s76 offen offset:2112 lds
    v_mfma_f32_16x16x32_bf16 v[4:7], v[132:135], v[160:163], v[4:7]
    ds_read_b64_tr_b16 v[148:149], v250 offset:4384
    ds_read_b64_tr_b16 v[150:151], v250 offset:4896
    v_mfma_f32_16x16x32_bf16 v[32:35], v[136:139], v[160:163], v[32:35]
    buffer_load_dwordx4 v249, s[44:47], s76 offen offset:3168 lds
    v_mfma_f32_16x16x32_bf16 v[40:43], v[136:139], v[164:167], v[40:43]
    ds_read_b64_tr_b16 v[152:153], v250 offset:4416
    ds_read_b64_tr_b16 v[154:155], v250 offset:4928
    v_mfma_f32_16x16x32_bf16 v[48:51], v[136:139], v[168:171], v[48:51]
    ds_read_b64_tr_b16 v[156:157], v250 offset:4448
    ds_read_b64_tr_b16 v[158:159], v250 offset:4960
    v_mfma_f32_16x16x32_bf16 v[56:59], v[136:139], v[172:175], v[56:59]
    v_mfma_f32_16x16x32_bf16 v[60:63], v[140:143], v[172:175], v[60:63]
    v_mfma_f32_16x16x32_bf16 v[52:55], v[140:143], v[168:171], v[52:55]
    v_mfma_f32_16x16x32_bf16 v[44:47], v[140:143], v[164:167], v[44:47]
    v_mfma_f32_16x16x32_bf16 v[36:39], v[140:143], v[160:163], v[36:39]
    s_waitcnt lgkmcnt(0)
    v_mfma_f32_16x16x32_bf16 v[64:67], v[144:147], v[160:163], v[64:67]
    s_add_u32 m0, s72, 4352
    s_mov_b32 s76, 458752
    v_mfma_f32_16x16x32_bf16 v[72:75], v[144:147], v[164:167], v[72:75]
    ds_read_b64_tr_b16 v[184:185], v251 offset:56640
    ds_read_b64_tr_b16 v[186:187], v251 offset:56776
    v_mfma_f32_16x16x32_bf16 v[80:83], v[144:147], v[168:171], v[80:83]
    buffer_load_dwordx4 v246, s[44:47], s76 offen offset:0 lds
    v_mfma_f32_16x16x32_bf16 v[88:91], v[144:147], v[172:175], v[88:91]
    ds_read_b64_tr_b16 v[188:189], v251 offset:56672
    ds_read_b64_tr_b16 v[190:191], v251 offset:56808
    v_mfma_f32_16x16x32_bf16 v[92:95], v[148:151], v[172:175], v[92:95]
    buffer_load_dwordx4 v247, s[44:47], s76 offen offset:1056 lds
    s_waitcnt vmcnt(6)
    v_mfma_f32_16x16x32_bf16 v[84:87], v[148:151], v[168:171], v[84:87]
    ds_read_b64_tr_b16 v[128:129], v250 offset:8704
    ds_read_b64_tr_b16 v[130:131], v250 offset:9216
    v_mfma_f32_16x16x32_bf16 v[76:79], v[148:151], v[164:167], v[76:79]
    buffer_load_dwordx4 v248, s[44:47], s76 offen offset:2112 lds
    v_mfma_f32_16x16x32_bf16 v[68:71], v[148:151], v[160:163], v[68:71]
    ds_read_b64_tr_b16 v[132:133], v250 offset:8736
    ds_read_b64_tr_b16 v[134:135], v250 offset:9248
    v_mfma_f32_16x16x32_bf16 v[96:99], v[152:155], v[160:163], v[96:99]
    buffer_load_dwordx4 v249, s[44:47], s76 offen offset:3168 lds
    v_mfma_f32_16x16x32_bf16 v[104:107], v[152:155], v[164:167], v[104:107]
    ds_read_b64_tr_b16 v[136:137], v250 offset:8768
    ds_read_b64_tr_b16 v[138:139], v250 offset:9280
    v_mfma_f32_16x16x32_bf16 v[112:115], v[152:155], v[168:171], v[112:115]
    ds_read_b64_tr_b16 v[140:141], v250 offset:8800
    ds_read_b64_tr_b16 v[142:143], v250 offset:9312
    v_mfma_f32_16x16x32_bf16 v[120:123], v[152:155], v[172:175], v[120:123]
    v_mfma_f32_16x16x32_bf16 v[124:127], v[156:159], v[172:175], v[124:127]
    v_mfma_f32_16x16x32_bf16 v[116:119], v[156:159], v[168:171], v[116:119]
    v_mfma_f32_16x16x32_bf16 v[108:111], v[156:159], v[164:167], v[108:111]
    v_mfma_f32_16x16x32_bf16 v[100:103], v[156:159], v[160:163], v[100:103]
    s_waitcnt lgkmcnt(0)
    v_mfma_f32_16x16x32_bf16 v[0:3], v[128:131], v[176:179], v[0:3]
    s_add_u32 m0, s72, 8704
    s_mov_b32 s76, 491520
    v_mfma_f32_16x16x32_bf16 v[8:11], v[128:131], v[180:183], v[8:11]
    ds_read_b64_tr_b16 v[160:161], v251 offset:60928
    ds_read_b64_tr_b16 v[162:163], v251 offset:61064
    v_mfma_f32_16x16x32_bf16 v[16:19], v[128:131], v[184:187], v[16:19]
    buffer_load_dwordx4 v246, s[44:47], s76 offen offset:0 lds
    v_mfma_f32_16x16x32_bf16 v[24:27], v[128:131], v[188:191], v[24:27]
    ds_read_b64_tr_b16 v[164:165], v251 offset:60960
    ds_read_b64_tr_b16 v[166:167], v251 offset:61096
    v_mfma_f32_16x16x32_bf16 v[28:31], v[132:135], v[188:191], v[28:31]
    buffer_load_dwordx4 v247, s[44:47], s76 offen offset:1056 lds
    s_waitcnt vmcnt(6)
    v_mfma_f32_16x16x32_bf16 v[20:23], v[132:135], v[184:187], v[20:23]
    ds_read_b64_tr_b16 v[144:145], v250 offset:0
    ds_read_b64_tr_b16 v[146:147], v250 offset:512
    v_mfma_f32_16x16x32_bf16 v[12:15], v[132:135], v[180:183], v[12:15]
    buffer_load_dwordx4 v248, s[44:47], s76 offen offset:2112 lds
    v_mfma_f32_16x16x32_bf16 v[4:7], v[132:135], v[176:179], v[4:7]
    ds_read_b64_tr_b16 v[148:149], v250 offset:32
    ds_read_b64_tr_b16 v[150:151], v250 offset:544
    v_mfma_f32_16x16x32_bf16 v[32:35], v[136:139], v[176:179], v[32:35]
    buffer_load_dwordx4 v249, s[44:47], s76 offen offset:3168 lds
    v_mfma_f32_16x16x32_bf16 v[40:43], v[136:139], v[180:183], v[40:43]
    ds_read_b64_tr_b16 v[152:153], v250 offset:64
    ds_read_b64_tr_b16 v[154:155], v250 offset:576
    v_mfma_f32_16x16x32_bf16 v[48:51], v[136:139], v[184:187], v[48:51]
    ds_read_b64_tr_b16 v[156:157], v250 offset:96
    ds_read_b64_tr_b16 v[158:159], v250 offset:608
    v_mfma_f32_16x16x32_bf16 v[56:59], v[136:139], v[188:191], v[56:59]
    v_mfma_f32_16x16x32_bf16 v[60:63], v[140:143], v[188:191], v[60:63]
    v_mfma_f32_16x16x32_bf16 v[52:55], v[140:143], v[184:187], v[52:55]
    v_mfma_f32_16x16x32_bf16 v[44:47], v[140:143], v[180:183], v[44:47]
    v_mfma_f32_16x16x32_bf16 v[36:39], v[140:143], v[176:179], v[36:39]
    s_waitcnt lgkmcnt(0)
    v_mfma_f32_16x16x32_bf16 v[64:67], v[144:147], v[176:179], v[64:67]
    s_add_u32 m0, s72, 0
    s_mov_b32 s76, 458880
    v_mfma_f32_16x16x32_bf16 v[72:75], v[144:147], v[180:183], v[72:75]
    ds_read_b64_tr_b16 v[168:169], v251 offset:60992
    ds_read_b64_tr_b16 v[170:171], v251 offset:61128
    v_mfma_f32_16x16x32_bf16 v[80:83], v[144:147], v[184:187], v[80:83]
    buffer_load_dwordx4 v246, s[44:47], s76 offen offset:0 lds
    v_mfma_f32_16x16x32_bf16 v[88:91], v[144:147], v[188:191], v[88:91]
    ds_read_b64_tr_b16 v[172:173], v251 offset:61024
    ds_read_b64_tr_b16 v[174:175], v251 offset:61160
    v_mfma_f32_16x16x32_bf16 v[92:95], v[148:151], v[188:191], v[92:95]
    buffer_load_dwordx4 v247, s[44:47], s76 offen offset:1056 lds
    s_waitcnt vmcnt(6)
    v_mfma_f32_16x16x32_bf16 v[84:87], v[148:151], v[184:187], v[84:87]
    ds_read_b64_tr_b16 v[128:129], v250 offset:4352
    ds_read_b64_tr_b16 v[130:131], v250 offset:4864
    v_mfma_f32_16x16x32_bf16 v[76:79], v[148:151], v[180:183], v[76:79]
    buffer_load_dwordx4 v248, s[44:47], s76 offen offset:2112 lds
    v_mfma_f32_16x16x32_bf16 v[68:71], v[148:151], v[176:179], v[68:71]
    ds_read_b64_tr_b16 v[132:133], v250 offset:4384
    ds_read_b64_tr_b16 v[134:135], v250 offset:4896
    v_mfma_f32_16x16x32_bf16 v[96:99], v[152:155], v[176:179], v[96:99]
    buffer_load_dwordx4 v249, s[44:47], s76 offen offset:3168 lds
    v_mfma_f32_16x16x32_bf16 v[104:107], v[152:155], v[180:183], v[104:107]
    ds_read_b64_tr_b16 v[136:137], v250 offset:4416
    ds_read_b64_tr_b16 v[138:139], v250 offset:4928
    v_mfma_f32_16x16x32_bf16 v[112:115], v[152:155], v[184:187], v[112:115]
    ds_read_b64_tr_b16 v[140:141], v250 offset:4448
    ds_read_b64_tr_b16 v[142:143], v250 offset:4960
    v_mfma_f32_16x16x32_bf16 v[120:123], v[152:155], v[188:191], v[120:123]
    v_mfma_f32_16x16x32_bf16 v[124:127], v[156:159], v[188:191], v[124:127]
    v_mfma_f32_16x16x32_bf16 v[116:119], v[156:159], v[184:187], v[116:119]
    v_mfma_f32_16x16x32_bf16 v[108:111], v[156:159], v[180:183], v[108:111]
    v_mfma_f32_16x16x32_bf16 v[100:103], v[156:159], v[176:179], v[100:103]
    s_waitcnt lgkmcnt(0)
    v_mfma_f32_16x16x32_bf16 v[0:3], v[128:131], v[160:163], v[0:3]
    s_add_u32 m0, s72, 4352
    s_mov_b32 s76, 491648
    v_mfma_f32_16x16x32_bf16 v[8:11], v[128:131], v[164:167], v[8:11]
    ds_read_b64_tr_b16 v[176:177], v251 offset:65280
    ds_read_b64_tr_b16 v[178:179], v251 offset:65416
    v_mfma_f32_16x16x32_bf16 v[16:19], v[128:131], v[168:171], v[16:19]
    buffer_load_dwordx4 v246, s[44:47], s76 offen offset:0 lds
    v_mfma_f32_16x16x32_bf16 v[24:27], v[128:131], v[172:175], v[24:27]
    ds_read_b64_tr_b16 v[180:181], v251 offset:65312
    ds_read_b64_tr_b16 v[182:183], v251 offset:65448
    v_mfma_f32_16x16x32_bf16 v[28:31], v[132:135], v[172:175], v[28:31]
    buffer_load_dwordx4 v247, s[44:47], s76 offen offset:1056 lds
    s_waitcnt vmcnt(6)
    v_mfma_f32_16x16x32_bf16 v[20:23], v[132:135], v[168:171], v[20:23]
    ds_read_b64_tr_b16 v[144:145], v250 offset:8704
    ds_read_b64_tr_b16 v[146:147], v250 offset:9216
    v_mfma_f32_16x16x32_bf16 v[12:15], v[132:135], v[164:167], v[12:15]
    buffer_load_dwordx4 v248, s[44:47], s76 offen offset:2112 lds
    v_mfma_f32_16x16x32_bf16 v[4:7], v[132:135], v[160:163], v[4:7]
    ds_read_b64_tr_b16 v[148:149], v250 offset:8736
    ds_read_b64_tr_b16 v[150:151], v250 offset:9248
    v_mfma_f32_16x16x32_bf16 v[32:35], v[136:139], v[160:163], v[32:35]
    buffer_load_dwordx4 v249, s[44:47], s76 offen offset:3168 lds
    v_mfma_f32_16x16x32_bf16 v[40:43], v[136:139], v[164:167], v[40:43]
    ds_read_b64_tr_b16 v[152:153], v250 offset:8768
    ds_read_b64_tr_b16 v[154:155], v250 offset:9280
    v_mfma_f32_16x16x32_bf16 v[48:51], v[136:139], v[168:171], v[48:51]
    ds_read_b64_tr_b16 v[156:157], v250 offset:8800
    ds_read_b64_tr_b16 v[158:159], v250 offset:9312
    v_mfma_f32_16x16x32_bf16 v[56:59], v[136:139], v[172:175], v[56:59]
    ds_read_b64_tr_b16 v[184:185], v251 offset:65344
    ds_read_b64_tr_b16 v[186:187], v251 offset:65480
    v_mfma_f32_16x16x32_bf16 v[60:63], v[140:143], v[172:175], v[60:63]
    ds_read_b64_tr_b16 v[188:189], v251 offset:65376
    ds_read_b64_tr_b16 v[190:191], v251 offset:65512
    v_mfma_f32_16x16x32_bf16 v[52:55], v[140:143], v[168:171], v[52:55]
    v_mfma_f32_16x16x32_bf16 v[44:47], v[140:143], v[164:167], v[44:47]
    v_mfma_f32_16x16x32_bf16 v[36:39], v[140:143], v[160:163], v[36:39]
    s_waitcnt lgkmcnt(0)
    s_cmp_eq_u32 s64, 0
    s_cbranch_scc0 L_OA
    s_waitcnt vmcnt(4)
    s_barrier
    v_mfma_f32_16x16x32_bf16 v[0:3], v[144:147], v[176:179], v[0:3]
    v_mfma_f32_16x16x32_bf16 v[8:11], v[144:147], v[180:183], v[8:11]
    v_mfma_f32_16x16x32_bf16 v[16:19], v[144:147], v[184:187], v[16:19]
    v_mfma_f32_16x16x32_bf16 v[24:27], v[144:147], v[188:191], v[24:27]
    v_mfma_f32_16x16x32_bf16 v[28:31], v[148:151], v[188:191], v[28:31]
    v_mfma_f32_16x16x32_bf16 v[20:23], v[148:151], v[184:187], v[20:23]
    ds_read_b64_tr_b16 v[128:129], v250 offset:0
    ds_read_b64_tr_b16 v[130:131], v250 offset:512
    v_mfma_f32_16x16x32_bf16 v[12:15], v[148:151], v[180:183], v[12:15]
    v_mfma_f32_16x16x32_bf16 v[4:7], v[148:151], v[176:179], v[4:7]
    ds_read_b64_tr_b16 v[132:133], v250 offset:32
    ds_read_b64_tr_b16 v[134:135], v250 offset:544
    v_mfma_f32_16x16x32_bf16 v[32:35], v[152:155], v[176:179], v[32:35]
    v_mfma_f32_16x16x32_bf16 v[40:43], v[152:155], v[180:183], v[40:43]
    ds_read_b64_tr_b16 v[136:137], v250 offset:64
    ds_read_b64_tr_b16 v[138:139], v250 offset:576
    v_mfma_f32_16x16x32_bf16 v[48:51], v[152:155], v[184:187], v[48:51]
    ds_read_b64_tr_b16 v[140:141], v250 offset:96
    ds_read_b64_tr_b16 v[142:143], v250 offset:608
    v_mfma_f32_16x16x32_bf16 v[56:59], v[152:155], v[188:191], v[56:59]
    v_mfma_f32_16x16x32_bf16 v[60:63], v[156:159], v[188:191], v[60:63]
    v_mfma_f32_16x16x32_bf16 v[52:55], v[156:159], v[184:187], v[52:55]
    v_mfma_f32_16x16x32_bf16 v[44:47], v[156:159], v[180:183], v[44:47]
    v_mfma_f32_16x16x32_bf16 v[36:39], v[156:159], v[176:179], v[36:39]
    s_waitcnt vmcnt(0) lgkmcnt(0)
    v_mfma_f32_16x16x32_bf16 v[64:67], v[128:131], v[160:163], v[64:67]
    v_mfma_f32_16x16x32_bf16 v[72:75], v[128:131], v[164:167], v[72:75]
    v_mfma_f32_16x16x32_bf16 v[80:83], v[128:131], v[168:171], v[80:83]
    v_mfma_f32_16x16x32_bf16 v[88:91], v[128:131], v[172:175], v[88:91]
    v_mfma_f32_16x16x32_bf16 v[92:95], v[132:135], v[172:175], v[92:95]
    v_cvt_pk_bf16_f32 v0, v0, v1
    v_mfma_f32_16x16x32_bf16 v[84:87], v[132:135], v[168:171], v[84:87]
    ds_read_b64_tr_b16 v[144:145], v250 offset:4352
    ds_read_b64_tr_b16 v[146:147], v250 offset:4864
    v_cvt_pk_bf16_f32 v1, v2, v3
    v_mfma_f32_16x16x32_bf16 v[76:79], v[132:135], v[164:167], v[76:79]
    v_cvt_pk_bf16_f32 v2, v4, v5
    v_mfma_f32_16x16x32_bf16 v[68:71], v[132:135], v[160:163], v[68:71]
    ds_read_b64_tr_b16 v[148:149], v250 offset:4384
    ds_read_b64_tr_b16 v[150:151], v250 offset:4896
    v_cvt_pk_bf16_f32 v3, v6, v7
    v_mfma_f32_16x16x32_bf16 v[96:99], v[136:139], v[160:163], v[96:99]
    v_cvt_pk_bf16_f32 v32, v32, v33
    v_cvt_pk_bf16_f32 v33, v34, v35
    v_mfma_f32_16x16x32_bf16 v[104:107], v[136:139], v[164:167], v[104:107]
    ds_read_b64_tr_b16 v[152:153], v250 offset:4416
    ds_read_b64_tr_b16 v[154:155], v250 offset:4928
    v_cvt_pk_bf16_f32 v34, v36, v37
    v_cvt_pk_bf16_f32 v35, v38, v39
    v_mfma_f32_16x16x32_bf16 v[112:115], v[136:139], v[168:171], v[112:115]
    ds_read_b64_tr_b16 v[156:157], v250 offset:4448
    ds_read_b64_tr_b16 v[158:159], v250 offset:4960
    s_mov_b32 s71, 0
    s_cmp_eq_u32 s66, 0
    v_mfma_f32_16x16x32_bf16 v[120:123], v[136:139], v[172:175], v[120:123]
    s_cbranch_scc1 L_ps7
    buffer_store_dwordx4 v[0:3], v245, s[52:55], s71 offen offset:0 sc1
    buffer_store_dwordx4 v[32:35], v245, s[52:55], s71 offen offset:1024 sc1
L_ps7:
    v_mfma_f32_16x16x32_bf16 v[124:127], v[140:143], v[172:175], v[124:127]
    v_cvt_pk_bf16_f32 v8, v8, v9
    v_cvt_pk_bf16_f32 v9, v10, v11
    v_mfma_f32_16x16x32_bf16 v[116:119], v[140:143], v[168:171], v[116:119]
    v_cvt_pk_bf16_f32 v10, v12, v13
    v_cvt_pk_bf16_f32 v11, v14, v15
    v_mfma_f32_16x16x32_bf16 v[108:111], v[140:143], v[164:167], v[108:111]
    v_cvt_pk_bf16_f32 v40, v40, v41
    v_cvt_pk_bf16_f32 v41, v42, v43
    v_mfma_f32_16x16x32_bf16 v[100:103], v[140:143], v[160:163], v[100:103]
    v_cvt_pk_bf16_f32 v42, v44, v45
    v_cvt_pk_bf16_f32 v43, v46, v47
    s_waitcnt lgkmcnt(0)
    v_mfma_f32_16x16x32_bf16 v[64:67], v[144:147], v[176:179], v[64:67]
    s_mov_b32 s71, 131072
    s_cmp_eq_u32 s66, 2
    v_mfma_f32_16x16x32_bf16 v[72:75], v[144:147], v[180:183], v[72:75]
    s_cbranch_scc1 L_ps8
    buffer_store_dwordx4 v[8:11], v245, s[52:55], s71 offen offset:0 sc1
    buffer_store_dwordx4 v[40:43], v245, s[52:55], s71 offen offset:1024 sc1
L_ps8:
    v_mfma_f32_16x16x32_bf16 v[80:83], v[144:147], v[184:187], v[80:83]
    v_cvt_pk_bf16_f32 v16, v16, v17
    v_cvt_pk_bf16_f32 v17, v18, v19
    v_mfma_f32_16x16x32_bf16 v[88:91], v[144:147], v[188:191], v[88:91]
    v_cvt_pk_bf16_f32 v18, v20, v21
    v_cvt_pk_bf16_f32 v19, v22, v23
    v_mfma_f32_16x16x32_bf16 v[92:95], v[148:151], v[188:191], v[92:95]
    v_cvt_pk_bf16_f32 v48, v48, v49
    v_cvt_pk_bf16_f32 v49, v50, v51
    v_mfma_f32_16x16x32_bf16 v[84:87], v[148:151], v[184:187], v[84:87]
    v_cvt_pk_bf16_f32 v50, v52, v53
    v_cvt_pk_bf16_f32 v51, v54, v55
    v_mfma_f32_16x16x32_bf16 v[76:79], v[148:151], v[180:183], v[76:79]
    s_mov_b32 s71, 262144
    s_cmp_eq_u32 s66, 4
    v_mfma_f32_16x16x32_bf16 v[68:71], v[148:151], v[176:179], v[68:71]
    s_cbranch_scc1 L_ps9
    buffer_store_dwordx4 v[16:19], v245, s[52:55], s71 offen offset:0 sc1
    buffer_store_dwordx4 v[48:51], v245, s[52:55], s71 offen offset:1024 sc1
L_ps9:
    v_mfma_f32_16x16x32_bf16 v[96:99], v[152:155], v[176:179], v[96:99]
    v_cvt_pk_bf16_f32 v24, v24, v25
    v_cvt_pk_bf16_f32 v25, v26, v27
    v_mfma_f32_16x16x32_bf16 v[104:107], v[152:155], v[180:183], v[104:107]
    v_cvt_pk_bf16_f32 v26, v28, v29
    v_cvt_pk_bf16_f32 v27, v30, v31
    v_mfma_f32_16x16x32_bf16 v[112:115], v[152:155], v[184:187], v[112:115]
    v_cvt_pk_bf16_f32 v56, v56, v57
    v_cvt_pk_bf16_f32 v57, v58, v59
    v_mfma_f32_16x16x32_bf16 v[120:123], v[152:155], v[188:191], v[120:123]
    v_cvt_pk_bf16_f32 v58, v60, v61
    v_cvt_pk_bf16_f32 v59, v62, v63
    v_mfma_f32_16x16x32_bf16 v[124:127], v[156:159], v[188:191], v[124:127]
    s_mov_b32 s71, 393216
    s_cmp_eq_u32 s66, 6
    v_mfma_f32_16x16x32_bf16 v[116:119], v[156:159], v[184:187], v[116:119]
    s_cbranch_scc1 L_ps10
    buffer_store_dwordx4 v[24:27], v245, s[52:55], s71 offen offset:0 sc1
    buffer_store_dwordx4 v[56:59], v245, s[52:55], s71 offen offset:1024 sc1
L_ps10:
    v_mfma_f32_16x16x32_bf16 v[108:111], v[156:159], v[180:183], v[108:111]
    v_mfma_f32_16x16x32_bf16 v[100:103], v[156:159], v[176:179], v[100:103]
    s_branch L_store1
L_OA:
    s_waitcnt vmcnt(4)
    v_mfma_f32_16x16x32_bf16 v[0:3], v[144:147], v[176:179], v[0:3]
    s_add_u32 m0, s72, 8704
    s_mov_b32 s76, 32768
    v_mfma_f32_16x16x32_bf16 v[8:11], v[144:147], v[180:183], v[8:11]
    v_mfma_f32_16x16x32_bf16 v[16:19], v[144:147], v[184:187], v[16:19]
    buffer_load_dwordx4 v246, s[60:63], s76 offen offset:0 lds
    v_mfma_f32_16x16x32_bf16 v[24:27], v[144:147], v[188:191], v[24:27]
    v_mfma_f32_16x16x32_bf16 v[28:31], v[148:151], v[188:191], v[28:31]
    buffer_load_dwordx4 v247, s[60:63], s76 offen offset:1056 lds
    v_mfma_f32_16x16x32_bf16 v[20:23], v[148:151], v[184:187], v[20:23]
    ds_read_b64_tr_b16 v[128:129], v250 offset:0
    ds_read_b64_tr_b16 v[130:131], v250 offset:512
    v_mfma_f32_16x16x32_bf16 v[12:15], v[148:151], v[180:183], v[12:15]
    buffer_load_dwordx4 v248, s[60:63], s76 offen offset:2112 lds
    v_mfma_f32_16x16x32_bf16 v[4:7], v[148:151], v[176:179], v[4:7]
    ds_read_b64_tr_b16 v[132:133], v250 offset:32
    ds_read_b64_tr_b16 v[134:135], v250 offset:544
    v_mfma_f32_16x16x32_bf16 v[32:35], v[152:155], v[176:179], v[32:35]
    buffer_load_dwordx4 v249, s[60:63], s76 offen offset:3168 lds
    v_mfma_f32_16x16x32_bf16 v[40:43], v[152:155], v[180:183], v[40:43]
    ds_read_b64_tr_b16 v[136:137], v250 offset:64
    ds_read_b64_tr_b16 v[138:139], v250 offset:576
    v_mfma_f32_16x16x32_bf16 v[48:51], v[152:155], v[184:187], v[48:51]
    ds_read_b64_tr_b16 v[140:141], v250 offset:96
    ds_read_b64_tr_b16 v[142:143], v250 offset:608
    v_mfma_f32_16x16x32_bf16 v[56:59], v[152:155], v[188:191], v[56:59]
    v_mfma_f32_16x16x32_bf16 v[60:63], v[156:159], v[188:191], v[60:63]
    v_mfma_f32_16x16x32_bf16 v[52:55], v[156:159], v[184:187], v[52:55]
    v_mfma_f32_16x16x32_bf16 v[44:47], v[156:159], v[180:183], v[44:47]
    v_mfma_f32_16x16x32_bf16 v[36:39], v[156:159], v[176:179], v[36:39]
    s_waitcnt vmcnt(4) lgkmcnt(0)
    v_mfma_f32_16x16x32_bf16 v[64:67], v[128:131], v[160:163], v[64:67]
    s_add_u32 m0, s72, 0
    s_mov_b32 s76, 0
    v_mfma_f32_16x16x32_bf16 v[72:75], v[128:131], v[164:167], v[72:75]
    v_mfma_f32_16x16x32_bf16 v[80:83], v[128:131], v[168:171], v[80:83]
    buffer_load_dwordx4 v246, s[60:63], s76 offen offset:0 lds
    v_mfma_f32_16x16x32_bf16 v[88:91], v[128:131], v[172:175], v[88:91]
    v_mfma_f32_16x16x32_bf16 v[92:95], v[132:135], v[172:175], v[92:95]
    buffer_load_dwordx4 v247, s[60:63], s76 offen offset:1056 lds
    v_mfma_f32_16x16x32_bf16 v[84:87], v[132:135], v[168:171], v[84:87]
    ds_read_b64_tr_b16 v[144:145], v250 offset:4352
    ds_read_b64_tr_b16 v[146:147], v250 offset:4864
    v_mfma_f32_16x16x32_bf16 v[76:79], v[132:135], v[164:167], v[76:79]
    buffer_load_dwordx4 v248, s[60:63], s76 offen offset:2112 lds
    v_mfma_f32_16x16x32_bf16 v[68:71], v[132:135], v[160:163], v[68:71]
    ds_read_b64_tr_b16 v[148:149], v250 offset:4384
    ds_read_b64_tr_b16 v[150:151], v250 offset:4896
    v_mfma_f32_16x16x32_bf16 v[96:99], v[136:139], v[160:163], v[96:99]
    buffer_load_dwordx4 v249, s[60:63], s76 offen offset:3168 lds
    v_mfma_f32_16x16x32_bf16 v[104:107], v[136:139], v[164:167], v[104:107]
    ds_read_b64_tr_b16 v[152:153], v250 offset:4416
    ds_read_b64_tr_b16 v[154:155], v250 offset:4928
    v_mfma_f32_16x16x32_bf16 v[112:115], v[136:139], v[168:171], v[112:115]
    ds_read_b64_tr_b16 v[156:157], v250 offset:4448
    ds_read_b64_tr_b16 v[158:159], v250 offset:4960
    v_mfma_f32_16x16x32_bf16 v[120:123], v[136:139], v[172:175], v[120:123]
    v_mfma_f32_16x16x32_bf16 v[124:127], v[140:143], v[172:175], v[124:127]
    v_mfma_f32_16x16x32_bf16 v[116:119], v[140:143], v[168:171], v[116:119]
    v_mfma_f32_16x16x32_bf16 v[108:111], v[140:143], v[164:167], v[108:111]
    v_mfma_f32_16x16x32_bf16 v[100:103], v[140:143], v[160:163], v[100:103]
    s_waitcnt lgkmcnt(0)
    s_barrier
    v_mfma_f32_16x16x32_bf16 v[64:67], v[144:147], v[176:179], v[64:67]
    s_add_u32 m0, s72, 4352
    s_mov_b32 s76, 128
    v_mfma_f32_16x16x32_bf16 v[72:75], v[144:147], v[180:183], v[72:75]
    v_mfma_f32_16x16x32_bf16 v[80:83], v[144:147], v[184:187], v[80:83]
    buffer_load_dwordx4 v246, s[60:63], s76 offen offset:0 lds
    v_mfma_f32_16x16x32_bf16 v[88:91], v[144:147], v[188:191], v[88:91]
    v_mfma_f32_16x16x32_bf16 v[92:95], v[148:151], v[188:191], v[92:95]
    buffer_load_dwordx4 v247, s[60:63], s76 offen offset:1056 lds
    v_mfma_f32_16x16x32_bf16 v[84:87], v[148:151], v[184:187], v[84:87]
    v_mfma_f32_16x16x32_bf16 v[76:79], v[148:151], v[180:183], v[76:79]
    buffer_load_dwordx4 v248, s[60:63], s76 offen offset:2112 lds
    v_mfma_f32_16x16x32_bf16 v[68:71], v[148:151], v[176:179], v[68:71]
    v_mfma_f32_16x16x32_bf16 v[96:99], v[152:155], v[176:179], v[96:99]
    buffer_load_dwordx4 v249, s[60:63], s76 offen offset:3168 lds
    v_mfma_f32_16x16x32_bf16 v[104:107], v[152:155], v[180:183], v[104:107]
    v_mfma_f32_16x16x32_bf16 v[112:115], v[152:155], v[184:187], v[112:115]
    v_mfma_f32_16x16x32_bf16 v[120:123], v[152:155], v[188:191], v[120:123]
    v_mfma_f32_16x16x32_bf16 v[124:127], v[156:159], v[188:191], v[124:127]
    v_mfma_f32_16x16x32_bf16 v[116:119], v[156:159], v[184:187], v[116:119]
    v_mfma_f32_16x16x32_bf16 v[108:111], v[156:159], v[180:183], v[108:111]
    v_mfma_f32_16x16x32_bf16 v[100:103], v[156:159], v[176:179], v[100:103]
    s_setprio 0
    s_barrier
L_store0:
    v_cvt_pk_bf16_f32 v0, v0, v1
    v_cvt_pk_bf16_f32 v1, v2, v3
    v_cvt_pk_bf16_f32 v2, v4, v5
    v_cvt_pk_bf16_f32 v3, v6, v7
    v_cvt_pk_bf16_f32 v32, v32, v33
    v_cvt_pk_bf16_f32 v33, v34, v35
    v_cvt_pk_bf16_f32 v34, v36, v37
    v_cvt_pk_bf16_f32 v35, v38, v39
    s_mov_b32 s71, 0
    s_cmp_eq_u32 s66, 0
    s_cbranch_scc1 L_ps11
    buffer_store_dwordx4 v[0:3], v245, s[52:55], s71 offen offset:0 sc1
    buffer_store_dwordx4 v[32:35], v245, s[52:55], s71 offen offset:1024 sc1
L_ps11:
    v_cvt_pk_bf16_f32 v8, v8, v9
    v_cvt_pk_bf16_f32 v9, v10, v11
    v_cvt_pk_bf16_f32 v10, v12, v13
    v_cvt_pk_bf16_f32 v11, v14, v15
    v_cvt_pk_bf16_f32 v40, v40, v41
    v_cvt_pk_bf16_f32 v41, v42, v43
    v_cvt_pk_bf16_f32 v42, v44, v45
    v_cvt_pk_bf16_f32 v43, v46, v47
    s_mov_b32 s71, 131072
    s_cmp_eq_u32 s66, 2
    s_cbranch_scc1 L_ps12
    buffer_store_dwordx4 v[8:11], v245, s[52:55], s71 offen offset:0 sc1
    buffer_store_dwordx4 v[40:43], v245, s[52:55], s71 offen offset:1024 sc1
L_ps12:
    v_cvt_pk_bf16_f32 v16, v16, v17
    v_cvt_pk_bf16_f32 v17, v18, v19
    v_cvt_pk_bf16_f32 v18, v20, v21
    v_cvt_pk_bf16_f32 v19, v22, v23
    v_cvt_pk_bf16_f32 v48, v48, v49
    v_cvt_pk_bf16_f32 v49, v50, v51
    v_cvt_pk_bf16_f32 v50, v52, v53
    v_cvt_pk_bf16_f32 v51, v54, v55
    s_mov_b32 s71, 262144
    s_cmp_eq_u32 s66, 4
    s_cbranch_scc1 L_ps13
    buffer_store_dwordx4 v[16:19], v245, s[52:55], s71 offen offset:0 sc1
    buffer_store_dwordx4 v[48:51], v245, s[52:55], s71 offen offset:1024 sc1
L_ps13:
    v_cvt_pk_bf16_f32 v24, v24, v25
    v_cvt_pk_bf16_f32 v25, v26, v27
    v_cvt_pk_bf16_f32 v26, v28, v29
    v_cvt_pk_bf16_f32 v27, v30, v31
    v_cvt_pk_bf16_f32 v56, v56, v57
    v_cvt_pk_bf16_f32 v57, v58, v59
    v_cvt_pk_bf16_f32 v58, v60, v61
    v_cvt_pk_bf16_f32 v59, v62, v63
    s_mov_b32 s71, 393216
    s_cmp_eq_u32 s66, 6
    s_cbranch_scc1 L_ps14
    buffer_store_dwordx4 v[24:27], v245, s[52:55], s71 offen offset:0 sc1
    buffer_store_dwordx4 v[56:59], v245, s[52:55], s71 offen offset:1024 sc1
L_ps14:
L_store1:
    v_cvt_pk_bf16_f32 v64, v64, v65
    v_cvt_pk_bf16_f32 v65, v66, v67
    v_cvt_pk_bf16_f32 v66, v68, v69
    v_cvt_pk_bf16_f32 v67, v70, v71
    v_cvt_pk_bf16_f32 v96, v96, v97
    v_cvt_pk_bf16_f32 v97, v98, v99
    s_nop 0
    v_cvt_pk_bf16_f32 v98, v100, v101
    v_cvt_pk_bf16_f32 v99, v102, v103
    s_mov_b32 s71, 65536
    s_cmp_eq_u32 s66, 1
    s_cbranch_scc1 L_ps15
    buffer_store_dwordx4 v[64:67], v245, s[52:55], s71 offen offset:0 sc1
    buffer_store_dwordx4 v[96:99], v245, s[52:55], s71 offen offset:1024 sc1
L_ps15:
    v_cvt_pk_bf16_f32 v72, v72, v73
    v_cvt_pk_bf16_f32 v73, v74, v75
    v_cvt_pk_bf16_f32 v74, v76, v77
    v_cvt_pk_bf16_f32 v75, v78, v79
    v_cvt_pk_bf16_f32 v104, v104, v105
    v_cvt_pk_bf16_f32 v105, v106, v107
    v_cvt_pk_bf16_f32 v106, v108, v109
    v_cvt_pk_bf16_f32 v107, v110, v111
    s_mov_b32 s71, 196608
    s_cmp_eq_u32 s66, 3
    s_cbranch_scc1 L_ps16
    buffer_store_dwordx4 v[72:75], v245, s[52:55], s71 offen offset:0 sc1
    buffer_store_dwordx4 v[104:107], v245, s[52:55], s71 offen offset:1024 sc1
L_ps16:
    v_cvt_pk_bf16_f32 v80, v80, v81
    v_cvt_pk_bf16_f32 v81, v82, v83
    v_cvt_pk_bf16_f32 v82, v84, v85
    v_cvt_pk_bf16_f32 v83, v86, v87
    v_cvt_pk_bf16_f32 v112, v112, v113
    v_cvt_pk_bf16_f32 v113, v114, v115
    v_cvt_pk_bf16_f32 v114, v116, v117
    v_cvt_pk_bf16_f32 v115, v118, v119
    s_mov_b32 s71, 327680
    s_cmp_eq_u32 s66, 5
    s_cbranch_scc1 L_ps17
    buffer_store_dwordx4 v[80:83], v245, s[52:55], s71 offen offset:0 sc1
    buffer_store_dwordx4 v[112:115], v245, s[52:55], s71 offen offset:1024 sc1
L_ps17:
    v_cvt_pk_bf16_f32 v88, v88, v89
    v_cvt_pk_bf16_f32 v89, v90, v91
    v_cvt_pk_bf16_f32 v90, v92, v93
    v_cvt_pk_bf16_f32 v91, v94, v95
    v_cvt_pk_bf16_f32 v120, v120, v121
    v_cvt_pk_bf16_f32 v121, v122, v123
    v_cvt_pk_bf16_f32 v122, v124, v125
    v_cvt_pk_bf16_f32 v123, v126, v127
    s_mov_b32 s71, 458752
    s_cmp_eq_u32 s66, 7
    s_cbranch_scc1 L_ps18
    buffer_store_dwordx4 v[88:91], v245, s[52:55], s71 offen offset:0 sc1
    buffer_store_dwordx4 v[120:123], v245, s[52:55], s71 offen offset:1024 sc1
L_ps18:
    s_waitcnt vmcnt(14)
    s_barrier
L_passed:
    s_cmp_eq_u32 s66, 0
    s_cbranch_scc1 L_kp19
    s_cmp_eq_u32 s66, 1
    s_cbranch_scc1 L_kp20
    s_cmp_eq_u32 s66, 2
    s_cbranch_scc1 L_kp21
    s_cmp_eq_u32 s66, 3
    s_cbranch_scc1 L_kp22
    s_cmp_eq_u32 s66, 4
    s_cbranch_scc1 L_kp23
    s_cmp_eq_u32 s66, 5
    s_cbranch_scc1 L_kp24
    s_cmp_eq_u32 s66, 6
    s_cbranch_scc1 L_kp25
L_kp26:
    v_lshlrev_b32 v192, 16, v88
    v_and_b32 v193, 0xffff0000, v88
    v_lshlrev_b32 v194, 16, v89
    v_and_b32 v195, 0xffff0000, v89
    v_lshlrev_b32 v196, 16, v90
    v_and_b32 v197, 0xffff0000, v90
    v_lshlrev_b32 v198, 16, v91
    v_and_b32 v199, 0xffff0000, v91
    v_lshlrev_b32 v200, 16, v120
    v_and_b32 v201, 0xffff0000, v120
    v_lshlrev_b32 v202, 16, v121
    v_and_b32 v203, 0xffff0000, v121
    v_lshlrev_b32 v204, 16, v122
    v_and_b32 v205, 0xffff0000, v122
    v_lshlrev_b32 v206, 16, v123
    v_and_b32 v207, 0xffff0000, v123
    s_branch L_kept
L_kp25:
    v_lshlrev_b32 v192, 16, v24
    v_and_b32 v193, 0xffff0000, v24
    v_lshlrev_b32 v194, 16, v25
    v_and_b32 v195, 0xffff0000, v25
    v_lshlrev_b32 v196, 16, v26
    v_and_b32 v197, 0xffff0000, v26
    v_lshlrev_b32 v198, 16, v27
    v_and_b32 v199, 0xffff0000, v27
    v_lshlrev_b32 v200, 16, v56
    v_and_b32 v201, 0xffff0000, v56
    v_lshlrev_b32 v202, 16, v57
    v_and_b32 v203, 0xffff0000, v57
    v_lshlrev_b32 v204, 16, v58
    v_and_b32 v205, 0xffff0000, v58
    v_lshlrev_b32 v206, 16, v59
    v_and_b32 v207, 0xffff0000, v59
    s_branch L_kept
L_kp24:
    v_lshlrev_b32 v192, 16, v80
    v_and_b32 v193, 0xffff0000, v80
    v_lshlrev_b32 v194, 16, v81
    v_and_b32 v195, 0xffff0000, v81
    v_lshlrev_b32 v196, 16, v82
    v_and_b32 v197, 0xffff0000, v82
    v_lshlrev_b32 v198, 16, v83
    v_and_b32 v199, 0xffff0000, v83
    v_lshlrev_b32 v200, 16, v112
    v_and_b32 v201, 0xffff0000, v112
    v_lshlrev_b32 v202, 16, v113
    v_and_b32 v203, 0xffff0000, v113
    v_lshlrev_b32 v204, 16, v114
    v_and_b32 v205, 0xffff0000, v114
    v_lshlrev_b32 v206, 16, v115
    v_and_b32 v207, 0xffff0000, v115
    s_branch L_kept
L_kp23:
    v_lshlrev_b32 v192, 16, v16
    v_and_b32 v193, 0xffff0000, v16
    v_lshlrev_b32 v194, 16, v17
    v_and_b32 v195, 0xffff0000, v17
    v_lshlrev_b32 v196, 16, v18
    v_and_b32 v197, 0xffff0000, v18
    v_lshlrev_b32 v198, 16, v19
    v_and_b32 v199, 0xffff0000, v19
    v_lshlrev_b32 v200, 16, v48
    v_and_b32 v201, 0xffff0000, v48
    v_lshlrev_b32 v202, 16, v49
    v_and_b32 v203, 0xffff0000, v49
    v_lshlrev_b32 v204, 16, v50
    v_and_b32 v205, 0xffff0000, v50
    v_lshlrev_b32 v206, 16, v51
    v_and_b32 v207, 0xffff0000, v51
    s_branch L_kept
L_kp22:
    v_lshlrev_b32 v192, 16, v72
    v_and_b32 v193, 0xffff0000, v72
    v_lshlrev_b32 v194, 16, v73
    v_and_b32 v195, 0xffff0000, v73
    v_lshlrev_b32 v196, 16, v74
    v_and_b32 v197, 0xffff0000, v74
    v_lshlrev_b32 v198, 16, v75
    v_and_b32 v199, 0xffff0000, v75
    v_lshlrev_b32 v200, 16, v104
    v_and_b32 v201, 0xffff0000, v104
    v_lshlrev_b32 v202, 16, v105
    v_and_b32 v203, 0xffff0000, v105
    v_lshlrev_b32 v204, 16, v106
    v_and_b32 v205, 0xffff0000, v106
    v_lshlrev_b32 v206, 16, v107
    v_and_b32 v207, 0xffff0000, v107
    s_branch L_kept
L_kp21:
    v_lshlrev_b32 v192, 16, v8
    v_and_b32 v193, 0xffff0000, v8
    v_lshlrev_b32 v194, 16, v9
    v_and_b32 v195, 0xffff0000, v9
    v_lshlrev_b32 v196, 16, v10
    v_and_b32 v197, 0xffff0000, v10
    v_lshlrev_b32 v198, 16, v11
    v_and_b32 v199, 0xffff0000, v11
    v_lshlrev_b32 v200, 16, v40
    v_and_b32 v201, 0xffff0000, v40
    v_lshlrev_b32 v202, 16, v41
    v_and_b32 v203, 0xffff0000, v41
    v_lshlrev_b32 v204, 16, v42
    v_and_b32 v205, 0xffff0000, v42
    v_lshlrev_b32 v206, 16, v43
    v_and_b32 v207, 0xffff0000, v43
    s_branch L_kept
L_kp20:
    v_lshlrev_b32 v192, 16, v64
    v_and_b32 v193, 0xffff0000, v64
    v_lshlrev_b32 v194, 16, v65
    v_and_b32 v195, 0xffff0000, v65
    v_lshlrev_b32 v196, 16, v66
    v_and_b32 v197, 0xffff0000, v66
    v_lshlrev_b32 v198, 16, v67
    v_and_b32 v199, 0xffff0000, v67
    v_lshlrev_b32 v200, 16, v96
    v_and_b32 v201, 0xffff0000, v96
    v_lshlrev_b32 v202, 16, v97
    v_and_b32 v203, 0xffff0000, v97
    v_lshlrev_b32 v204, 16, v98
    v_and_b32 v205, 0xffff0000, v98
    v_lshlrev_b32 v206, 16, v99
    v_and_b32 v207, 0xffff0000, v99
    s_branch L_kept
L_kp19:
    v_lshlrev_b32 v192, 16, v0
    v_and_b32 v193, 0xffff0000, v0
    v_lshlrev_b32 v194, 16, v1
    v_and_b32 v195, 0xffff0000, v1
    v_lshlrev_b32 v196, 16, v2
    v_and_b32 v197, 0xffff0000, v2
    v_lshlrev_b32 v198, 16, v3
    v_and_b32 v199, 0xffff0000, v3
    v_lshlrev_b32 v200, 16, v32
    v_and_b32 v201, 0xffff0000, v32
    v_lshlrev_b32 v202, 16, v33
    v_and_b32 v203, 0xffff0000, v33
    v_lshlrev_b32 v204, 16, v34
    v_and_b32 v205, 0xffff0000, v34
    v_lshlrev_b32 v206, 16, v35
    v_and_b32 v207, 0xffff0000, v35
L_kept:
    s_xor_b32 s75, s64, 1
    s_lshl_b32 s74, s75, 5
    s_add_u32 s74, s74, s67
    s_lshl_b32 s74, s74, 19
    s_lshl_b32 s82, s66, 16
    s_add_u32 s74, s74, s82
    s_add_u32 s52, s28, s74
    s_addc_u32 s53, s29, 0
    s_mov_b32 s54, 0x10000
    s_mov_b32 s55, 0x20000
    s_lshl_b32 s82, s66, 2
    s_add_u32 s82, s82, s65
    s_lshl_b32 s82, s82, 11
    s_lshl_b32 s74, s67, 17
    s_add_u32 s56, s24, s74
    s_addc_u32 s57, s25, 0
    s_mov_b32 s58, 0x20000
    s_mov_b32 s59, 0x20000
    s_lshl_b32 s81, s75, 10
    s_lshr_b32 s74, s66, 1
    s_lshl_b32 s74, s74, 15
    s_add_u32 s81, s81, s74
    s_lshl_b32 s74, s65, 8
    s_add_u32 s81, s81, s74
    s_and_b32 s74, s66, 1
    s_lshl_b32 s74, s74, 7
    s_add_u32 s81, s81, s74
    v_and_b32 v254, 15, v253
    v_lshlrev_b32 v242, 11, v254
    v_bfe_u32 v254, v253, 4, 1
    v_lshl_add_u32 v242, v254, 5, v242
    v_lshrrev_b32 v254, 5, v253
    v_lshl_add_u32 v242, v254, 4, v242
    s_cmp_eq_u32 s64, 0
    s_cbranch_scc0 L_Apub
    s_add_u32 s60, s28, 0x2000000
    s_addc_u32 s61, s29, 0
    s_mov_b32 s62, 0x8000
    s_mov_b32 s63, 0x20000
    s_mul_i32 s71, s67, 768
    s_add_u32 s71, s71, 256
    v_mov_b32 v254, 156676
    v_mov_b32 v255, 1
    s_mov_b64 exec, 1
    s_waitcnt vmcnt(0)
    ds_add_rtn_u32 v254, v254, v255
    s_waitcnt lgkmcnt(0)
    v_readfirstlane_b32 s74, v254
    s_cmp_eq_u32 s74, 3
    s_cbranch_scc0 L_Bwait
    s_mov_b64 exec, 1
    buffer_atomic_add v255, off, s[60:63], s71 sc0
    s_waitcnt vmcnt(0)
    v_readfirstlane_b32 s74, v255
    s_cmp_ge_u32 s74, 7
    s_cbranch_scc1 L_pl28
    s_mov_b32 s75, 0x40000
L_pl27:
    buffer_load_dword v254, off, s[60:63], s71 sc1
    s_waitcnt vmcnt(0)
    v_readfirstlane_b32 s74, v254
    s_cmp_eq_u32 s74, 8
    s_cbranch_scc1 L_pl28
    s_sleep 3
    s_sub_u32 s75, s75, 1
    s_cmp_lg_u32 s75, 0
    s_cbranch_scc1 L_pl27
L_pl28:
    s_mov_b64 exec, -1
    v_mov_b32 v254, 156680
    v_mov_b32 v255, 1
    ds_write_b32 v254, v255
    s_branch L_final
L_Bwait:
    v_mov_b32 v254, 156680
L_Bspin:
    ds_read_b32 v255, v254
    s_waitcnt lgkmcnt(0)
    v_readfirstlane_b32 s74, v255
    s_cmp_eq_u32 s74, 0
    s_cbranch_scc1 L_Bspin
    s_branch L_final
L_Apub:
    s_add_u32 s60, s28, 0x2000000
    s_addc_u32 s61, s29, 0
    s_mov_b32 s62, 0x8000
    s_mov_b32 s63, 0x20000
    s_mul_i32 s71, s67, 768
    s_add_u32 s71, s71, 0
    v_mov_b32 v254, 156672
    v_mov_b32 v255, 1
    s_mov_b64 exec, 1
    s_waitcnt vmcnt(0)
    ds_add_rtn_u32 v254, v254, v255
    s_waitcnt lgkmcnt(0)
    v_readfirstlane_b32 s74, v254
    s_cmp_eq_u32 s74, 3
    s_cbranch_scc0 L_nosig
    buffer_atomic_add v255, off, s[60:63], s71
L_nosig:
    s_mov_b64 exec, -1
    s_barrier
    s_cmp_eq_u32 s65, 0
    s_cbranch_scc0 L_nopoll
    s_mov_b64 exec, 1
    s_mov_b32 s75, 0x40000
L_pl29:
    buffer_load_dword v254, off, s[60:63], s71 sc1
    s_waitcnt vmcnt(0)
    v_readfirstlane_b32 s74, v254
    s_cmp_eq_u32 s74, 8
    s_cbranch_scc1 L_pl30
    s_sleep 3
    s_sub_u32 s75, s75, 1
    s_cmp_lg_u32 s75, 0
    s_cbranch_scc1 L_pl29
L_pl30:
    s_mov_b64 exec, -1
L_nopoll:
    s_barrier
    s_add_u32 s82, s82, 0x2000
    s_and_b32 s82, s82, 0xffff
    s_waitcnt vmcnt(4)
    buffer_load_dwordx4 v[128:131], v245, s[52:55], s82 offen offset:0 sc1
    s_waitcnt vmcnt(4)
    buffer_load_dwordx4 v[132:135], v245, s[52:55], s82 offen offset:1024 sc1
    s_add_u32 s82, s82, 0x2000
    s_and_b32 s82, s82, 0xffff
    s_waitcnt vmcnt(4)
    buffer_load_dwordx4 v[136:139], v245, s[52:55], s82 offen offset:0 sc1
    s_waitcnt vmcnt(4)
    buffer_load_dwordx4 v[140:143], v245, s[52:55], s82 offen offset:1024 sc1
    s_add_u32 s82, s82, 0x2000
    s_and_b32 s82, s82, 0xffff
    s_waitcnt vmcnt(4)
    buffer_load_dwordx4 v[144:147], v245, s[52:55], s82 offen offset:0 sc1
    s_waitcnt vmcnt(4)
    buffer_load_dwordx4 v[148:151], v245, s[52:55], s82 offen offset:1024 sc1
    s_add_u32 s82, s82, 0x2000
    s_and_b32 s82, s82, 0xffff
    s_waitcnt vmcnt(4)
    buffer_load_dwordx4 v[152:155], v245, s[52:55], s82 offen offset:0 sc1
    s_waitcnt vmcnt(4)
    buffer_load_dwordx4 v[156:159], v245, s[52:55], s82 offen offset:1024 sc1
    s_add_u32 s82, s82, 0x2000
    s_and_b32 s82, s82, 0xffff
    s_waitcnt vmcnt(4)
    buffer_load_dwordx4 v[160:163], v245, s[52:55], s82 offen offset:0 sc1
    s_waitcnt vmcnt(4)
    buffer_load_dwordx4 v[164:167], v245, s[52:55], s82 offen offset:1024 sc1
    s_add_u32 s82, s82, 0x2000
    s_and_b32 s82, s82, 0xffff
    s_waitcnt vmcnt(4)
    buffer_load_dwordx4 v[168:171], v245, s[52:55], s82 offen offset:0 sc1
    s_waitcnt vmcnt(4)
    buffer_load_dwordx4 v[172:175], v245, s[52:55], s82 offen offset:1024 sc1
    s_add_u32 s82, s82, 0x2000
    s_and_b32 s82, s82, 0xffff
    s_waitcnt vmcnt(4)
    buffer_load_dwordx4 v[176:179], v245, s[52:55], s82 offen offset:0 sc1
    s_waitcnt vmcnt(4)
    buffer_load_dwordx4 v[180:183], v245, s[52:55], s82 offen offset:1024 sc1
    s_branch L_sum
L_final:
    s_mov_b64 exec, -1
    s_add_u32 s82, s82, 0x2000
    s_and_b32 s82, s82, 0xffff
    buffer_load_dwordx4 v[128:131], v245, s[52:55], s82 offen offset:0 sc1
    buffer_load_dwordx4 v[132:135], v245, s[52:55], s82 offen offset:1024 sc1
    s_add_u32 s82, s82, 0x2000
    s_and_b32 s82, s82, 0xffff
    buffer_load_dwordx4 v[136:139], v245, s[52:55], s82 offen offset:0 sc1
    buffer_load_dwordx4 v[140:143], v245, s[52:55], s82 offen offset:1024 sc1
    s_add_u32 s82, s82, 0x2000
    s_and_b32 s82, s82, 0xffff
    buffer_load_dwordx4 v[144:147], v245, s[52:55], s82 offen offset:0 sc1
    buffer_load_dwordx4 v[148:151], v245, s[52:55], s82 offen offset:1024 sc1
    s_add_u32 s82, s82, 0x2000
    s_and_b32 s82, s82, 0xffff
    buffer_load_dwordx4 v[152:155], v245, s[52:55], s82 offen offset:0 sc1
    buffer_load_dwordx4 v[156:159], v245, s[52:55], s82 offen offset:1024 sc1
    s_add_u32 s82, s82, 0x2000
    s_and_b32 s82, s82, 0xffff
    buffer_load_dwordx4 v[160:163], v245, s[52:55], s82 offen offset:0 sc1
    buffer_load_dwordx4 v[164:167], v245, s[52:55], s82 offen offset:1024 sc1
    s_add_u32 s82, s82, 0x2000
    s_and_b32 s82, s82, 0xffff
    buffer_load_dwordx4 v[168:171], v245, s[52:55], s82 offen offset:0 sc1
    buffer_load_dwordx4 v[172:175], v245, s[52:55], s82 offen offset:1024 sc1
    s_add_u32 s82, s82, 0x2000
    s_and_b32 s82, s82, 0xffff
    buffer_load_dwordx4 v[176:179], v245, s[52:55], s82 offen offset:0 sc1
    buffer_load_dwordx4 v[180:183], v245, s[52:55], s82 offen offset:1024 sc1
L_sum:
    s_waitcnt vmcnt(13)
    v_lshlrev_b32 v208, 16, v128
    v_and_b32 v209, 0xffff0000, v128
    v_lshlrev_b32 v210, 16, v129
    v_and_b32 v211, 0xffff0000, v129
    v_lshlrev_b32 v212, 16, v130
    v_and_b32 v213, 0xffff0000, v130
    v_lshlrev_b32 v214, 16, v131
    v_and_b32 v215, 0xffff0000, v131
    v_add_f32 v192, v192, v208
    v_add_f32 v193, v193, v209
    v_add_f32 v194, v194, v210
    v_add_f32 v195, v195, v211
    v_add_f32 v196, v196, v212
    v_add_f32 v197, v197, v213
    v_add_f32 v198, v198, v214
    v_add_f32 v199, v199, v215
    s_waitcnt vmcnt(12)
    v_lshlrev_b32 v216, 16, v132
    v_and_b32 v217, 0xffff0000, v132
    v_lshlrev_b32 v218, 16, v133
    v_and_b32 v219, 0xffff0000, v133
    v_lshlrev_b32 v220, 16, v134
    v_and_b32 v221, 0xffff0000, v134
    v_lshlrev_b32 v222, 16, v135
    v_and_b32 v223, 0xffff0000, v135
    v_add_f32 v200, v200, v216
    v_add_f32 v201, v201, v217
    v_add_f32 v202, v202, v218
    v_add_f32 v203, v203, v219
    v_add_f32 v204, v204, v220
    v_add_f32 v205, v205, v221
    v_add_f32 v206, v206, v222
    v_add_f32 v207, v207, v223
    s_waitcnt vmcnt(11)
    v_lshlrev_b32 v208, 16, v136
    v_and_b32 v209, 0xffff0000, v136
    v_lshlrev_b32 v210, 16, v137
    v_and_b32 v211, 0xffff0000, v137
    v_lshlrev_b32 v212, 16, v138
    v_and_b32 v213, 0xffff0000, v138
    v_lshlrev_b32 v214, 16, v139
    v_and_b32 v215, 0xffff0000, v139
    v_add_f32 v192, v192, v208
    v_add_f32 v193, v193, v209
    v_add_f32 v194, v194, v210
    v_add_f32 v195, v195, v211
    v_add_f32 v196, v196, v212
    v_add_f32 v197, v197, v213
    v_add_f32 v198, v198, v214
    v_add_f32 v199, v199, v215
    s_waitcnt vmcnt(10)
    v_lshlrev_b32 v216, 16, v140
    v_and_b32 v217, 0xffff0000, v140
    v_lshlrev_b32 v218, 16, v141
    v_and_b32 v219, 0xffff0000, v141
    v_lshlrev_b32 v220, 16, v142
    v_and_b32 v221, 0xffff0000, v142
    v_lshlrev_b32 v222, 16, v143
    v_and_b32 v223, 0xffff0000, v143
    v_add_f32 v200, v200, v216
    v_add_f32 v201, v201, v217
    v_add_f32 v202, v202, v218
    v_add_f32 v203, v203, v219
    v_add_f32 v204, v204, v220
    v_add_f32 v205, v205, v221
    v_add_f32 v206, v206, v222
    v_add_f32 v207, v207, v223
    s_waitcnt vmcnt(9)
    v_lshlrev_b32 v208, 16, v144
    v_and_b32 v209, 0xffff0000, v144
    v_lshlrev_b32 v210, 16, v145
    v_and_b32 v211, 0xffff0000, v145
    v_lshlrev_b32 v212, 16, v146
    v_and_b32 v213, 0xffff0000, v146
    v_lshlrev_b32 v214, 16, v147
    v_and_b32 v215, 0xffff0000, v147
    v_add_f32 v192, v192, v208
    v_add_f32 v193, v193, v209
    v_add_f32 v194, v194, v210
    v_add_f32 v195, v195, v211
    v_add_f32 v196, v196, v212
    v_add_f32 v197, v197, v213
    v_add_f32 v198, v198, v214
    v_add_f32 v199, v199, v215
    s_waitcnt vmcnt(8)
    v_lshlrev_b32 v216, 16, v148
    v_and_b32 v217, 0xffff0000, v148
    v_lshlrev_b32 v218, 16, v149
    v_and_b32 v219, 0xffff0000, v149
    v_lshlrev_b32 v220, 16, v150
    v_and_b32 v221, 0xffff0000, v150
    v_lshlrev_b32 v222, 16, v151
    v_and_b32 v223, 0xffff0000, v151
    v_add_f32 v200, v200, v216
    v_add_f32 v201, v201, v217
    v_add_f32 v202, v202, v218
    v_add_f32 v203, v203, v219
    v_add_f32 v204, v204, v220
    v_add_f32 v205, v205, v221
    v_add_f32 v206, v206, v222
    v_add_f32 v207, v207, v223
    s_waitcnt vmcnt(7)
    v_lshlrev_b32 v208, 16, v152
    v_and_b32 v209, 0xffff0000, v152
    v_lshlrev_b32 v210, 16, v153
    v_and_b32 v211, 0xffff0000, v153
    v_lshlrev_b32 v212, 16, v154
    v_and_b32 v213, 0xffff0000, v154
    v_lshlrev_b32 v214, 16, v155
    v_and_b32 v215, 0xffff0000, v155
    v_add_f32 v192, v192, v208
    v_add_f32 v193, v193, v209
    v_add_f32 v194, v194, v210
    v_add_f32 v195, v195, v211
    v_add_f32 v196, v196, v212
    v_add_f32 v197, v197, v213
    v_add_f32 v198, v198, v214
    v_add_f32 v199, v199, v215
    s_waitcnt vmcnt(6)
    v_lshlrev_b32 v216, 16, v156
    v_and_b32 v217, 0xffff0000, v156
    v_lshlrev_b32 v218, 16, v157
    v_and_b32 v219, 0xffff0000, v157
    v_lshlrev_b32 v220, 16, v158
    v_and_b32 v221, 0xffff0000, v158
    v_lshlrev_b32 v222, 16, v159
    v_and_b32 v223, 0xffff0000, v159
    v_add_f32 v200, v200, v216
    v_add_f32 v201, v201, v217
    v_add_f32 v202, v202, v218
    v_add_f32 v203, v203, v219
    v_add_f32 v204, v204, v220
    v_add_f32 v205, v205, v221
    v_add_f32 v206, v206, v222
    v_add_f32 v207, v207, v223
    s_waitcnt vmcnt(5)
    v_lshlrev_b32 v208, 16, v160
    v_and_b32 v209, 0xffff0000, v160
    v_lshlrev_b32 v210, 16, v161
    v_and_b32 v211, 0xffff0000, v161
    v_lshlrev_b32 v212, 16, v162
    v_and_b32 v213, 0xffff0000, v162
    v_lshlrev_b32 v214, 16, v163
    v_and_b32 v215, 0xffff0000, v163
    v_add_f32 v192, v192, v208
    v_add_f32 v193, v193, v209
    v_add_f32 v194, v194, v210
    v_add_f32 v195, v195, v211
    v_add_f32 v196, v196, v212
    v_add_f32 v197, v197, v213
    v_add_f32 v198, v198, v214
    v_add_f32 v199, v199, v215
    s_waitcnt vmcnt(4)
    v_lshlrev_b32 v216, 16, v164
    v_and_b32 v217, 0xffff0000, v164
    v_lshlrev_b32 v218, 16, v165
    v_and_b32 v219, 0xffff0000, v165
    v_lshlrev_b32 v220, 16, v166
    v_and_b32 v221, 0xffff0000, v166
    v_lshlrev_b32 v222, 16, v167
    v_and_b32 v223, 0xffff0000, v167
    v_add_f32 v200, v200, v216
    v_add_f32 v201, v201, v217
    v_add_f32 v202, v202, v218
    v_add_f32 v203, v203, v219
    v_add_f32 v204, v204, v220
    v_add_f32 v205, v205, v221
    v_add_f32 v206, v206, v222
    v_add_f32 v207, v207, v223
    s_waitcnt vmcnt(3)
    v_lshlrev_b32 v208, 16, v168
    v_and_b32 v209, 0xffff0000, v168
    v_lshlrev_b32 v210, 16, v169
    v_and_b32 v211, 0xffff0000, v169
    v_lshlrev_b32 v212, 16, v170
    v_and_b32 v213, 0xffff0000, v170
    v_lshlrev_b32 v214, 16, v171
    v_and_b32 v215, 0xffff0000, v171
    v_add_f32 v192, v192, v208
    v_add_f32 v193, v193, v209
    v_add_f32 v194, v194, v210
    v_add_f32 v195, v195, v211
    v_add_f32 v196, v196, v212
    v_add_f32 v197, v197, v213
    v_add_f32 v198, v198, v214
    v_add_f32 v199, v199, v215
    s_waitcnt vmcnt(2)
    v_lshlrev_b32 v216, 16, v172
    v_and_b32 v217, 0xffff0000, v172
    v_lshlrev_b32 v218, 16, v173
    v_and_b32 v219, 0xffff0000, v173
    v_lshlrev_b32 v220, 16, v174
    v_and_b32 v221, 0xffff0000, v174
    v_lshlrev_b32 v222, 16, v175
    v_and_b32 v223, 0xffff0000, v175
    v_add_f32 v200, v200, v216
    v_add_f32 v201, v201, v217
    v_add_f32 v202, v202, v218
    v_add_f32 v203, v203, v219
    v_add_f32 v204, v204, v220
    v_add_f32 v205, v205, v221
    v_add_f32 v206, v206, v222
    v_add_f32 v207, v207, v223
    s_waitcnt vmcnt(1)
    v_lshlrev_b32 v208, 16, v176
    v_and_b32 v209, 0xffff0000, v176
    v_lshlrev_b32 v210, 16, v177
    v_and_b32 v211, 0xffff0000, v177
    v_lshlrev_b32 v212, 16, v178
    v_and_b32 v213, 0xffff0000, v178
    v_lshlrev_b32 v214, 16, v179
    v_and_b32 v215, 0xffff0000, v179
    v_add_f32 v192, v192, v208
    v_add_f32 v193, v193, v209
    v_add_f32 v194, v194, v210
    v_add_f32 v195, v195, v211
    v_add_f32 v196, v196, v212
    v_add_f32 v197, v197, v213
    v_add_f32 v198, v198, v214
    v_add_f32 v199, v199, v215
    v_cvt_pk_bf16_f32 v192, v192, v193
    v_cvt_pk_bf16_f32 v193, v194, v195
    v_cvt_pk_bf16_f32 v194, v196, v197
    v_cvt_pk_bf16_f32 v195, v198, v199
    s_waitcnt vmcnt(0)
    v_lshlrev_b32 v216, 16, v180
    v_and_b32 v217, 0xffff0000, v180
    v_lshlrev_b32 v218, 16, v181
    v_and_b32 v219, 0xffff0000, v181
    v_lshlrev_b32 v220, 16, v182
    v_and_b32 v221, 0xffff0000, v182
    v_lshlrev_b32 v222, 16, v183
    v_and_b32 v223, 0xffff0000, v183
    v_add_f32 v200, v200, v216
    v_add_f32 v201, v201, v217
    v_add_f32 v202, v202, v218
    v_add_f32 v203, v203, v219
    v_add_f32 v204, v204, v220
    v_add_f32 v205, v205, v221
    v_add_f32 v206, v206, v222
    v_add_f32 v207, v207, v223
    v_cvt_pk_bf16_f32 v200, v200, v201
    v_cvt_pk_bf16_f32 v201, v202, v203
    v_cvt_pk_bf16_f32 v202, v204, v205
    v_cvt_pk_bf16_f32 v203, v206, v207
    v_permlane16_swap_b32 v192, v194
    v_permlane16_swap_b32 v193, v195
    buffer_store_dwordx4 v[192:195], v242, s[56:59], s81 offen offset:0 sc1
    v_permlane16_swap_b32 v200, v202
    v_permlane16_swap_b32 v201, v203
    buffer_store_dwordx4 v[200:203], v242, s[56:59], s81 offen offset:64 sc1
L_end:
    s_endpgm
L_slow:
    s_cmp_eq_u32 s64, 0
    s_cbranch_scc1 L_slowB
    v_bfe_u32 v254, v253, 4, 1
    v_lshlrev_b32 v254, 4, v254
    v_xor_b32 v244, v245, v254
    s_barrier
    v_add_u32 v242, 0xffff3400, v242
    v_add_u32 v243, 0xffff3400, v243
    s_mul_i32 s73, s65, 17408
    v_add_u32 v242, s73, v242
    v_add_u32 v243, s73, v243
    v_add_u32 v243, 0, v243
    s_add_u32 s73, s73, 34816
L_slowB:
    v_add_u32 v243, 0xffffde00, v243
    v_mov_b64 v[0:1], 0
    v_mov_b64 v[2:3], 0
    v_mov_b64 v[4:5], 0
    v_mov_b64 v[6:7], 0
    v_mov_b64 v[8:9], 0
    v_mov_b64 v[10:11], 0
    v_mov_b64 v[12:13], 0
    v_mov_b64 v[14:15], 0
    v_mov_b64 v[16:17], 0
    v_mov_b64 v[18:19], 0
    v_mov_b64 v[20:21], 0
    v_mov_b64 v[22:23], 0
    v_mov_b64 v[24:25], 0
    v_mov_b64 v[26:27], 0
    v_mov_b64 v[28:29], 0
    v_mov_b64 v[30:31], 0
    v_mov_b64 v[32:33], 0
    v_mov_b64 v[34:35], 0
    v_mov_b64 v[36:37], 0
    v_mov_b64 v[38:39], 0
    v_mov_b64 v[40:41], 0
    v_mov_b64 v[42:43], 0
    v_mov_b64 v[44:45], 0
    v_mov_b64 v[46:47], 0
    v_mov_b64 v[48:49], 0
    v_mov_b64 v[50:51], 0
    v_mov_b64 v[52:53], 0
    v_mov_b64 v[54:55], 0
    v_mov_b64 v[56:57], 0
    v_mov_b64 v[58:59], 0
    v_mov_b64 v[60:61], 0
    v_mov_b64 v[62:63], 0
    v_mov_b64 v[64:65], 0
    v_mov_b64 v[66:67], 0
    v_mov_b64 v[68:69], 0
    v_mov_b64 v[70:71], 0
    v_mov_b64 v[72:73], 0
    v_mov_b64 v[74:75], 0
    v_mov_b64 v[76:77], 0
    v_mov_b64 v[78:79], 0
    v_mov_b64 v[80:81], 0
    v_mov_b64 v[82:83], 0
    v_mov_b64 v[84:85], 0
    v_mov_b64 v[86:87], 0
    v_mov_b64 v[88:89], 0
    v_mov_b64 v[90:91], 0
    v_mov_b64 v[92:93], 0
    v_mov_b64 v[94:95], 0
    v_mov_b64 v[96:97], 0
    v_mov_b64 v[98:99], 0
    v_mov_b64 v[100:101], 0
    v_mov_b64 v[102:103], 0
    v_mov_b64 v[104:105], 0
    v_mov_b64 v[106:107], 0
    v_mov_b64 v[108:109], 0
    v_mov_b64 v[110:111], 0
    v_mov_b64 v[112:113], 0
    v_mov_b64 v[114:115], 0
    v_mov_b64 v[116:117], 0
    v_mov_b64 v[118:119], 0
    v_mov_b64 v[120:121], 0
    v_mov_b64 v[122:123], 0
    v_mov_b64 v[124:125], 0
    v_mov_b64 v[126:127], 0
    v_mov_b32 v236, 0
    v_mov_b32 v246, 0xff61b1e6
    v_mov_b32 v237, 0
    v_mov_b32 v247, 0xff61b1e6
    v_mov_b32 v238, 0
    v_mov_b32 v248, 0xff61b1e6
    v_mov_b32 v239, 0
    v_mov_b32 v249, 0xff61b1e6
    s_mov_b32 s70, 0
L_slowloop:
    s_add_u32 s71, s70, 4096
    s_add_u32 m0, s73, 0
    s_nop 0
    buffer_load_dwordx4 v244, s[32:35], s70 offen offset:0 nt lds
    s_add_u32 m0, s73, 4352
    s_nop 0
    buffer_load_dwordx4 v244, s[32:35], s71 offen offset:0 nt lds
    s_add_u32 m0, s73, 128
    s_nop 0
    buffer_load_dwordx4 v244, s[32:35], s70 offen offset:2048 nt lds
    s_add_u32 m0, s73, 4480
    s_nop 0
    buffer_load_dwordx4 v244, s[32:35], s71 offen offset:2048 nt lds
    s_add_u32 m0, s73, 64
    s_nop 0
    buffer_load_dwordx4 v244, s[32:35], s70 offen offset:1024 nt lds
    s_add_u32 m0, s73, 4416
    s_nop 0
    buffer_load_dwordx4 v244, s[32:35], s71 offen offset:1024 nt lds
    s_add_u32 m0, s73, 192
    s_nop 0
    buffer_load_dwordx4 v244, s[32:35], s70 offen offset:3072 nt lds
    s_add_u32 m0, s73, 4544
    s_nop 0
    buffer_load_dwordx4 v244, s[32:35], s71 offen offset:3072 nt lds
    s_waitcnt vmcnt(0)
    ds_read_b128 v[224:227], v242 offset:0
    ds_read_b128 v[228:231], v242 offset:64
    ds_read_b128 v[232:235], v242 offset:128
    s_waitcnt lgkmcnt(2)
    v_mfma_f32_16x16x32_bf16 v[192:195], v[224:227], v[128:131], 0
    v_mfma_f32_16x16x32_bf16 v[200:203], v[224:227], v[144:147], 0
    v_mfma_f32_16x16x32_bf16 v[208:211], v[224:227], v[160:163], 0
    v_mfma_f32_16x16x32_bf16 v[216:219], v[224:227], v[176:179], 0
    ds_read_b128 v[224:227], v242 offset:192
    s_waitcnt lgkmcnt(2)
    v_mfma_f32_16x16x32_bf16 v[192:195], v[228:231], v[132:135], v[192:195]
    v_mfma_f32_16x16x32_bf16 v[200:203], v[228:231], v[148:151], v[200:203]
    v_mfma_f32_16x16x32_bf16 v[208:211], v[228:231], v[164:167], v[208:211]
    v_mfma_f32_16x16x32_bf16 v[216:219], v[228:231], v[180:183], v[216:219]
    ds_read_b128 v[228:231], v242 offset:512
    s_waitcnt lgkmcnt(2)
    v_mfma_f32_16x16x32_bf16 v[192:195], v[232:235], v[136:139], v[192:195]
    v_mfma_f32_16x16x32_bf16 v[200:203], v[232:235], v[152:155], v[200:203]
    v_mfma_f32_16x16x32_bf16 v[208:211], v[232:235], v[168:171], v[208:211]
    v_mfma_f32_16x16x32_bf16 v[216:219], v[232:235], v[184:187], v[216:219]
    ds_read_b128 v[232:235], v242 offset:576
    s_waitcnt lgkmcnt(2)
    v_mfma_f32_16x16x32_bf16 v[192:195], v[224:227], v[140:143], v[192:195]
    v_mfma_f32_16x16x32_bf16 v[200:203], v[224:227], v[156:159], v[200:203]
    v_mfma_f32_16x16x32_bf16 v[208:211], v[224:227], v[172:175], v[208:211]
    v_mfma_f32_16x16x32_bf16 v[216:219], v[224:227], v[188:191], v[216:219]
    ds_read_b128 v[224:227], v242 offset:640
    s_waitcnt lgkmcnt(2)
    v_mfma_f32_16x16x32_bf16 v[196:199], v[228:231], v[128:131], 0
    v_mfma_f32_16x16x32_bf16 v[204:207], v[228:231], v[144:147], 0
    v_mfma_f32_16x16x32_bf16 v[212:215], v[228:231], v[160:163], 0
    v_mfma_f32_16x16x32_bf16 v[220:223], v[228:231], v[176:179], 0
    ds_read_b128 v[228:231], v242 offset:704
    s_waitcnt lgkmcnt(2)
    v_mfma_f32_16x16x32_bf16 v[196:199], v[232:235], v[132:135], v[196:199]
    v_mfma_f32_16x16x32_bf16 v[204:207], v[232:235], v[148:151], v[204:207]
    v_mfma_f32_16x16x32_bf16 v[212:215], v[232:235], v[164:167], v[212:215]
    v_mfma_f32_16x16x32_bf16 v[220:223], v[232:235], v[180:183], v[220:223]
    s_waitcnt lgkmcnt(1)
    v_mfma_f32_16x16x32_bf16 v[196:199], v[224:227], v[136:139], v[196:199]
    v_mfma_f32_16x16x32_bf16 v[204:207], v[224:227], v[152:155], v[204:207]
    v_mfma_f32_16x16x32_bf16 v[212:215], v[224:227], v[168:171], v[212:215]
    v_mfma_f32_16x16x32_bf16 v[220:223], v[224:227], v[184:187], v[220:223]
    s_waitcnt lgkmcnt(0)
    v_mfma_f32_16x16x32_bf16 v[196:199], v[228:231], v[140:143], v[196:199]
    v_mfma_f32_16x16x32_bf16 v[204:207], v[228:231], v[156:159], v[204:207]
    v_mfma_f32_16x16x32_bf16 v[212:215], v[228:231], v[172:175], v[212:215]
    v_mfma_f32_16x16x32_bf16 v[220:223], v[228:231], v[188:191], v[220:223]
    s_add_u32 s71, s70, 4096
    s_add_u32 m0, s73, 0
    s_nop 0
    buffer_load_dwordx4 v245, s[36:39], s70 offen offset:0 nt lds
    s_add_u32 m0, s73, 4224
    s_nop 0
    buffer_load_dwordx4 v245, s[36:39], s71 offen offset:0 nt lds
    s_add_u32 m0, s73, 64
    s_nop 0
    buffer_load_dwordx4 v245, s[36:39], s70 offen offset:2048 nt lds
    s_add_u32 m0, s73, 4288
    s_nop 0
    buffer_load_dwordx4 v245, s[36:39], s71 offen offset:2048 nt lds
    s_add_u32 m0, s73, 32
    s_nop 0
    buffer_load_dwordx4 v245, s[36:39], s70 offen offset:1024 nt lds
    s_add_u32 m0, s73, 4256
    s_nop 0
    buffer_load_dwordx4 v245, s[36:39], s71 offen offset:1024 nt lds
    s_add_u32 m0, s73, 96
    s_nop 0
    buffer_load_dwordx4 v245, s[36:39], s70 offen offset:3072 nt lds
    s_add_u32 m0, s73, 4320
    s_nop 0
    buffer_load_dwordx4 v245, s[36:39], s71 offen offset:3072 nt lds
    v_max3_f32 v224, v192, v193, v194
    v_max3_f32 v224, v224, v195, v196
    v_max3_f32 v224, v224, v197, v198
    v_max3_f32 v224, v224, v199, v246
    v_mov_b32 v254, v224
    s_nop 1
    v_permlane32_swap_b32 v224, v254
    v_max_f32 v224, v224, v254
    v_mov_b32 v254, v224
    s_nop 1
    v_permlane16_swap_b32 v224, v254
    v_max_f32 v224, v224, v254
    v_sub_f32 v225, v246, v224
    v_mov_b32 v246, v224
    v_exp_f32 v225, v225
    v_sub_f32 v192, v192, v246
    v_sub_f32 v193, v193, v246
    v_sub_f32 v194, v194, v246
    v_sub_f32 v195, v195, v246
    v_sub_f32 v196, v196, v246
    v_sub_f32 v197, v197, v246
    v_sub_f32 v198, v198, v246
    v_sub_f32 v199, v199, v246
    v_mul_f32 v236, v236, v225
    v_and_b32 v255, 48, v253
    ds_bpermute_b32 v232, v255, v225 offset:0
    ds_bpermute_b32 v233, v255, v225 offset:4
    ds_bpermute_b32 v234, v255, v225 offset:8
    ds_bpermute_b32 v235, v255, v225 offset:12
    s_waitcnt lgkmcnt(0)
    v_pk_mul_f32 v[0:1], v[0:1], v[232:233]
    v_pk_mul_f32 v[2:3], v[2:3], v[234:235]
    v_pk_mul_f32 v[4:5], v[4:5], v[232:233]
    v_pk_mul_f32 v[6:7], v[6:7], v[234:235]
    v_pk_mul_f32 v[32:33], v[32:33], v[232:233]
    v_pk_mul_f32 v[34:35], v[34:35], v[234:235]
    v_pk_mul_f32 v[36:37], v[36:37], v[232:233]
    v_pk_mul_f32 v[38:39], v[38:39], v[234:235]
    v_pk_mul_f32 v[64:65], v[64:65], v[232:233]
    v_pk_mul_f32 v[66:67], v[66:67], v[234:235]
    v_pk_mul_f32 v[68:69], v[68:69], v[232:233]
    v_pk_mul_f32 v[70:71], v[70:71], v[234:235]
    v_pk_mul_f32 v[96:97], v[96:97], v[232:233]
    v_pk_mul_f32 v[98:99], v[98:99], v[234:235]
    v_pk_mul_f32 v[100:101], v[100:101], v[232:233]
    v_pk_mul_f32 v[102:103], v[102:103], v[234:235]
    v_exp_f32 v192, v192
    v_exp_f32 v193, v193
    v_exp_f32 v194, v194
    v_exp_f32 v195, v195
    v_cvt_pk_bf16_f32 v192, v192, v193
    v_cvt_pk_bf16_f32 v193, v194, v195
    v_max3_f32 v226, v200, v201, v202
    v_max3_f32 v226, v226, v203, v204
    v_max3_f32 v226, v226, v205, v206
    v_max3_f32 v226, v226, v207, v247
    v_mov_b32 v254, v226
    s_nop 1
    v_permlane32_swap_b32 v226, v254
    v_max_f32 v226, v226, v254
    v_mov_b32 v254, v226
    s_nop 1
    v_permlane16_swap_b32 v226, v254
    v_max_f32 v226, v226, v254
    v_sub_f32 v227, v247, v226
    v_mov_b32 v247, v226
    v_exp_f32 v227, v227
    v_sub_f32 v200, v200, v247
    v_sub_f32 v201, v201, v247
    v_sub_f32 v202, v202, v247
    v_sub_f32 v203, v203, v247
    v_sub_f32 v204, v204, v247
    v_sub_f32 v205, v205, v247
    v_sub_f32 v206, v206, v247
    v_sub_f32 v207, v207, v247
    v_mul_f32 v237, v237, v227
    v_and_b32 v255, 48, v253
    ds_bpermute_b32 v232, v255, v227 offset:0
    ds_bpermute_b32 v233, v255, v227 offset:4
    ds_bpermute_b32 v234, v255, v227 offset:8
    ds_bpermute_b32 v235, v255, v227 offset:12
    s_waitcnt lgkmcnt(0)
    v_pk_mul_f32 v[8:9], v[8:9], v[232:233]
    v_pk_mul_f32 v[10:11], v[10:11], v[234:235]
    v_pk_mul_f32 v[12:13], v[12:13], v[232:233]
    v_pk_mul_f32 v[14:15], v[14:15], v[234:235]
    v_pk_mul_f32 v[40:41], v[40:41], v[232:233]
    v_pk_mul_f32 v[42:43], v[42:43], v[234:235]
    v_pk_mul_f32 v[44:45], v[44:45], v[232:233]
    v_pk_mul_f32 v[46:47], v[46:47], v[234:235]
    v_pk_mul_f32 v[72:73], v[72:73], v[232:233]
    v_pk_mul_f32 v[74:75], v[74:75], v[234:235]
    v_pk_mul_f32 v[76:77], v[76:77], v[232:233]
    v_pk_mul_f32 v[78:79], v[78:79], v[234:235]
    v_pk_mul_f32 v[104:105], v[104:105], v[232:233]
    v_pk_mul_f32 v[106:107], v[106:107], v[234:235]
    v_pk_mul_f32 v[108:109], v[108:109], v[232:233]
    v_pk_mul_f32 v[110:111], v[110:111], v[234:235]
    v_exp_f32 v200, v200
    v_exp_f32 v201, v201
    v_exp_f32 v202, v202
    v_exp_f32 v203, v203
    v_cvt_pk_bf16_f32 v200, v200, v201
    v_cvt_pk_bf16_f32 v201, v202, v203
    v_max3_f32 v228, v208, v209, v210
    v_max3_f32 v228, v228, v211, v212
    v_max3_f32 v228, v228, v213, v214
    v_max3_f32 v228, v228, v215, v248
    v_mov_b32 v254, v228
    s_nop 1
    v_permlane32_swap_b32 v228, v254
    v_max_f32 v228, v228, v254
    v_mov_b32 v254, v228
    s_nop 1
    v_permlane16_swap_b32 v228, v254
    v_max_f32 v228, v228, v254
    v_sub_f32 v229, v248, v228
    v_mov_b32 v248, v228
    v_exp_f32 v229, v229
    v_sub_f32 v208, v208, v248
    v_sub_f32 v209, v209, v248
    v_sub_f32 v210, v210, v248
    v_sub_f32 v211, v211, v248
    v_sub_f32 v212, v212, v248
    v_sub_f32 v213, v213, v248
    v_sub_f32 v214, v214, v248
    v_sub_f32 v215, v215, v248
    v_mul_f32 v238, v238, v229
    v_and_b32 v255, 48, v253
    ds_bpermute_b32 v232, v255, v229 offset:0
    ds_bpermute_b32 v233, v255, v229 offset:4
    ds_bpermute_b32 v234, v255, v229 offset:8
    ds_bpermute_b32 v235, v255, v229 offset:12
    s_waitcnt lgkmcnt(0)
    v_pk_mul_f32 v[16:17], v[16:17], v[232:233]
    v_pk_mul_f32 v[18:19], v[18:19], v[234:235]
    v_pk_mul_f32 v[20:21], v[20:21], v[232:233]
    v_pk_mul_f32 v[22:23], v[22:23], v[234:235]
    v_pk_mul_f32 v[48:49], v[48:49], v[232:233]
    v_pk_mul_f32 v[50:51], v[50:51], v[234:235]
    v_pk_mul_f32 v[52:53], v[52:53], v[232:233]
    v_pk_mul_f32 v[54:55], v[54:55], v[234:235]
    v_pk_mul_f32 v[80:81], v[80:81], v[232:233]
    v_pk_mul_f32 v[82:83], v[82:83], v[234:235]
    v_pk_mul_f32 v[84:85], v[84:85], v[232:233]
    v_pk_mul_f32 v[86:87], v[86:87], v[234:235]
    v_pk_mul_f32 v[112:113], v[112:113], v[232:233]
    v_pk_mul_f32 v[114:115], v[114:115], v[234:235]
    v_pk_mul_f32 v[116:117], v[116:117], v[232:233]
    v_pk_mul_f32 v[118:119], v[118:119], v[234:235]
    v_exp_f32 v208, v208
    v_exp_f32 v209, v209
    v_exp_f32 v210, v210
    v_exp_f32 v211, v211
    v_cvt_pk_bf16_f32 v208, v208, v209
    v_cvt_pk_bf16_f32 v209, v210, v211
    v_max3_f32 v230, v216, v217, v218
    v_max3_f32 v230, v230, v219, v220
    v_max3_f32 v230, v230, v221, v222
    v_max3_f32 v230, v230, v223, v249
    v_mov_b32 v254, v230
    s_nop 1
    v_permlane32_swap_b32 v230, v254
    v_max_f32 v230, v230, v254
    v_mov_b32 v254, v230
    s_nop 1
    v_permlane16_swap_b32 v230, v254
    v_max_f32 v230, v230, v254
    v_sub_f32 v231, v249, v230
    v_mov_b32 v249, v230
    v_exp_f32 v231, v231
    v_sub_f32 v216, v216, v249
    v_sub_f32 v217, v217, v249
    v_sub_f32 v218, v218, v249
    v_sub_f32 v219, v219, v249
    v_sub_f32 v220, v220, v249
    v_sub_f32 v221, v221, v249
    v_sub_f32 v222, v222, v249
    v_sub_f32 v223, v223, v249
    v_mul_f32 v239, v239, v231
    v_and_b32 v255, 48, v253
    ds_bpermute_b32 v232, v255, v231 offset:0
    ds_bpermute_b32 v233, v255, v231 offset:4
    ds_bpermute_b32 v234, v255, v231 offset:8
    ds_bpermute_b32 v235, v255, v231 offset:12
    s_waitcnt lgkmcnt(0)
    v_pk_mul_f32 v[24:25], v[24:25], v[232:233]
    v_pk_mul_f32 v[26:27], v[26:27], v[234:235]
    v_pk_mul_f32 v[28:29], v[28:29], v[232:233]
    v_pk_mul_f32 v[30:31], v[30:31], v[234:235]
    v_pk_mul_f32 v[56:57], v[56:57], v[232:233]
    v_pk_mul_f32 v[58:59], v[58:59], v[234:235]
    v_pk_mul_f32 v[60:61], v[60:61], v[232:233]
    v_pk_mul_f32 v[62:63], v[62:63], v[234:235]
    v_pk_mul_f32 v[88:89], v[88:89], v[232:233]
    v_pk_mul_f32 v[90:91], v[90:91], v[234:235]
    v_pk_mul_f32 v[92:93], v[92:93], v[232:233]
    v_pk_mul_f32 v[94:95], v[94:95], v[234:235]
    v_pk_mul_f32 v[120:121], v[120:121], v[232:233]
    v_pk_mul_f32 v[122:123], v[122:123], v[234:235]
    v_pk_mul_f32 v[124:125], v[124:125], v[232:233]
    v_pk_mul_f32 v[126:127], v[126:127], v[234:235]
    v_exp_f32 v216, v216
    v_exp_f32 v217, v217
    v_exp_f32 v218, v218
    v_exp_f32 v219, v219
    v_cvt_pk_bf16_f32 v216, v216, v217
    v_cvt_pk_bf16_f32 v217, v218, v219
    s_waitcnt vmcnt(0)
    ds_read_b64_tr_b16 v[224:225], v243 offset:0
    ds_read_b64_tr_b16 v[226:227], v243 offset:512
    ds_read_b64_tr_b16 v[228:229], v243 offset:32
    ds_read_b64_tr_b16 v[230:231], v243 offset:544
    ds_read_b64_tr_b16 v[232:233], v243 offset:64
    ds_read_b64_tr_b16 v[234:235], v243 offset:576
    v_exp_f32 v196, v196
    v_exp_f32 v197, v197
    v_exp_f32 v198, v198
    v_exp_f32 v199, v199
    v_cvt_pk_bf16_f32 v194, v196, v197
    v_cvt_pk_bf16_f32 v195, v198, v199
    ds_read_b64_tr_b16 v[196:197], v243 offset:96
    ds_read_b64_tr_b16 v[198:199], v243 offset:608
    s_waitcnt lgkmcnt(6)
    v_mfma_f32_16x16x32_bf16 v[0:3], v[192:195], v[224:227], v[0:3]
    v_exp_f32 v204, v204
    v_exp_f32 v205, v205
    v_mfma_f32_4x4x4_16b_bf16 v[236:239], v[240:241], v[192:193], v[236:239] cbsz:2 abid:0
    s_waitcnt lgkmcnt(4)
    v_mfma_f32_16x16x32_bf16 v[4:7], v[192:195], v[228:231], v[4:7]
    v_exp_f32 v206, v206
    v_exp_f32 v207, v207
    s_waitcnt lgkmcnt(2)
    v_mfma_f32_16x16x32_bf16 v[32:35], v[192:195], v[232:235], v[32:35]
    v_cvt_pk_bf16_f32 v202, v204, v205
    v_cvt_pk_bf16_f32 v203, v206, v207
    v_mfma_f32_4x4x4_16b_bf16 v[236:239], v[240:241], v[194:195], v[236:239] cbsz:2 abid:0
    ds_read_b64_tr_b16 v[204:205], v243 offset:128
    ds_read_b64_tr_b16 v[206:207], v243 offset:640
    v_mfma_f32_16x16x32_bf16 v[8:11], v[200:203], v[224:227], v[8:11]
    v_exp_f32 v212, v212
    v_exp_f32 v213, v213
    v_mfma_f32_4x4x4_16b_bf16 v[236:239], v[240:241], v[200:201], v[236:239] cbsz:2 abid:1
    v_mfma_f32_16x16x32_bf16 v[12:15], v[200:203], v[228:231], v[12:15]
    v_exp_f32 v214, v214
    v_exp_f32 v215, v215
    v_mfma_f32_16x16x32_bf16 v[40:43], v[200:203], v[232:235], v[40:43]
    v_cvt_pk_bf16_f32 v210, v212, v213
    v_cvt_pk_bf16_f32 v211, v214, v215
    v_mfma_f32_4x4x4_16b_bf16 v[236:239], v[240:241], v[202:203], v[236:239] cbsz:2 abid:1
    ds_read_b64_tr_b16 v[212:213], v243 offset:160
    ds_read_b64_tr_b16 v[214:215], v243 offset:672
    v_mfma_f32_16x16x32_bf16 v[16:19], v[208:211], v[224:227], v[16:19]
    v_exp_f32 v220, v220
    v_exp_f32 v221, v221
    v_mfma_f32_4x4x4_16b_bf16 v[236:239], v[240:241], v[208:209], v[236:239] cbsz:2 abid:2
    v_mfma_f32_16x16x32_bf16 v[20:23], v[208:211], v[228:231], v[20:23]
    v_exp_f32 v222, v222
    v_exp_f32 v223, v223
    v_mfma_f32_16x16x32_bf16 v[48:51], v[208:211], v[232:235], v[48:51]
    v_cvt_pk_bf16_f32 v218, v220, v221
    v_cvt_pk_bf16_f32 v219, v222, v223
    v_mfma_f32_4x4x4_16b_bf16 v[236:239], v[240:241], v[210:211], v[236:239] cbsz:2 abid:2
    ds_read_b64_tr_b16 v[220:221], v243 offset:192
    ds_read_b64_tr_b16 v[222:223], v243 offset:704
    v_mfma_f32_16x16x32_bf16 v[24:27], v[216:219], v[224:227], v[24:27]
    v_mfma_f32_4x4x4_16b_bf16 v[236:239], v[240:241], v[216:217], v[236:239] cbsz:2 abid:3
    v_mfma_f32_16x16x32_bf16 v[28:31], v[216:219], v[228:231], v[28:31]
    v_mfma_f32_16x16x32_bf16 v[56:59], v[216:219], v[232:235], v[56:59]
    v_mfma_f32_4x4x4_16b_bf16 v[236:239], v[240:241], v[218:219], v[236:239] cbsz:2 abid:3
    ds_read_b64_tr_b16 v[224:225], v243 offset:224
    ds_read_b64_tr_b16 v[226:227], v243 offset:736
    s_waitcnt lgkmcnt(8)
    v_mfma_f32_16x16x32_bf16 v[60:63], v[216:219], v[196:199], v[60:63]
    v_mfma_f32_16x16x32_bf16 v[52:55], v[208:211], v[196:199], v[52:55]
    v_mfma_f32_16x16x32_bf16 v[44:47], v[200:203], v[196:199], v[44:47]
    v_mfma_f32_16x16x32_bf16 v[36:39], v[192:195], v[196:199], v[36:39]
    s_waitcnt lgkmcnt(6)
    v_mfma_f32_16x16x32_bf16 v[64:67], v[192:195], v[204:207], v[64:67]
    v_mfma_f32_16x16x32_bf16 v[72:75], v[200:203], v[204:207], v[72:75]
    v_mfma_f32_16x16x32_bf16 v[80:83], v[208:211], v[204:207], v[80:83]
    v_mfma_f32_16x16x32_bf16 v[88:91], v[216:219], v[204:207], v[88:91]
    s_waitcnt lgkmcnt(4)
    v_mfma_f32_16x16x32_bf16 v[92:95], v[216:219], v[212:215], v[92:95]
    v_mfma_f32_16x16x32_bf16 v[84:87], v[208:211], v[212:215], v[84:87]
    v_mfma_f32_16x16x32_bf16 v[76:79], v[200:203], v[212:215], v[76:79]
    v_mfma_f32_16x16x32_bf16 v[68:71], v[192:195], v[212:215], v[68:71]
    s_waitcnt lgkmcnt(2)
    v_mfma_f32_16x16x32_bf16 v[96:99], v[192:195], v[220:223], v[96:99]
    v_mfma_f32_16x16x32_bf16 v[104:107], v[200:203], v[220:223], v[104:107]
    v_mfma_f32_16x16x32_bf16 v[112:115], v[208:211], v[220:223], v[112:115]
    v_mfma_f32_16x16x32_bf16 v[120:123], v[216:219], v[220:223], v[120:123]
    s_waitcnt lgkmcnt(0)
    v_mfma_f32_16x16x32_bf16 v[124:127], v[216:219], v[224:227], v[124:127]
    v_mfma_f32_16x16x32_bf16 v[116:119], v[208:211], v[224:227], v[116:119]
    v_mfma_f32_16x16x32_bf16 v[108:111], v[200:203], v[224:227], v[108:111]
    v_mfma_f32_16x16x32_bf16 v[100:103], v[192:195], v[224:227], v[100:103]
    s_add_u32 s70, s70, 8192
    s_cmp_lt_u32 s70, 0x20000
    s_cbranch_scc1 L_slowloop
    v_mov_b32 v224, v236
    v_mov_b32 v225, v237
    v_mov_b32 v226, v238
    v_mov_b32 v227, v239
    v_permlane32_swap_b32 v236, v224
    v_permlane32_swap_b32 v237, v225
    v_permlane32_swap_b32 v238, v226
    v_permlane32_swap_b32 v239, v227
    v_add_f32 v236, v236, v224
    v_add_f32 v237, v237, v225
    v_add_f32 v238, v238, v226
    v_add_f32 v239, v239, v227
    v_mov_b32 v224, v236
    v_mov_b32 v225, v237
    v_mov_b32 v226, v238
    v_mov_b32 v227, v239
    v_permlane16_swap_b32 v236, v224
    v_permlane16_swap_b32 v237, v225
    v_permlane16_swap_b32 v238, v226
    v_permlane16_swap_b32 v239, v227
    v_add_f32 v236, v236, v224
    v_add_f32 v237, v237, v225
    v_add_f32 v238, v238, v226
    v_add_f32 v239, v239, v227
    v_bfe_u32 v254, v253, 3, 1
    v_lshlrev_b32 v246, 14, v254
    v_bfe_u32 v254, v253, 4, 1
    v_lshl_add_u32 v246, v254, 11, v246
    v_lshrrev_b32 v254, 5, v253
    v_lshl_add_u32 v246, v254, 10, v246
    v_and_b32 v254, 7, v253
    v_lshl_add_u32 v246, v254, 4, v246
    v_add_u32 v249, 9248, v246
    v_add_u32 v248, 6208, v246
    v_add_u32 v247, 3168, v246
    v_add_u32 v246, 128, v246
    s_branch L_slow_back
L_last:
.section .rodata,"a"
.p2align 6
.amdhsa_kernel concat_heads__gqa_block_cached__mha_block_cached__near_ridge_kernel
  .amdhsa_next_free_vgpr 256
  .amdhsa_next_free_sgpr 102
  .amdhsa_accum_offset 256
  .amdhsa_group_segment_fixed_size 0
  .amdhsa_kernarg_size 104
  .amdhsa_user_sgpr_count 2
  .amdhsa_user_sgpr_kernarg_segment_ptr 1
  .amdhsa_system_sgpr_workgroup_id_x 1
  .amdhsa_float_denorm_mode_32 3
.end_amdhsa_kernel
```
